```python
import torch

def _softmax(x, axis=-1):
    return torch.softmax(x, dim=axis)
def _gelu(x):
    return torch.nn.functional.gelu(x, approximate="tanh")
def _silu(x):
    return torch.nn.functional.silu(x)
def _sigmoid(x):
    return torch.sigmoid(x)
def _layernorm(x, axis=-1, eps=1e-5):
    m = x.mean(dim=axis, keepdim=True)
    v = x.var(dim=axis, keepdim=True, unbiased=False)
    return (x - m) / torch.sqrt(v + eps)
def _scatter_add(tgt, idx, src, axis=0):
    return tgt.clone().index_add_(axis, idx, src)
def _segment_sum(src, seg, n):
    out = torch.zeros((n,) + src.shape[1:], dtype=src.dtype)
    return out.index_add_(0, seg, src)
def _pad(x, pw):
    flat = tuple(v for pair in reversed(pw) for v in pair)
    return torch.nn.functional.pad(x, flat)

kernel_name = 'sequential_preLN__mha_block__glu_gated_reglu__prompt'

def setup_inputs():

    _w = (lambda a: (lambda t: t.to(torch.bfloat16) if t.is_floating_point() else t)(torch.as_tensor(a)))
    def _A_setup():
        B, S, D, H = 1, 2048, 640, 32
        return {
            "x": _w((lambda *s: torch.randn(*s, dtype=torch.bfloat16) * 0.05)(B, S, D)),
            "wqkv": _w((lambda *s: torch.randn(*s, dtype=torch.bfloat16) * 0.05)(D, 3 * D)),
            "wo": _w((lambda *s: torch.randn(*s, dtype=torch.bfloat16) * 0.05)(D, D)),
        }
    _A_in = _A_setup()

    def _B_setup():
        B, S, D, F = 1, 2048, 640, 1728
        return {
            "x": _w((lambda *s: torch.randn(*s, dtype=torch.bfloat16) * 0.05)(B, S, D)),
            "W_gate": _w((lambda *s: torch.randn(*s, dtype=torch.bfloat16) * 0.4)(D, F) * (2.0 / D) ** 0.5),
            "W_up": _w((lambda *s: torch.randn(*s, dtype=torch.bfloat16) * 0.4)(D, F) * (2.0 / D) ** 0.5),
            "W_down": _w((lambda *s: torch.randn(*s, dtype=torch.bfloat16) * 0.4)(F, D) * (1.0 / F) ** 0.5),
        }
    _B_in = _B_setup()

    return {
        "A_x": _A_in["x"],
        "A_wqkv": _A_in["wqkv"],
        "A_wo": _A_in["wo"],
        "B_x": _B_in["x"],
        "B_W_gate": _B_in["W_gate"],
        "B_W_up": _B_in["W_up"],
        "B_W_down": _B_in["W_down"],
    }

def reference(A_x, A_wqkv, A_wo, B_x, B_W_gate, B_W_up, B_W_down):
    def _A_ref(x, wqkv, wo):
        B, S, D = x.shape
        H = 32
        Dh = D // H
        qkv = (lambda x, *d: x.permute(*d))((x @ wqkv).reshape(B, S, 3, H, Dh), 2, 0, 3, 1, 4)
        q, k, v = qkv[0], qkv[1], qkv[2]
        scores = torch.einsum("bhqd,bhkd->bhqk", q, k) * (Dh ** -0.5)
        p = _softmax(scores, axis=-1)
        o = torch.einsum("bhqk,bhkd->bhqd", p, v)
        return (lambda x, *d: x.permute(*d))(o, 0, 2, 1, 3).reshape(B, S, D) @ wo

    def _B_ref(x, W_gate, W_up, W_down):
        gate = torch.einsum("bsd,df->bsf", x, W_gate)
        up = torch.einsum("bsd,df->bsf", x, W_up)
        gate = gate * (lambda x, dt: x.to(dt))(gate > 0, gate.dtype)
        h = gate * up
        return torch.einsum("bsf,fd->bsd", h, W_down)

    x = A_x
    h = x + _A_ref(_layernorm(x, axis=-1), A_wqkv, A_wo)
    h2 = h + _B_ref(_layernorm(h, axis=-1), B_W_gate, B_W_up, B_W_down)
    return h2
```

```asm
; @launch kernel=k_qkv_kernel grid=(240,1,1) block=(512,1,1) lds=133120
; @launch kernel=k_attn_kernel grid=(256,1,1) block=(512,1,1) lds=163840
; @launch kernel=k_ffn_kernel grid=(256,1,1) block=(512,1,1) lds=163840
.amdgcn_target "amdgcn-amd-amdhsa--gfx950"
.text
.globl k_qkv_kernel
.p2align 8
.type k_qkv_kernel,@function
k_qkv_kernel:
    s_cmp_ge_u32 s2, 240
    s_cbranch_scc1 k_qkv_kernel_end
    s_load_dwordx4 s[4:7], s[0:1], 0
    s_load_dwordx4 s[24:27], s[0:1], 32
    s_load_dwordx2 s[8:9], s[0:1], 72
    v_lshrrev_b32 v1, 6, v0
    v_and_b32 v0, 63, v0
    v_readfirstlane_b32 s3, v1
    v_readfirstlane_b32 s101, v1
    s_and_b32 s28, s2, 7
    s_lshr_b32 s29, s2, 3
    s_lshr_b32 s30, s28, 2
    s_mul_i32 s30, s30, 30
    s_add_u32 s30, s30, s29
    s_lshr_b32 s31, s30, 2
    s_and_b32 s30, s30, 3
    s_and_b32 s28, s28, 3
    s_lshl_b32 s28, s28, 2
    s_add_u32 s30, s30, s28
    v_and_b32 v2, 31, v0
    v_lshrrev_b32 v3, 5, v0
    v_bfe_u32 v4, v0, 1, 3
    s_cmp_ge_u32 s3, 4
    s_cbranch_scc1 k_qkv_kernel_helper
    s_setprio 2
    s_lshl_b32 s32, s29, 2
    s_add_u32 s32, s32, s3
    s_cmp_ge_u32 s32, 9
    s_cbranch_scc1 k_qkv_kernel_nocw
    s_getpc_b64 s[34:35]
k_qkv_kernel_cw_1:
    s_lshl_b32 s36, s32, 13
    v_lshlrev_b32 v190, 7, v0
    v_add_u32 v190, s36, v190
    v_min_u32 v190, code_end-k_qkv_kernel-4, v190
    s_sub_u32 s34, s34, k_qkv_kernel_cw_1-k_qkv_kernel
    s_subb_u32 s35, s35, 0
    v_mov_b32 v191, s35
    v_add_co_u32 v190, vcc, s34, v190
    s_nop 1
    v_addc_co_u32 v191, vcc, 0, v191, vcc
    global_load_dword v190, v[190:191], off
k_qkv_kernel_nocw:
    s_and_b32 s32, s3, 1
    s_lshr_b32 s33, s3, 1
    s_lshl_b32 s34, s32, 13
    s_lshl_b32 s35, s33, 12
    s_add_u32 s34, s34, s35
    v_lshlrev_b32 v5, 7, v2
    v_add_u32 v5, s34, v5
    v_or_b32 v6, 0, v3
    v_xor_b32 v6, v6, v4
    v_lshl_add_u32 v8, v6, 4, v5
    v_xor_b32 v128, 4096, v8
    v_or_b32 v6, 2, v3
    v_xor_b32 v6, v6, v4
    v_lshl_add_u32 v9, v6, 4, v5
    v_xor_b32 v129, 4096, v9
    v_or_b32 v6, 4, v3
    v_xor_b32 v6, v6, v4
    v_lshl_add_u32 v10, v6, 4, v5
    v_xor_b32 v130, 4096, v10
    v_or_b32 v6, 6, v3
    v_xor_b32 v6, v6, v4
    v_lshl_add_u32 v11, v6, 4, v5
    v_xor_b32 v131, 4096, v11
    v_mov_b32 v132, 0
    v_mov_b32 v133, 0
    v_mov_b32 v134, 0
    v_mov_b32 v135, 0
    s_mov_b32 s47, 0xffff0000
    v_bfe_u32 v5, v0, 2, 2
    v_lshl_add_u32 v6, v3, 3, v5
    v_lshlrev_b32 v6, 8, v6
    v_bfe_u32 v7, v0, 4, 1
    v_lshl_add_u32 v6, v7, 5, v6
    v_and_b32 v7, 3, v0
    v_lshl_add_u32 v6, v7, 3, v6
    v_add_u32 v6, 65536, v6
    s_lshl_b32 s35, s33, 1
    s_add_u32 s35, s35, s32
    s_xor_b32 s36, s35, 0
    v_xor_b32 v7, s36, v5
    v_lshl_add_u32 v12, v7, 6, v6
    s_xor_b32 s36, s35, 1
    v_xor_b32 v7, s36, v5
    v_lshl_add_u32 v13, v7, 6, v6
    v_and_b32 v5, 15, v0
    v_bfe_u32 v6, v0, 4, 1
    v_cmp_eq_u32 vcc, v5, v6
    v_mov_b32 v5, 0x3f803f80
    s_nop 0
    v_cndmask_b32 v116, 0, v5, vcc
    v_mov_b32 v117, v116
    v_mov_b32 v118, v116
    v_mov_b32 v119, v116
    v_mov_b32 v48, 0
    v_mov_b32 v49, 0
    v_mov_b32 v50, 0
    v_mov_b32 v51, 0
    v_mov_b32 v52, 0
    v_mov_b32 v53, 0
    v_mov_b32 v54, 0
    v_mov_b32 v55, 0
    v_mov_b32 v56, 0
    v_mov_b32 v57, 0
    v_mov_b32 v58, 0
    v_mov_b32 v59, 0
    v_mov_b32 v60, 0
    v_mov_b32 v61, 0
    v_mov_b32 v62, 0
    v_mov_b32 v63, 0
    v_mov_b32 v64, 0
    v_mov_b32 v65, 0
    v_mov_b32 v66, 0
    v_mov_b32 v67, 0
    v_mov_b32 v68, 0
    v_mov_b32 v69, 0
    v_mov_b32 v70, 0
    v_mov_b32 v71, 0
    v_mov_b32 v72, 0
    v_mov_b32 v73, 0
    v_mov_b32 v74, 0
    v_mov_b32 v75, 0
    v_mov_b32 v76, 0
    v_mov_b32 v77, 0
    v_mov_b32 v78, 0
    v_mov_b32 v79, 0
    v_mov_b32 v80, 0
    v_mov_b32 v81, 0
    v_mov_b32 v82, 0
    v_mov_b32 v83, 0
    v_mov_b32 v84, 0
    v_mov_b32 v85, 0
    v_mov_b32 v86, 0
    v_mov_b32 v87, 0
    v_mov_b32 v88, 0
    v_mov_b32 v89, 0
    v_mov_b32 v90, 0
    v_mov_b32 v91, 0
    v_mov_b32 v92, 0
    v_mov_b32 v93, 0
    v_mov_b32 v94, 0
    v_mov_b32 v95, 0
    v_mov_b32 v96, 0
    v_mov_b32 v97, 0
    v_mov_b32 v98, 0
    v_mov_b32 v99, 0
    v_mov_b32 v100, 0
    v_mov_b32 v101, 0
    v_mov_b32 v102, 0
    v_mov_b32 v103, 0
    v_mov_b32 v104, 0
    v_mov_b32 v105, 0
    v_mov_b32 v106, 0
    v_mov_b32 v107, 0
    v_mov_b32 v108, 0
    v_mov_b32 v109, 0
    v_mov_b32 v110, 0
    v_mov_b32 v111, 0
    v_mov_b32 v112, 0
    v_mov_b32 v113, 0
    v_mov_b32 v114, 0
    v_mov_b32 v115, 0
    s_waitcnt lgkmcnt(0)
    s_cmp_ge_u32 s31, 10
    s_cbranch_scc1 k_qkv_kernel_vsetup
    s_cmp_ge_u32 s31, 5
    s_cselect_b32 s37, 5, 0
    s_sub_u32 s37, s31, s37
    s_cmp_ge_u32 s31, 5
    s_cselect_b32 s38, 0x300000, 0x0
    s_movk_i32 s39, 1280
    s_cselect_b32 s39, 2560, s39
    s_cselect_b32 s40, 0x3f800000, 0x3ea52b5c
    s_add_u32 s20, s8, s38
    s_addc_u32 s21, s9, 0
    s_lshl_b32 s22, s39, 11
    s_mov_b32 s23, 0x00020000
    s_lshl_b32 s41, s39, 6
    s_lshl_b32 s42, s30, 2
    s_lshl_b32 s43, s32, 1
    s_add_u32 s42, s42, s43
    s_add_u32 s42, s42, s33
    s_xor_b32 s43, s42, 1
    s_mul_i32 s42, s42, s39
    s_mul_i32 s43, s43, s39
    v_bfe_u32 v5, v2, 2, 1
    v_bfe_u32 v6, v2, 3, 1
    v_xor_b32 v5, v5, v6
    v_mul_u32_u24 v5, 12, v5
    v_xor_b32 v5, v5, v2
    s_cmp_ge_u32 s31, 5
    s_cselect_b64 vcc, -1, 0
    v_cndmask_b32 v5, v2, v5, vcc
    v_lshlrev_b32 v5, 4, v5
    s_lshl_b32 s44, s37, 5
    s_lshl_b32 s45, s33, 4
    s_add_u32 s44, s44, s45
    s_xor_b32 s45, s32, 0
    s_lshl_b32 s45, s45, 3
    s_add_u32 s45, s45, s44
    v_add_u32 v6, s45, v3
    v_add_u32 v7, 0, v6
    v_mul_u32_u24 v1, 205, v7
    v_lshrrev_b32 v1, 10, v1
    v_mul_u32_u24 v4, 5, v1
    v_sub_u32 v7, v7, v4
    v_mul_lo_u32 v120, v1, s41
    v_lshrrev_b32 v1, 1, v7
    v_lshl_add_u32 v120, v1, 9, v120
    v_and_b32 v1, 1, v7
    v_lshl_add_u32 v120, v1, 3, v120
    v_lshrrev_b32 v1, 2, v7
    v_lshrrev_b32 v1, v1, v5
    v_add_u32 v120, v120, v1
    v_add_u32 v7, 2, v6
    v_mul_u32_u24 v1, 205, v7
    v_lshrrev_b32 v1, 10, v1
    v_mul_u32_u24 v4, 5, v1
    v_sub_u32 v7, v7, v4
    v_mul_lo_u32 v121, v1, s41
    v_lshrrev_b32 v1, 1, v7
    v_lshl_add_u32 v121, v1, 9, v121
    v_and_b32 v1, 1, v7
    v_lshl_add_u32 v121, v1, 3, v121
    v_lshrrev_b32 v1, 2, v7
    v_lshrrev_b32 v1, v1, v5
    v_add_u32 v121, v121, v1
    v_add_u32 v7, 4, v6
    v_mul_u32_u24 v1, 205, v7
    v_lshrrev_b32 v1, 10, v1
    v_mul_u32_u24 v4, 5, v1
    v_sub_u32 v7, v7, v4
    v_mul_lo_u32 v122, v1, s41
    v_lshrrev_b32 v1, 1, v7
    v_lshl_add_u32 v122, v1, 9, v122
    v_and_b32 v1, 1, v7
    v_lshl_add_u32 v122, v1, 3, v122
    v_lshrrev_b32 v1, 2, v7
    v_lshrrev_b32 v1, v1, v5
    v_add_u32 v122, v122, v1
    v_add_u32 v7, 6, v6
    v_mul_u32_u24 v1, 205, v7
    v_lshrrev_b32 v1, 10, v1
    v_mul_u32_u24 v4, 5, v1
    v_sub_u32 v7, v7, v4
    v_mul_lo_u32 v123, v1, s41
    v_lshrrev_b32 v1, 1, v7
    v_lshl_add_u32 v123, v1, 9, v123
    v_and_b32 v1, 1, v7
    v_lshl_add_u32 v123, v1, 3, v123
    v_lshrrev_b32 v1, 2, v7
    v_lshrrev_b32 v1, v1, v5
    v_add_u32 v123, v123, v1
    s_xor_b32 s45, s32, 1
    s_lshl_b32 s45, s45, 3
    s_add_u32 s45, s45, s44
    v_add_u32 v6, s45, v3
    v_add_u32 v7, 0, v6
    v_mul_u32_u24 v1, 205, v7
    v_lshrrev_b32 v1, 10, v1
    v_mul_u32_u24 v4, 5, v1
    v_sub_u32 v7, v7, v4
    v_mul_lo_u32 v124, v1, s41
    v_lshrrev_b32 v1, 1, v7
    v_lshl_add_u32 v124, v1, 9, v124
    v_and_b32 v1, 1, v7
    v_lshl_add_u32 v124, v1, 3, v124
    v_lshrrev_b32 v1, 2, v7
    v_lshrrev_b32 v1, v1, v5
    v_add_u32 v124, v124, v1
    v_add_u32 v7, 2, v6
    v_mul_u32_u24 v1, 205, v7
    v_lshrrev_b32 v1, 10, v1
    v_mul_u32_u24 v4, 5, v1
    v_sub_u32 v7, v7, v4
    v_mul_lo_u32 v125, v1, s41
    v_lshrrev_b32 v1, 1, v7
    v_lshl_add_u32 v125, v1, 9, v125
    v_and_b32 v1, 1, v7
    v_lshl_add_u32 v125, v1, 3, v125
    v_lshrrev_b32 v1, 2, v7
    v_lshrrev_b32 v1, v1, v5
    v_add_u32 v125, v125, v1
    v_add_u32 v7, 4, v6
    v_mul_u32_u24 v1, 205, v7
    v_lshrrev_b32 v1, 10, v1
    v_mul_u32_u24 v4, 5, v1
    v_sub_u32 v7, v7, v4
    v_mul_lo_u32 v126, v1, s41
    v_lshrrev_b32 v1, 1, v7
    v_lshl_add_u32 v126, v1, 9, v126
    v_and_b32 v1, 1, v7
    v_lshl_add_u32 v126, v1, 3, v126
    v_lshrrev_b32 v1, 2, v7
    v_lshrrev_b32 v1, v1, v5
    v_add_u32 v126, v126, v1
    v_add_u32 v7, 6, v6
    v_mul_u32_u24 v1, 205, v7
    v_lshrrev_b32 v1, 10, v1
    v_mul_u32_u24 v4, 5, v1
    v_sub_u32 v7, v7, v4
    v_mul_lo_u32 v127, v1, s41
    v_lshrrev_b32 v1, 1, v7
    v_lshl_add_u32 v127, v1, 9, v127
    v_and_b32 v1, 1, v7
    v_lshl_add_u32 v127, v1, 3, v127
    v_lshrrev_b32 v1, 2, v7
    v_lshrrev_b32 v1, v1, v5
    v_add_u32 v127, v127, v1
    s_barrier
    ds_read_b128 v[16:19], v8 offset:0
    ds_read_b64_tr_b16 v[32:33], v12 offset:0
    ds_read_b64_tr_b16 v[34:35], v12 offset:1024
    ds_read_b128 v[20:23], v128 offset:0
    ds_read_b64_tr_b16 v[36:37], v13 offset:0
    ds_read_b64_tr_b16 v[38:39], v13 offset:1024
    s_waitcnt lgkmcnt(0)
    v_mfma_f32_32x32x16_bf16 v[48:63], v[32:35], v[16:19], v[48:63]
    ds_read_b128 v[24:27], v9 offset:0
    ds_read_b64_tr_b16 v[40:41], v12 offset:4096
    ds_read_b64_tr_b16 v[42:43], v12 offset:5120
    v_lshlrev_b32 v136, 16, v16
    v_and_b32 v137, s47, v16
    v_add_f32 v132, v132, v136
    v_add_f32 v133, v133, v137
    v_fmac_f32 v134, v136, v136
    v_mfma_f32_32x32x16_bf16 v[64:79], v[32:35], v[20:23], v[64:79]
    ds_read_b128 v[28:31], v129 offset:0
    ds_read_b64_tr_b16 v[44:45], v13 offset:4096
    ds_read_b64_tr_b16 v[46:47], v13 offset:5120
    v_fmac_f32 v135, v137, v137
    v_lshlrev_b32 v138, 16, v17
    v_and_b32 v139, s47, v17
    v_add_f32 v132, v132, v138
    v_add_f32 v133, v133, v139
    v_mfma_f32_32x32x16_bf16 v[96:111], v[36:39], v[20:23], v[96:111]
    v_fmac_f32 v134, v138, v138
    v_fmac_f32 v135, v139, v139
    v_lshlrev_b32 v136, 16, v18
    v_and_b32 v137, s47, v18
    v_add_f32 v132, v132, v136
    v_add_f32 v133, v133, v137
    v_fmac_f32 v134, v136, v136
    v_mfma_f32_32x32x16_bf16 v[80:95], v[36:39], v[16:19], v[80:95]
    v_fmac_f32 v135, v137, v137
    v_lshlrev_b32 v138, 16, v19
    v_and_b32 v139, s47, v19
    v_add_f32 v132, v132, v138
    v_add_f32 v133, v133, v139
    v_fmac_f32 v134, v138, v138
    v_fmac_f32 v135, v139, v139
    v_mfma_f32_16x16x32_bf16 v[112:115], v[116:119], v[32:35], v[112:115]
    s_waitcnt lgkmcnt(0)
    v_mfma_f32_32x32x16_bf16 v[48:63], v[40:43], v[24:27], v[48:63]
    ds_read_b128 v[16:19], v10 offset:0
    ds_read_b64_tr_b16 v[32:33], v12 offset:8192
    ds_read_b64_tr_b16 v[34:35], v12 offset:9216
    v_lshlrev_b32 v136, 16, v24
    v_and_b32 v137, s47, v24
    v_add_f32 v132, v132, v136
    v_add_f32 v133, v133, v137
    v_fmac_f32 v134, v136, v136
    v_mfma_f32_32x32x16_bf16 v[64:79], v[40:43], v[28:31], v[64:79]
    ds_read_b128 v[20:23], v130 offset:0
    ds_read_b64_tr_b16 v[36:37], v13 offset:8192
    ds_read_b64_tr_b16 v[38:39], v13 offset:9216
    v_fmac_f32 v135, v137, v137
    v_lshlrev_b32 v138, 16, v25
    v_and_b32 v139, s47, v25
    v_add_f32 v132, v132, v138
    v_add_f32 v133, v133, v139
    v_mfma_f32_32x32x16_bf16 v[96:111], v[44:47], v[28:31], v[96:111]
    v_fmac_f32 v134, v138, v138
    v_fmac_f32 v135, v139, v139
    v_lshlrev_b32 v136, 16, v26
    v_and_b32 v137, s47, v26
    v_add_f32 v132, v132, v136
    v_add_f32 v133, v133, v137
    v_fmac_f32 v134, v136, v136
    v_mfma_f32_32x32x16_bf16 v[80:95], v[44:47], v[24:27], v[80:95]
    v_fmac_f32 v135, v137, v137
    v_lshlrev_b32 v138, 16, v27
    v_and_b32 v139, s47, v27
    v_add_f32 v132, v132, v138
    v_add_f32 v133, v133, v139
    v_fmac_f32 v134, v138, v138
    v_fmac_f32 v135, v139, v139
    v_mfma_f32_16x16x32_bf16 v[112:115], v[116:119], v[40:43], v[112:115]
    s_waitcnt lgkmcnt(0)
    v_mfma_f32_32x32x16_bf16 v[48:63], v[32:35], v[16:19], v[48:63]
    ds_read_b128 v[24:27], v11 offset:0
    ds_read_b64_tr_b16 v[40:41], v12 offset:12288
    ds_read_b64_tr_b16 v[42:43], v12 offset:13312
    v_lshlrev_b32 v136, 16, v16
    v_and_b32 v137, s47, v16
    v_add_f32 v132, v132, v136
    v_add_f32 v133, v133, v137
    v_fmac_f32 v134, v136, v136
    v_mfma_f32_32x32x16_bf16 v[64:79], v[32:35], v[20:23], v[64:79]
    ds_read_b128 v[28:31], v131 offset:0
    ds_read_b64_tr_b16 v[44:45], v13 offset:12288
    ds_read_b64_tr_b16 v[46:47], v13 offset:13312
    v_fmac_f32 v135, v137, v137
    v_lshlrev_b32 v138, 16, v17
    v_and_b32 v139, s47, v17
    v_add_f32 v132, v132, v138
    v_add_f32 v133, v133, v139
    v_mfma_f32_32x32x16_bf16 v[96:111], v[36:39], v[20:23], v[96:111]
    v_fmac_f32 v134, v138, v138
    v_fmac_f32 v135, v139, v139
    v_lshlrev_b32 v136, 16, v18
    v_and_b32 v137, s47, v18
    v_add_f32 v132, v132, v136
    v_add_f32 v133, v133, v137
    v_fmac_f32 v134, v136, v136
    v_mfma_f32_32x32x16_bf16 v[80:95], v[36:39], v[16:19], v[80:95]
    v_fmac_f32 v135, v137, v137
    v_lshlrev_b32 v138, 16, v19
    v_and_b32 v139, s47, v19
    v_add_f32 v132, v132, v138
    v_add_f32 v133, v133, v139
    v_fmac_f32 v134, v138, v138
    v_fmac_f32 v135, v139, v139
    v_mfma_f32_16x16x32_bf16 v[112:115], v[116:119], v[32:35], v[112:115]
    s_waitcnt lgkmcnt(0)
    v_mfma_f32_32x32x16_bf16 v[48:63], v[40:43], v[24:27], v[48:63]
    v_lshlrev_b32 v136, 16, v24
    v_and_b32 v137, s47, v24
    v_add_f32 v132, v132, v136
    v_add_f32 v133, v133, v137
    v_fmac_f32 v134, v136, v136
    v_fmac_f32 v135, v137, v137
    v_lshlrev_b32 v138, 16, v25
    v_and_b32 v139, s47, v25
    v_mfma_f32_32x32x16_bf16 v[64:79], v[40:43], v[28:31], v[64:79]
    s_barrier
    ds_read_b128 v[16:19], v8 offset:16384
    ds_read_b64_tr_b16 v[32:33], v12 offset:16384
    ds_read_b64_tr_b16 v[34:35], v12 offset:17408
    v_add_f32 v132, v132, v138
    v_add_f32 v133, v133, v139
    v_fmac_f32 v134, v138, v138
    v_fmac_f32 v135, v139, v139
    v_lshlrev_b32 v136, 16, v26
    v_mfma_f32_32x32x16_bf16 v[96:111], v[44:47], v[28:31], v[96:111]
    ds_read_b128 v[20:23], v128 offset:16384
    ds_read_b64_tr_b16 v[36:37], v13 offset:16384
    ds_read_b64_tr_b16 v[38:39], v13 offset:17408
    v_and_b32 v137, s47, v26
    v_add_f32 v132, v132, v136
    v_add_f32 v133, v133, v137
    v_fmac_f32 v134, v136, v136
    v_mfma_f32_32x32x16_bf16 v[80:95], v[44:47], v[24:27], v[80:95]
    v_fmac_f32 v135, v137, v137
    v_lshlrev_b32 v138, 16, v27
    v_and_b32 v139, s47, v27
    v_add_f32 v132, v132, v138
    v_add_f32 v133, v133, v139
    v_fmac_f32 v134, v138, v138
    v_fmac_f32 v135, v139, v139
    v_mfma_f32_16x16x32_bf16 v[112:115], v[116:119], v[40:43], v[112:115]
    s_waitcnt lgkmcnt(0)
    v_mfma_f32_32x32x16_bf16 v[48:63], v[32:35], v[16:19], v[48:63]
    ds_read_b128 v[24:27], v9 offset:16384
    ds_read_b64_tr_b16 v[40:41], v12 offset:20480
    ds_read_b64_tr_b16 v[42:43], v12 offset:21504
    v_lshlrev_b32 v136, 16, v16
    v_and_b32 v137, s47, v16
    v_add_f32 v132, v132, v136
    v_add_f32 v133, v133, v137
    v_fmac_f32 v134, v136, v136
    v_mfma_f32_32x32x16_bf16 v[64:79], v[32:35], v[20:23], v[64:79]
    ds_read_b128 v[28:31], v129 offset:16384
    ds_read_b64_tr_b16 v[44:45], v13 offset:20480
    ds_read_b64_tr_b16 v[46:47], v13 offset:21504
    v_fmac_f32 v135, v137, v137
    v_lshlrev_b32 v138, 16, v17
    v_and_b32 v139, s47, v17
    v_add_f32 v132, v132, v138
    v_add_f32 v133, v133, v139
    v_mfma_f32_32x32x16_bf16 v[96:111], v[36:39], v[20:23], v[96:111]
    v_fmac_f32 v134, v138, v138
    v_fmac_f32 v135, v139, v139
    v_lshlrev_b32 v136, 16, v18
    v_and_b32 v137, s47, v18
    v_add_f32 v132, v132, v136
    v_add_f32 v133, v133, v137
    v_fmac_f32 v134, v136, v136
    v_mfma_f32_32x32x16_bf16 v[80:95], v[36:39], v[16:19], v[80:95]
    v_fmac_f32 v135, v137, v137
    v_lshlrev_b32 v138, 16, v19
    v_and_b32 v139, s47, v19
    v_add_f32 v132, v132, v138
    v_add_f32 v133, v133, v139
    v_fmac_f32 v134, v138, v138
    v_fmac_f32 v135, v139, v139
    v_mfma_f32_16x16x32_bf16 v[112:115], v[116:119], v[32:35], v[112:115]
    s_waitcnt lgkmcnt(0)
    v_mfma_f32_32x32x16_bf16 v[48:63], v[40:43], v[24:27], v[48:63]
    ds_read_b128 v[16:19], v10 offset:16384
    ds_read_b64_tr_b16 v[32:33], v12 offset:24576
    ds_read_b64_tr_b16 v[34:35], v12 offset:25600
    v_lshlrev_b32 v136, 16, v24
    v_and_b32 v137, s47, v24
    v_add_f32 v132, v132, v136
    v_add_f32 v133, v133, v137
    v_fmac_f32 v134, v136, v136
    v_mfma_f32_32x32x16_bf16 v[64:79], v[40:43], v[28:31], v[64:79]
    ds_read_b128 v[20:23], v130 offset:16384
    ds_read_b64_tr_b16 v[36:37], v13 offset:24576
    ds_read_b64_tr_b16 v[38:39], v13 offset:25600
    v_fmac_f32 v135, v137, v137
    v_lshlrev_b32 v138, 16, v25
    v_and_b32 v139, s47, v25
    v_add_f32 v132, v132, v138
    v_add_f32 v133, v133, v139
    v_mfma_f32_32x32x16_bf16 v[96:111], v[44:47], v[28:31], v[96:111]
    v_fmac_f32 v134, v138, v138
    v_fmac_f32 v135, v139, v139
    v_lshlrev_b32 v136, 16, v26
    v_and_b32 v137, s47, v26
    v_add_f32 v132, v132, v136
    v_add_f32 v133, v133, v137
    v_fmac_f32 v134, v136, v136
    v_mfma_f32_32x32x16_bf16 v[80:95], v[44:47], v[24:27], v[80:95]
    v_fmac_f32 v135, v137, v137
    v_lshlrev_b32 v138, 16, v27
    v_and_b32 v139, s47, v27
    v_add_f32 v132, v132, v138
    v_add_f32 v133, v133, v139
    v_fmac_f32 v134, v138, v138
    v_fmac_f32 v135, v139, v139
    v_mfma_f32_16x16x32_bf16 v[112:115], v[116:119], v[40:43], v[112:115]
    s_waitcnt lgkmcnt(0)
    v_mfma_f32_32x32x16_bf16 v[48:63], v[32:35], v[16:19], v[48:63]
    ds_read_b128 v[24:27], v11 offset:16384
    ds_read_b64_tr_b16 v[40:41], v12 offset:28672
    ds_read_b64_tr_b16 v[42:43], v12 offset:29696
    v_lshlrev_b32 v136, 16, v16
    v_and_b32 v137, s47, v16
    v_add_f32 v132, v132, v136
    v_add_f32 v133, v133, v137
    v_fmac_f32 v134, v136, v136
    v_mfma_f32_32x32x16_bf16 v[64:79], v[32:35], v[20:23], v[64:79]
    ds_read_b128 v[28:31], v131 offset:16384
    ds_read_b64_tr_b16 v[44:45], v13 offset:28672
    ds_read_b64_tr_b16 v[46:47], v13 offset:29696
    v_fmac_f32 v135, v137, v137
    v_lshlrev_b32 v138, 16, v17
    v_and_b32 v139, s47, v17
    v_add_f32 v132, v132, v138
    v_add_f32 v133, v133, v139
    v_mfma_f32_32x32x16_bf16 v[96:111], v[36:39], v[20:23], v[96:111]
    v_fmac_f32 v134, v138, v138
    v_fmac_f32 v135, v139, v139
    v_lshlrev_b32 v136, 16, v18
    v_and_b32 v137, s47, v18
    v_add_f32 v132, v132, v136
    v_add_f32 v133, v133, v137
    v_fmac_f32 v134, v136, v136
    v_mfma_f32_32x32x16_bf16 v[80:95], v[36:39], v[16:19], v[80:95]
    v_fmac_f32 v135, v137, v137
    v_lshlrev_b32 v138, 16, v19
    v_and_b32 v139, s47, v19
    v_add_f32 v132, v132, v138
    v_add_f32 v133, v133, v139
    v_fmac_f32 v134, v138, v138
    v_fmac_f32 v135, v139, v139
    v_mfma_f32_16x16x32_bf16 v[112:115], v[116:119], v[32:35], v[112:115]
    s_waitcnt lgkmcnt(0)
    v_mfma_f32_32x32x16_bf16 v[48:63], v[40:43], v[24:27], v[48:63]
    v_lshlrev_b32 v136, 16, v24
    v_and_b32 v137, s47, v24
    v_add_f32 v132, v132, v136
    v_add_f32 v133, v133, v137
    v_fmac_f32 v134, v136, v136
    v_fmac_f32 v135, v137, v137
    v_lshlrev_b32 v138, 16, v25
    v_and_b32 v139, s47, v25
    v_mfma_f32_32x32x16_bf16 v[64:79], v[40:43], v[28:31], v[64:79]
    s_barrier
    ds_read_b128 v[16:19], v8 offset:32768
    ds_read_b64_tr_b16 v[32:33], v12 offset:32768
    ds_read_b64_tr_b16 v[34:35], v12 offset:33792
    v_add_f32 v132, v132, v138
    v_add_f32 v133, v133, v139
    v_fmac_f32 v134, v138, v138
    v_fmac_f32 v135, v139, v139
    v_lshlrev_b32 v136, 16, v26
    v_mfma_f32_32x32x16_bf16 v[96:111], v[44:47], v[28:31], v[96:111]
    ds_read_b128 v[20:23], v128 offset:32768
    ds_read_b64_tr_b16 v[36:37], v13 offset:32768
    ds_read_b64_tr_b16 v[38:39], v13 offset:33792
    v_and_b32 v137, s47, v26
    v_add_f32 v132, v132, v136
    v_add_f32 v133, v133, v137
    v_fmac_f32 v134, v136, v136
    v_mfma_f32_32x32x16_bf16 v[80:95], v[44:47], v[24:27], v[80:95]
    v_fmac_f32 v135, v137, v137
    v_lshlrev_b32 v138, 16, v27
    v_and_b32 v139, s47, v27
    v_add_f32 v132, v132, v138
    v_add_f32 v133, v133, v139
    v_fmac_f32 v134, v138, v138
    v_fmac_f32 v135, v139, v139
    v_mfma_f32_16x16x32_bf16 v[112:115], v[116:119], v[40:43], v[112:115]
    s_waitcnt lgkmcnt(0)
    v_mfma_f32_32x32x16_bf16 v[48:63], v[32:35], v[16:19], v[48:63]
    ds_read_b128 v[24:27], v9 offset:32768
    ds_read_b64_tr_b16 v[40:41], v12 offset:36864
    ds_read_b64_tr_b16 v[42:43], v12 offset:37888
    v_lshlrev_b32 v136, 16, v16
    v_and_b32 v137, s47, v16
    v_add_f32 v132, v132, v136
    v_add_f32 v133, v133, v137
    v_fmac_f32 v134, v136, v136
    v_mfma_f32_32x32x16_bf16 v[64:79], v[32:35], v[20:23], v[64:79]
    ds_read_b128 v[28:31], v129 offset:32768
    ds_read_b64_tr_b16 v[44:45], v13 offset:36864
    ds_read_b64_tr_b16 v[46:47], v13 offset:37888
    v_fmac_f32 v135, v137, v137
    v_lshlrev_b32 v138, 16, v17
    v_and_b32 v139, s47, v17
    v_add_f32 v132, v132, v138
    v_add_f32 v133, v133, v139
    v_mfma_f32_32x32x16_bf16 v[96:111], v[36:39], v[20:23], v[96:111]
    v_fmac_f32 v134, v138, v138
    v_fmac_f32 v135, v139, v139
    v_lshlrev_b32 v136, 16, v18
    v_and_b32 v137, s47, v18
    v_add_f32 v132, v132, v136
    v_add_f32 v133, v133, v137
    v_fmac_f32 v134, v136, v136
    v_mfma_f32_32x32x16_bf16 v[80:95], v[36:39], v[16:19], v[80:95]
    v_fmac_f32 v135, v137, v137
    v_lshlrev_b32 v138, 16, v19
    v_and_b32 v139, s47, v19
    v_add_f32 v132, v132, v138
    v_add_f32 v133, v133, v139
    v_fmac_f32 v134, v138, v138
    v_fmac_f32 v135, v139, v139
    v_mfma_f32_16x16x32_bf16 v[112:115], v[116:119], v[32:35], v[112:115]
    s_waitcnt lgkmcnt(0)
    v_mfma_f32_32x32x16_bf16 v[48:63], v[40:43], v[24:27], v[48:63]
    ds_read_b128 v[16:19], v10 offset:32768
    ds_read_b64_tr_b16 v[32:33], v12 offset:40960
    ds_read_b64_tr_b16 v[34:35], v12 offset:41984
    v_lshlrev_b32 v136, 16, v24
    v_and_b32 v137, s47, v24
    v_add_f32 v132, v132, v136
    v_add_f32 v133, v133, v137
    v_fmac_f32 v134, v136, v136
    v_mfma_f32_32x32x16_bf16 v[64:79], v[40:43], v[28:31], v[64:79]
    ds_read_b128 v[20:23], v130 offset:32768
    ds_read_b64_tr_b16 v[36:37], v13 offset:40960
    ds_read_b64_tr_b16 v[38:39], v13 offset:41984
    v_fmac_f32 v135, v137, v137
    v_lshlrev_b32 v138, 16, v25
    v_and_b32 v139, s47, v25
    v_add_f32 v132, v132, v138
    v_add_f32 v133, v133, v139
    v_mfma_f32_32x32x16_bf16 v[96:111], v[44:47], v[28:31], v[96:111]
    v_fmac_f32 v134, v138, v138
    v_fmac_f32 v135, v139, v139
    v_lshlrev_b32 v136, 16, v26
    v_and_b32 v137, s47, v26
    v_add_f32 v132, v132, v136
    v_add_f32 v133, v133, v137
    v_fmac_f32 v134, v136, v136
    v_mfma_f32_32x32x16_bf16 v[80:95], v[44:47], v[24:27], v[80:95]
    v_fmac_f32 v135, v137, v137
    v_lshlrev_b32 v138, 16, v27
    v_and_b32 v139, s47, v27
    v_add_f32 v132, v132, v138
    v_add_f32 v133, v133, v139
    v_fmac_f32 v134, v138, v138
    v_fmac_f32 v135, v139, v139
    v_mfma_f32_16x16x32_bf16 v[112:115], v[116:119], v[40:43], v[112:115]
    s_waitcnt lgkmcnt(0)
    v_mfma_f32_32x32x16_bf16 v[48:63], v[32:35], v[16:19], v[48:63]
    ds_read_b128 v[24:27], v11 offset:32768
    ds_read_b64_tr_b16 v[40:41], v12 offset:45056
    ds_read_b64_tr_b16 v[42:43], v12 offset:46080
    v_lshlrev_b32 v136, 16, v16
    v_and_b32 v137, s47, v16
    v_add_f32 v132, v132, v136
    v_add_f32 v133, v133, v137
    v_fmac_f32 v134, v136, v136
    v_mfma_f32_32x32x16_bf16 v[64:79], v[32:35], v[20:23], v[64:79]
    ds_read_b128 v[28:31], v131 offset:32768
    ds_read_b64_tr_b16 v[44:45], v13 offset:45056
    ds_read_b64_tr_b16 v[46:47], v13 offset:46080
    v_fmac_f32 v135, v137, v137
    v_lshlrev_b32 v138, 16, v17
    v_and_b32 v139, s47, v17
    v_add_f32 v132, v132, v138
    v_add_f32 v133, v133, v139
    v_mfma_f32_32x32x16_bf16 v[96:111], v[36:39], v[20:23], v[96:111]
    v_fmac_f32 v134, v138, v138
    v_fmac_f32 v135, v139, v139
    v_lshlrev_b32 v136, 16, v18
    v_and_b32 v137, s47, v18
    v_add_f32 v132, v132, v136
    v_add_f32 v133, v133, v137
    v_fmac_f32 v134, v136, v136
    v_mfma_f32_32x32x16_bf16 v[80:95], v[36:39], v[16:19], v[80:95]
    v_fmac_f32 v135, v137, v137
    v_lshlrev_b32 v138, 16, v19
    v_and_b32 v139, s47, v19
    v_add_f32 v132, v132, v138
    v_add_f32 v133, v133, v139
    v_fmac_f32 v134, v138, v138
    v_fmac_f32 v135, v139, v139
    v_mfma_f32_16x16x32_bf16 v[112:115], v[116:119], v[32:35], v[112:115]
    s_waitcnt lgkmcnt(0)
    v_mfma_f32_32x32x16_bf16 v[48:63], v[40:43], v[24:27], v[48:63]
    v_lshlrev_b32 v136, 16, v24
    v_and_b32 v137, s47, v24
    v_add_f32 v132, v132, v136
    v_add_f32 v133, v133, v137
    v_fmac_f32 v134, v136, v136
    v_fmac_f32 v135, v137, v137
    v_lshlrev_b32 v138, 16, v25
    v_and_b32 v139, s47, v25
    v_mfma_f32_32x32x16_bf16 v[64:79], v[40:43], v[28:31], v[64:79]
    s_barrier
    ds_read_b128 v[16:19], v8 offset:49152
    ds_read_b64_tr_b16 v[32:33], v12 offset:49152
    ds_read_b64_tr_b16 v[34:35], v12 offset:50176
    v_add_f32 v132, v132, v138
    v_add_f32 v133, v133, v139
    v_fmac_f32 v134, v138, v138
    v_fmac_f32 v135, v139, v139
    v_lshlrev_b32 v136, 16, v26
    v_mfma_f32_32x32x16_bf16 v[96:111], v[44:47], v[28:31], v[96:111]
    ds_read_b128 v[20:23], v128 offset:49152
    ds_read_b64_tr_b16 v[36:37], v13 offset:49152
    ds_read_b64_tr_b16 v[38:39], v13 offset:50176
    v_and_b32 v137, s47, v26
    v_add_f32 v132, v132, v136
    v_add_f32 v133, v133, v137
    v_fmac_f32 v134, v136, v136
    v_mfma_f32_32x32x16_bf16 v[80:95], v[44:47], v[24:27], v[80:95]
    v_fmac_f32 v135, v137, v137
    v_lshlrev_b32 v138, 16, v27
    v_and_b32 v139, s47, v27
    v_add_f32 v132, v132, v138
    v_add_f32 v133, v133, v139
    v_fmac_f32 v134, v138, v138
    v_fmac_f32 v135, v139, v139
    v_mfma_f32_16x16x32_bf16 v[112:115], v[116:119], v[40:43], v[112:115]
    s_waitcnt lgkmcnt(0)
    v_mfma_f32_32x32x16_bf16 v[48:63], v[32:35], v[16:19], v[48:63]
    ds_read_b128 v[24:27], v9 offset:49152
    ds_read_b64_tr_b16 v[40:41], v12 offset:53248
    ds_read_b64_tr_b16 v[42:43], v12 offset:54272
    v_lshlrev_b32 v136, 16, v16
    v_and_b32 v137, s47, v16
    v_add_f32 v132, v132, v136
    v_add_f32 v133, v133, v137
    v_fmac_f32 v134, v136, v136
    v_mfma_f32_32x32x16_bf16 v[64:79], v[32:35], v[20:23], v[64:79]
    ds_read_b128 v[28:31], v129 offset:49152
    ds_read_b64_tr_b16 v[44:45], v13 offset:53248
    ds_read_b64_tr_b16 v[46:47], v13 offset:54272
    v_fmac_f32 v135, v137, v137
    v_lshlrev_b32 v138, 16, v17
    v_and_b32 v139, s47, v17
    v_add_f32 v132, v132, v138
    v_add_f32 v133, v133, v139
    v_mfma_f32_32x32x16_bf16 v[96:111], v[36:39], v[20:23], v[96:111]
    v_fmac_f32 v134, v138, v138
    v_fmac_f32 v135, v139, v139
    v_lshlrev_b32 v136, 16, v18
    v_and_b32 v137, s47, v18
    v_add_f32 v132, v132, v136
    v_add_f32 v133, v133, v137
    v_fmac_f32 v134, v136, v136
    v_mfma_f32_32x32x16_bf16 v[80:95], v[36:39], v[16:19], v[80:95]
    v_fmac_f32 v135, v137, v137
    v_lshlrev_b32 v138, 16, v19
    v_and_b32 v139, s47, v19
    v_add_f32 v132, v132, v138
    v_add_f32 v133, v133, v139
    v_fmac_f32 v134, v138, v138
    v_fmac_f32 v135, v139, v139
    v_mfma_f32_16x16x32_bf16 v[112:115], v[116:119], v[32:35], v[112:115]
    s_waitcnt lgkmcnt(0)
    v_mfma_f32_32x32x16_bf16 v[48:63], v[40:43], v[24:27], v[48:63]
    ds_read_b128 v[16:19], v10 offset:49152
    ds_read_b64_tr_b16 v[32:33], v12 offset:57344
    ds_read_b64_tr_b16 v[34:35], v12 offset:58368
    v_lshlrev_b32 v136, 16, v24
    v_and_b32 v137, s47, v24
    v_add_f32 v132, v132, v136
    v_add_f32 v133, v133, v137
    v_fmac_f32 v134, v136, v136
    v_mfma_f32_32x32x16_bf16 v[64:79], v[40:43], v[28:31], v[64:79]
    ds_read_b128 v[20:23], v130 offset:49152
    ds_read_b64_tr_b16 v[36:37], v13 offset:57344
    ds_read_b64_tr_b16 v[38:39], v13 offset:58368
    v_fmac_f32 v135, v137, v137
    v_lshlrev_b32 v138, 16, v25
    v_and_b32 v139, s47, v25
    v_add_f32 v132, v132, v138
    v_add_f32 v133, v133, v139
    v_mfma_f32_32x32x16_bf16 v[96:111], v[44:47], v[28:31], v[96:111]
    v_fmac_f32 v134, v138, v138
    v_fmac_f32 v135, v139, v139
    v_lshlrev_b32 v136, 16, v26
    v_and_b32 v137, s47, v26
    v_add_f32 v132, v132, v136
    v_add_f32 v133, v133, v137
    v_fmac_f32 v134, v136, v136
    v_mfma_f32_32x32x16_bf16 v[80:95], v[44:47], v[24:27], v[80:95]
    v_fmac_f32 v135, v137, v137
    v_lshlrev_b32 v138, 16, v27
    v_and_b32 v139, s47, v27
    v_add_f32 v132, v132, v138
    v_add_f32 v133, v133, v139
    v_fmac_f32 v134, v138, v138
    v_fmac_f32 v135, v139, v139
    v_mfma_f32_16x16x32_bf16 v[112:115], v[116:119], v[40:43], v[112:115]
    s_waitcnt lgkmcnt(0)
    v_mfma_f32_32x32x16_bf16 v[48:63], v[32:35], v[16:19], v[48:63]
    ds_read_b128 v[24:27], v11 offset:49152
    ds_read_b64_tr_b16 v[40:41], v12 offset:61440
    ds_read_b64_tr_b16 v[42:43], v12 offset:62464
    v_lshlrev_b32 v136, 16, v16
    v_and_b32 v137, s47, v16
    v_add_f32 v132, v132, v136
    v_add_f32 v133, v133, v137
    v_fmac_f32 v134, v136, v136
    v_mfma_f32_32x32x16_bf16 v[64:79], v[32:35], v[20:23], v[64:79]
    ds_read_b128 v[28:31], v131 offset:49152
    ds_read_b64_tr_b16 v[44:45], v13 offset:61440
    ds_read_b64_tr_b16 v[46:47], v13 offset:62464
    v_fmac_f32 v135, v137, v137
    v_lshlrev_b32 v138, 16, v17
    v_and_b32 v139, s47, v17
    v_add_f32 v132, v132, v138
    v_add_f32 v133, v133, v139
    v_mfma_f32_32x32x16_bf16 v[96:111], v[36:39], v[20:23], v[96:111]
    v_fmac_f32 v134, v138, v138
    v_fmac_f32 v135, v139, v139
    v_lshlrev_b32 v136, 16, v18
    v_and_b32 v137, s47, v18
    v_add_f32 v132, v132, v136
    v_add_f32 v133, v133, v137
    v_fmac_f32 v134, v136, v136
    v_mfma_f32_32x32x16_bf16 v[80:95], v[36:39], v[16:19], v[80:95]
    v_fmac_f32 v135, v137, v137
    v_lshlrev_b32 v138, 16, v19
    v_and_b32 v139, s47, v19
    v_add_f32 v132, v132, v138
    v_add_f32 v133, v133, v139
    v_fmac_f32 v134, v138, v138
    v_fmac_f32 v135, v139, v139
    v_mfma_f32_16x16x32_bf16 v[112:115], v[116:119], v[32:35], v[112:115]
    s_waitcnt lgkmcnt(0)
    v_mfma_f32_32x32x16_bf16 v[48:63], v[40:43], v[24:27], v[48:63]
    v_lshlrev_b32 v136, 16, v24
    v_and_b32 v137, s47, v24
    v_add_f32 v132, v132, v136
    v_add_f32 v133, v133, v137
    v_fmac_f32 v134, v136, v136
    v_fmac_f32 v135, v137, v137
    v_lshlrev_b32 v138, 16, v25
    v_and_b32 v139, s47, v25
    v_mfma_f32_32x32x16_bf16 v[64:79], v[40:43], v[28:31], v[64:79]
    s_barrier
    ds_read_b128 v[16:19], v8 offset:0
    ds_read_b64_tr_b16 v[32:33], v12 offset:0
    ds_read_b64_tr_b16 v[34:35], v12 offset:1024
    v_add_f32 v132, v132, v138
    v_add_f32 v133, v133, v139
    v_fmac_f32 v134, v138, v138
    v_fmac_f32 v135, v139, v139
    v_lshlrev_b32 v136, 16, v26
    v_mfma_f32_32x32x16_bf16 v[96:111], v[44:47], v[28:31], v[96:111]
    ds_read_b128 v[20:23], v128 offset:0
    ds_read_b64_tr_b16 v[36:37], v13 offset:0
    ds_read_b64_tr_b16 v[38:39], v13 offset:1024
    v_and_b32 v137, s47, v26
    v_add_f32 v132, v132, v136
    v_add_f32 v133, v133, v137
    v_fmac_f32 v134, v136, v136
    v_mfma_f32_32x32x16_bf16 v[80:95], v[44:47], v[24:27], v[80:95]
    v_fmac_f32 v135, v137, v137
    v_lshlrev_b32 v138, 16, v27
    v_and_b32 v139, s47, v27
    v_add_f32 v132, v132, v138
    v_add_f32 v133, v133, v139
    v_fmac_f32 v134, v138, v138
    v_fmac_f32 v135, v139, v139
    v_mfma_f32_16x16x32_bf16 v[112:115], v[116:119], v[40:43], v[112:115]
    s_waitcnt lgkmcnt(0)
    v_mfma_f32_32x32x16_bf16 v[48:63], v[32:35], v[16:19], v[48:63]
    ds_read_b128 v[24:27], v9 offset:0
    ds_read_b64_tr_b16 v[40:41], v12 offset:4096
    ds_read_b64_tr_b16 v[42:43], v12 offset:5120
    v_lshlrev_b32 v136, 16, v16
    v_and_b32 v137, s47, v16
    v_add_f32 v132, v132, v136
    v_add_f32 v133, v133, v137
    v_fmac_f32 v134, v136, v136
    v_mfma_f32_32x32x16_bf16 v[64:79], v[32:35], v[20:23], v[64:79]
    ds_read_b128 v[28:31], v129 offset:0
    ds_read_b64_tr_b16 v[44:45], v13 offset:4096
    ds_read_b64_tr_b16 v[46:47], v13 offset:5120
    v_fmac_f32 v135, v137, v137
    v_lshlrev_b32 v138, 16, v17
    v_and_b32 v139, s47, v17
    v_add_f32 v132, v132, v138
    v_add_f32 v133, v133, v139
    v_mfma_f32_32x32x16_bf16 v[96:111], v[36:39], v[20:23], v[96:111]
    v_fmac_f32 v134, v138, v138
    v_fmac_f32 v135, v139, v139
    v_lshlrev_b32 v136, 16, v18
    v_and_b32 v137, s47, v18
    v_add_f32 v132, v132, v136
    v_add_f32 v133, v133, v137
    v_fmac_f32 v134, v136, v136
    v_mfma_f32_32x32x16_bf16 v[80:95], v[36:39], v[16:19], v[80:95]
    v_fmac_f32 v135, v137, v137
    v_lshlrev_b32 v138, 16, v19
    v_and_b32 v139, s47, v19
    v_add_f32 v132, v132, v138
    v_add_f32 v133, v133, v139
    v_fmac_f32 v134, v138, v138
    v_fmac_f32 v135, v139, v139
    v_mfma_f32_16x16x32_bf16 v[112:115], v[116:119], v[32:35], v[112:115]
    s_waitcnt lgkmcnt(0)
    v_mfma_f32_32x32x16_bf16 v[48:63], v[40:43], v[24:27], v[48:63]
    ds_read_b128 v[16:19], v10 offset:0
    ds_read_b64_tr_b16 v[32:33], v12 offset:8192
    ds_read_b64_tr_b16 v[34:35], v12 offset:9216
    v_lshlrev_b32 v136, 16, v24
    v_and_b32 v137, s47, v24
    v_add_f32 v132, v132, v136
    v_add_f32 v133, v133, v137
    v_fmac_f32 v134, v136, v136
    v_mfma_f32_32x32x16_bf16 v[64:79], v[40:43], v[28:31], v[64:79]
    ds_read_b128 v[20:23], v130 offset:0
    ds_read_b64_tr_b16 v[36:37], v13 offset:8192
    ds_read_b64_tr_b16 v[38:39], v13 offset:9216
    v_fmac_f32 v135, v137, v137
    v_lshlrev_b32 v138, 16, v25
    v_and_b32 v139, s47, v25
    v_add_f32 v132, v132, v138
    v_add_f32 v133, v133, v139
    v_mfma_f32_32x32x16_bf16 v[96:111], v[44:47], v[28:31], v[96:111]
    v_fmac_f32 v134, v138, v138
    v_fmac_f32 v135, v139, v139
    v_lshlrev_b32 v136, 16, v26
    v_and_b32 v137, s47, v26
    v_add_f32 v132, v132, v136
    v_add_f32 v133, v133, v137
    v_fmac_f32 v134, v136, v136
    v_mfma_f32_32x32x16_bf16 v[80:95], v[44:47], v[24:27], v[80:95]
    v_fmac_f32 v135, v137, v137
    v_lshlrev_b32 v138, 16, v27
    v_and_b32 v139, s47, v27
    v_add_f32 v132, v132, v138
    v_add_f32 v133, v133, v139
    v_fmac_f32 v134, v138, v138
    v_fmac_f32 v135, v139, v139
    v_mfma_f32_16x16x32_bf16 v[112:115], v[116:119], v[40:43], v[112:115]
    s_waitcnt lgkmcnt(0)
    v_mfma_f32_32x32x16_bf16 v[48:63], v[32:35], v[16:19], v[48:63]
    ds_read_b128 v[24:27], v11 offset:0
    ds_read_b64_tr_b16 v[40:41], v12 offset:12288
    ds_read_b64_tr_b16 v[42:43], v12 offset:13312
    v_lshlrev_b32 v136, 16, v16
    v_and_b32 v137, s47, v16
    v_add_f32 v132, v132, v136
    v_add_f32 v133, v133, v137
    v_fmac_f32 v134, v136, v136
    v_mfma_f32_32x32x16_bf16 v[64:79], v[32:35], v[20:23], v[64:79]
    ds_read_b128 v[28:31], v131 offset:0
    ds_read_b64_tr_b16 v[44:45], v13 offset:12288
    ds_read_b64_tr_b16 v[46:47], v13 offset:13312
    v_fmac_f32 v135, v137, v137
    v_lshlrev_b32 v138, 16, v17
    v_and_b32 v139, s47, v17
    v_add_f32 v132, v132, v138
    v_add_f32 v133, v133, v139
    v_mfma_f32_32x32x16_bf16 v[96:111], v[36:39], v[20:23], v[96:111]
    v_fmac_f32 v134, v138, v138
    v_fmac_f32 v135, v139, v139
    v_lshlrev_b32 v136, 16, v18
    v_and_b32 v137, s47, v18
    v_add_f32 v132, v132, v136
    v_add_f32 v133, v133, v137
    v_fmac_f32 v134, v136, v136
    v_mfma_f32_32x32x16_bf16 v[80:95], v[36:39], v[16:19], v[80:95]
    v_fmac_f32 v135, v137, v137
    v_lshlrev_b32 v138, 16, v19
    v_and_b32 v139, s47, v19
    v_add_f32 v132, v132, v138
    v_add_f32 v133, v133, v139
    v_fmac_f32 v134, v138, v138
    v_fmac_f32 v135, v139, v139
    v_mfma_f32_16x16x32_bf16 v[112:115], v[116:119], v[32:35], v[112:115]
    s_waitcnt lgkmcnt(0)
    v_mfma_f32_32x32x16_bf16 v[48:63], v[40:43], v[24:27], v[48:63]
    v_lshlrev_b32 v136, 16, v24
    v_and_b32 v137, s47, v24
    v_add_f32 v132, v132, v136
    v_add_f32 v133, v133, v137
    v_fmac_f32 v134, v136, v136
    v_fmac_f32 v135, v137, v137
    v_lshlrev_b32 v138, 16, v25
    v_and_b32 v139, s47, v25
    v_mfma_f32_32x32x16_bf16 v[64:79], v[40:43], v[28:31], v[64:79]
    s_barrier
    ds_read_b128 v[16:19], v8 offset:16384
    ds_read_b64_tr_b16 v[32:33], v12 offset:16384
    ds_read_b64_tr_b16 v[34:35], v12 offset:17408
    v_add_f32 v132, v132, v138
    v_add_f32 v133, v133, v139
    v_fmac_f32 v134, v138, v138
    v_fmac_f32 v135, v139, v139
    v_lshlrev_b32 v136, 16, v26
    v_mfma_f32_32x32x16_bf16 v[96:111], v[44:47], v[28:31], v[96:111]
    ds_read_b128 v[20:23], v128 offset:16384
    ds_read_b64_tr_b16 v[36:37], v13 offset:16384
    ds_read_b64_tr_b16 v[38:39], v13 offset:17408
    v_and_b32 v137, s47, v26
    v_add_f32 v132, v132, v136
    v_add_f32 v133, v133, v137
    v_fmac_f32 v134, v136, v136
    v_mfma_f32_32x32x16_bf16 v[80:95], v[44:47], v[24:27], v[80:95]
    v_fmac_f32 v135, v137, v137
    v_lshlrev_b32 v138, 16, v27
    v_and_b32 v139, s47, v27
    v_add_f32 v132, v132, v138
    v_add_f32 v133, v133, v139
    v_fmac_f32 v134, v138, v138
    v_fmac_f32 v135, v139, v139
    v_mfma_f32_16x16x32_bf16 v[112:115], v[116:119], v[40:43], v[112:115]
    s_waitcnt lgkmcnt(0)
    v_mfma_f32_32x32x16_bf16 v[48:63], v[32:35], v[16:19], v[48:63]
    ds_read_b128 v[24:27], v9 offset:16384
    ds_read_b64_tr_b16 v[40:41], v12 offset:20480
    ds_read_b64_tr_b16 v[42:43], v12 offset:21504
    v_lshlrev_b32 v136, 16, v16
    v_and_b32 v137, s47, v16
    v_add_f32 v132, v132, v136
    v_add_f32 v133, v133, v137
    v_fmac_f32 v134, v136, v136
    v_mfma_f32_32x32x16_bf16 v[64:79], v[32:35], v[20:23], v[64:79]
    ds_read_b128 v[28:31], v129 offset:16384
    ds_read_b64_tr_b16 v[44:45], v13 offset:20480
    ds_read_b64_tr_b16 v[46:47], v13 offset:21504
    v_fmac_f32 v135, v137, v137
    v_lshlrev_b32 v138, 16, v17
    v_and_b32 v139, s47, v17
    v_add_f32 v132, v132, v138
    v_add_f32 v133, v133, v139
    v_mfma_f32_32x32x16_bf16 v[96:111], v[36:39], v[20:23], v[96:111]
    v_fmac_f32 v134, v138, v138
    v_fmac_f32 v135, v139, v139
    v_lshlrev_b32 v136, 16, v18
    v_and_b32 v137, s47, v18
    v_add_f32 v132, v132, v136
    v_add_f32 v133, v133, v137
    v_fmac_f32 v134, v136, v136
    v_mfma_f32_32x32x16_bf16 v[80:95], v[36:39], v[16:19], v[80:95]
    v_fmac_f32 v135, v137, v137
    v_lshlrev_b32 v138, 16, v19
    v_and_b32 v139, s47, v19
    v_add_f32 v132, v132, v138
    v_add_f32 v133, v133, v139
    v_fmac_f32 v134, v138, v138
    v_fmac_f32 v135, v139, v139
    v_mfma_f32_16x16x32_bf16 v[112:115], v[116:119], v[32:35], v[112:115]
    s_waitcnt lgkmcnt(0)
    v_mfma_f32_32x32x16_bf16 v[48:63], v[40:43], v[24:27], v[48:63]
    ds_read_b128 v[16:19], v10 offset:16384
    ds_read_b64_tr_b16 v[32:33], v12 offset:24576
    ds_read_b64_tr_b16 v[34:35], v12 offset:25600
    v_lshlrev_b32 v136, 16, v24
    v_and_b32 v137, s47, v24
    v_add_f32 v132, v132, v136
    v_add_f32 v133, v133, v137
    v_fmac_f32 v134, v136, v136
    v_mfma_f32_32x32x16_bf16 v[64:79], v[40:43], v[28:31], v[64:79]
    ds_read_b128 v[20:23], v130 offset:16384
    ds_read_b64_tr_b16 v[36:37], v13 offset:24576
    ds_read_b64_tr_b16 v[38:39], v13 offset:25600
    v_fmac_f32 v135, v137, v137
    v_lshlrev_b32 v138, 16, v25
    v_and_b32 v139, s47, v25
    v_add_f32 v132, v132, v138
    v_add_f32 v133, v133, v139
    v_mfma_f32_32x32x16_bf16 v[96:111], v[44:47], v[28:31], v[96:111]
    v_fmac_f32 v134, v138, v138
    v_fmac_f32 v135, v139, v139
    v_lshlrev_b32 v136, 16, v26
    v_and_b32 v137, s47, v26
    v_add_f32 v132, v132, v136
    v_add_f32 v133, v133, v137
    v_fmac_f32 v134, v136, v136
    v_mfma_f32_32x32x16_bf16 v[80:95], v[44:47], v[24:27], v[80:95]
    v_fmac_f32 v135, v137, v137
    v_lshlrev_b32 v138, 16, v27
    v_and_b32 v139, s47, v27
    v_add_f32 v132, v132, v138
    v_add_f32 v133, v133, v139
    v_fmac_f32 v134, v138, v138
    v_fmac_f32 v135, v139, v139
    v_mfma_f32_16x16x32_bf16 v[112:115], v[116:119], v[40:43], v[112:115]
    s_waitcnt lgkmcnt(0)
    v_mfma_f32_32x32x16_bf16 v[48:63], v[32:35], v[16:19], v[48:63]
    ds_read_b128 v[24:27], v11 offset:16384
    ds_read_b64_tr_b16 v[40:41], v12 offset:28672
    ds_read_b64_tr_b16 v[42:43], v12 offset:29696
    v_lshlrev_b32 v136, 16, v16
    v_and_b32 v137, s47, v16
    v_add_f32 v132, v132, v136
    v_add_f32 v133, v133, v137
    v_fmac_f32 v134, v136, v136
    v_mfma_f32_32x32x16_bf16 v[64:79], v[32:35], v[20:23], v[64:79]
    ds_read_b128 v[28:31], v131 offset:16384
    ds_read_b64_tr_b16 v[44:45], v13 offset:28672
    ds_read_b64_tr_b16 v[46:47], v13 offset:29696
    v_fmac_f32 v135, v137, v137
    v_lshlrev_b32 v138, 16, v17
    v_and_b32 v139, s47, v17
    v_add_f32 v132, v132, v138
    v_add_f32 v133, v133, v139
    v_mfma_f32_32x32x16_bf16 v[96:111], v[36:39], v[20:23], v[96:111]
    v_fmac_f32 v134, v138, v138
    v_fmac_f32 v135, v139, v139
    v_lshlrev_b32 v136, 16, v18
    v_and_b32 v137, s47, v18
    v_add_f32 v132, v132, v136
    v_add_f32 v133, v133, v137
    v_fmac_f32 v134, v136, v136
    v_mfma_f32_32x32x16_bf16 v[80:95], v[36:39], v[16:19], v[80:95]
    v_fmac_f32 v135, v137, v137
    v_lshlrev_b32 v138, 16, v19
    v_and_b32 v139, s47, v19
    v_add_f32 v132, v132, v138
    v_add_f32 v133, v133, v139
    v_fmac_f32 v134, v138, v138
    v_fmac_f32 v135, v139, v139
    v_mfma_f32_16x16x32_bf16 v[112:115], v[116:119], v[32:35], v[112:115]
    s_waitcnt lgkmcnt(0)
    v_mfma_f32_32x32x16_bf16 v[48:63], v[40:43], v[24:27], v[48:63]
    v_lshlrev_b32 v136, 16, v24
    v_and_b32 v137, s47, v24
    v_add_f32 v132, v132, v136
    v_add_f32 v133, v133, v137
    v_fmac_f32 v134, v136, v136
    v_fmac_f32 v135, v137, v137
    v_lshlrev_b32 v138, 16, v25
    v_and_b32 v139, s47, v25
    v_mfma_f32_32x32x16_bf16 v[64:79], v[40:43], v[28:31], v[64:79]
    s_barrier
    ds_read_b128 v[16:19], v8 offset:32768
    ds_read_b64_tr_b16 v[32:33], v12 offset:32768
    ds_read_b64_tr_b16 v[34:35], v12 offset:33792
    v_add_f32 v132, v132, v138
    v_add_f32 v133, v133, v139
    v_fmac_f32 v134, v138, v138
    v_fmac_f32 v135, v139, v139
    v_lshlrev_b32 v136, 16, v26
    v_mfma_f32_32x32x16_bf16 v[96:111], v[44:47], v[28:31], v[96:111]
    ds_read_b128 v[20:23], v128 offset:32768
    ds_read_b64_tr_b16 v[36:37], v13 offset:32768
    ds_read_b64_tr_b16 v[38:39], v13 offset:33792
    v_and_b32 v137, s47, v26
    v_add_f32 v132, v132, v136
    v_add_f32 v133, v133, v137
    v_fmac_f32 v134, v136, v136
    v_mfma_f32_32x32x16_bf16 v[80:95], v[44:47], v[24:27], v[80:95]
    v_fmac_f32 v135, v137, v137
    v_lshlrev_b32 v138, 16, v27
    v_and_b32 v139, s47, v27
    v_add_f32 v132, v132, v138
    v_add_f32 v133, v133, v139
    v_fmac_f32 v134, v138, v138
    v_fmac_f32 v135, v139, v139
    v_mfma_f32_16x16x32_bf16 v[112:115], v[116:119], v[40:43], v[112:115]
    s_waitcnt lgkmcnt(0)
    v_mfma_f32_32x32x16_bf16 v[48:63], v[32:35], v[16:19], v[48:63]
    ds_read_b128 v[24:27], v9 offset:32768
    ds_read_b64_tr_b16 v[40:41], v12 offset:36864
    ds_read_b64_tr_b16 v[42:43], v12 offset:37888
    v_lshlrev_b32 v136, 16, v16
    v_and_b32 v137, s47, v16
    v_add_f32 v132, v132, v136
    v_add_f32 v133, v133, v137
    v_fmac_f32 v134, v136, v136
    v_mfma_f32_32x32x16_bf16 v[64:79], v[32:35], v[20:23], v[64:79]
    ds_read_b128 v[28:31], v129 offset:32768
    ds_read_b64_tr_b16 v[44:45], v13 offset:36864
    ds_read_b64_tr_b16 v[46:47], v13 offset:37888
    v_fmac_f32 v135, v137, v137
    v_lshlrev_b32 v138, 16, v17
    v_and_b32 v139, s47, v17
    v_add_f32 v132, v132, v138
    v_add_f32 v133, v133, v139
    v_mfma_f32_32x32x16_bf16 v[96:111], v[36:39], v[20:23], v[96:111]
    v_fmac_f32 v134, v138, v138
    v_fmac_f32 v135, v139, v139
    v_lshlrev_b32 v136, 16, v18
    v_and_b32 v137, s47, v18
    v_add_f32 v132, v132, v136
    v_add_f32 v133, v133, v137
    v_fmac_f32 v134, v136, v136
    v_mfma_f32_32x32x16_bf16 v[80:95], v[36:39], v[16:19], v[80:95]
    v_fmac_f32 v135, v137, v137
    v_lshlrev_b32 v138, 16, v19
    v_and_b32 v139, s47, v19
    v_add_f32 v132, v132, v138
    v_add_f32 v133, v133, v139
    v_fmac_f32 v134, v138, v138
    v_fmac_f32 v135, v139, v139
    v_mfma_f32_16x16x32_bf16 v[112:115], v[116:119], v[32:35], v[112:115]
    s_waitcnt lgkmcnt(0)
    v_mfma_f32_32x32x16_bf16 v[48:63], v[40:43], v[24:27], v[48:63]
    ds_read_b128 v[16:19], v10 offset:32768
    ds_read_b64_tr_b16 v[32:33], v12 offset:40960
    ds_read_b64_tr_b16 v[34:35], v12 offset:41984
    v_lshlrev_b32 v136, 16, v24
    v_and_b32 v137, s47, v24
    v_add_f32 v132, v132, v136
    v_add_f32 v133, v133, v137
    v_fmac_f32 v134, v136, v136
    v_mfma_f32_32x32x16_bf16 v[64:79], v[40:43], v[28:31], v[64:79]
    ds_read_b128 v[20:23], v130 offset:32768
    ds_read_b64_tr_b16 v[36:37], v13 offset:40960
    ds_read_b64_tr_b16 v[38:39], v13 offset:41984
    v_fmac_f32 v135, v137, v137
    v_lshlrev_b32 v138, 16, v25
    v_and_b32 v139, s47, v25
    v_add_f32 v132, v132, v138
    v_add_f32 v133, v133, v139
    v_mfma_f32_32x32x16_bf16 v[96:111], v[44:47], v[28:31], v[96:111]
    v_fmac_f32 v134, v138, v138
    v_fmac_f32 v135, v139, v139
    v_lshlrev_b32 v136, 16, v26
    v_and_b32 v137, s47, v26
    v_add_f32 v132, v132, v136
    v_add_f32 v133, v133, v137
    v_fmac_f32 v134, v136, v136
    v_mfma_f32_32x32x16_bf16 v[80:95], v[44:47], v[24:27], v[80:95]
    v_fmac_f32 v135, v137, v137
    v_lshlrev_b32 v138, 16, v27
    v_and_b32 v139, s47, v27
    v_add_f32 v132, v132, v138
    v_add_f32 v133, v133, v139
    v_fmac_f32 v134, v138, v138
    v_fmac_f32 v135, v139, v139
    v_mfma_f32_16x16x32_bf16 v[112:115], v[116:119], v[40:43], v[112:115]
    s_waitcnt lgkmcnt(0)
    v_mfma_f32_32x32x16_bf16 v[48:63], v[32:35], v[16:19], v[48:63]
    ds_read_b128 v[24:27], v11 offset:32768
    ds_read_b64_tr_b16 v[40:41], v12 offset:45056
    ds_read_b64_tr_b16 v[42:43], v12 offset:46080
    v_lshlrev_b32 v136, 16, v16
    v_and_b32 v137, s47, v16
    v_add_f32 v132, v132, v136
    v_add_f32 v133, v133, v137
    v_fmac_f32 v134, v136, v136
    v_mfma_f32_32x32x16_bf16 v[64:79], v[32:35], v[20:23], v[64:79]
    ds_read_b128 v[28:31], v131 offset:32768
    ds_read_b64_tr_b16 v[44:45], v13 offset:45056
    ds_read_b64_tr_b16 v[46:47], v13 offset:46080
    v_fmac_f32 v135, v137, v137
    v_lshlrev_b32 v138, 16, v17
    v_and_b32 v139, s47, v17
    v_add_f32 v132, v132, v138
    v_add_f32 v133, v133, v139
    v_mfma_f32_32x32x16_bf16 v[96:111], v[36:39], v[20:23], v[96:111]
    v_fmac_f32 v134, v138, v138
    v_fmac_f32 v135, v139, v139
    v_lshlrev_b32 v136, 16, v18
    v_and_b32 v137, s47, v18
    v_add_f32 v132, v132, v136
    v_add_f32 v133, v133, v137
    v_fmac_f32 v134, v136, v136
    v_mfma_f32_32x32x16_bf16 v[80:95], v[36:39], v[16:19], v[80:95]
    v_fmac_f32 v135, v137, v137
    v_lshlrev_b32 v138, 16, v19
    v_and_b32 v139, s47, v19
    v_add_f32 v132, v132, v138
    v_add_f32 v133, v133, v139
    v_fmac_f32 v134, v138, v138
    v_fmac_f32 v135, v139, v139
    v_mfma_f32_16x16x32_bf16 v[112:115], v[116:119], v[32:35], v[112:115]
    s_waitcnt lgkmcnt(0)
    v_mfma_f32_32x32x16_bf16 v[48:63], v[40:43], v[24:27], v[48:63]
    v_lshlrev_b32 v136, 16, v24
    v_and_b32 v137, s47, v24
    v_add_f32 v132, v132, v136
    v_add_f32 v133, v133, v137
    v_fmac_f32 v134, v136, v136
    v_fmac_f32 v135, v137, v137
    v_lshlrev_b32 v138, 16, v25
    v_and_b32 v139, s47, v25
    v_mfma_f32_32x32x16_bf16 v[64:79], v[40:43], v[28:31], v[64:79]
    s_barrier
    ds_read_b128 v[16:19], v8 offset:49152
    ds_read_b64_tr_b16 v[32:33], v12 offset:49152
    ds_read_b64_tr_b16 v[34:35], v12 offset:50176
    v_add_f32 v132, v132, v138
    v_add_f32 v133, v133, v139
    v_fmac_f32 v134, v138, v138
    v_fmac_f32 v135, v139, v139
    v_lshlrev_b32 v136, 16, v26
    v_mfma_f32_32x32x16_bf16 v[96:111], v[44:47], v[28:31], v[96:111]
    ds_read_b128 v[20:23], v128 offset:49152
    ds_read_b64_tr_b16 v[36:37], v13 offset:49152
    ds_read_b64_tr_b16 v[38:39], v13 offset:50176
    v_and_b32 v137, s47, v26
    v_add_f32 v132, v132, v136
    v_add_f32 v133, v133, v137
    v_fmac_f32 v134, v136, v136
    v_mfma_f32_32x32x16_bf16 v[80:95], v[44:47], v[24:27], v[80:95]
    v_fmac_f32 v135, v137, v137
    v_lshlrev_b32 v138, 16, v27
    v_and_b32 v139, s47, v27
    v_add_f32 v132, v132, v138
    v_add_f32 v133, v133, v139
    v_fmac_f32 v134, v138, v138
    v_fmac_f32 v135, v139, v139
    v_mfma_f32_16x16x32_bf16 v[112:115], v[116:119], v[40:43], v[112:115]
    s_waitcnt lgkmcnt(0)
    v_mfma_f32_32x32x16_bf16 v[48:63], v[32:35], v[16:19], v[48:63]
    ds_read_b128 v[24:27], v9 offset:49152
    ds_read_b64_tr_b16 v[40:41], v12 offset:53248
    ds_read_b64_tr_b16 v[42:43], v12 offset:54272
    v_lshlrev_b32 v136, 16, v16
    v_and_b32 v137, s47, v16
    v_add_f32 v132, v132, v136
    v_add_f32 v133, v133, v137
    v_fmac_f32 v134, v136, v136
    v_mfma_f32_32x32x16_bf16 v[64:79], v[32:35], v[20:23], v[64:79]
    ds_read_b128 v[28:31], v129 offset:49152
    ds_read_b64_tr_b16 v[44:45], v13 offset:53248
    ds_read_b64_tr_b16 v[46:47], v13 offset:54272
    v_fmac_f32 v135, v137, v137
    v_lshlrev_b32 v138, 16, v17
    v_and_b32 v139, s47, v17
    v_add_f32 v132, v132, v138
    v_add_f32 v133, v133, v139
    v_mfma_f32_32x32x16_bf16 v[96:111], v[36:39], v[20:23], v[96:111]
    v_fmac_f32 v134, v138, v138
    v_fmac_f32 v135, v139, v139
    v_lshlrev_b32 v136, 16, v18
    v_and_b32 v137, s47, v18
    v_add_f32 v132, v132, v136
    v_add_f32 v133, v133, v137
    v_fmac_f32 v134, v136, v136
    v_mfma_f32_32x32x16_bf16 v[80:95], v[36:39], v[16:19], v[80:95]
    v_fmac_f32 v135, v137, v137
    v_lshlrev_b32 v138, 16, v19
    v_and_b32 v139, s47, v19
    v_add_f32 v132, v132, v138
    v_add_f32 v133, v133, v139
    v_fmac_f32 v134, v138, v138
    v_fmac_f32 v135, v139, v139
    v_mfma_f32_16x16x32_bf16 v[112:115], v[116:119], v[32:35], v[112:115]
    s_waitcnt lgkmcnt(0)
    v_mfma_f32_32x32x16_bf16 v[48:63], v[40:43], v[24:27], v[48:63]
    ds_read_b128 v[16:19], v10 offset:49152
    ds_read_b64_tr_b16 v[32:33], v12 offset:57344
    ds_read_b64_tr_b16 v[34:35], v12 offset:58368
    v_lshlrev_b32 v136, 16, v24
    v_and_b32 v137, s47, v24
    v_add_f32 v132, v132, v136
    v_add_f32 v133, v133, v137
    v_fmac_f32 v134, v136, v136
    v_mfma_f32_32x32x16_bf16 v[64:79], v[40:43], v[28:31], v[64:79]
    ds_read_b128 v[20:23], v130 offset:49152
    ds_read_b64_tr_b16 v[36:37], v13 offset:57344
    ds_read_b64_tr_b16 v[38:39], v13 offset:58368
    v_fmac_f32 v135, v137, v137
    v_lshlrev_b32 v138, 16, v25
    v_and_b32 v139, s47, v25
    v_add_f32 v132, v132, v138
    v_add_f32 v133, v133, v139
    v_mfma_f32_32x32x16_bf16 v[96:111], v[44:47], v[28:31], v[96:111]
    v_fmac_f32 v134, v138, v138
    v_fmac_f32 v135, v139, v139
    v_lshlrev_b32 v136, 16, v26
    v_and_b32 v137, s47, v26
    v_add_f32 v132, v132, v136
    v_add_f32 v133, v133, v137
    v_fmac_f32 v134, v136, v136
    v_mfma_f32_32x32x16_bf16 v[80:95], v[44:47], v[24:27], v[80:95]
    v_fmac_f32 v135, v137, v137
    v_lshlrev_b32 v138, 16, v27
    v_and_b32 v139, s47, v27
    v_add_f32 v132, v132, v138
    v_add_f32 v133, v133, v139
    v_fmac_f32 v134, v138, v138
    v_fmac_f32 v135, v139, v139
    v_mfma_f32_16x16x32_bf16 v[112:115], v[116:119], v[40:43], v[112:115]
    s_waitcnt lgkmcnt(0)
    v_mfma_f32_32x32x16_bf16 v[48:63], v[32:35], v[16:19], v[48:63]
    ds_read_b128 v[24:27], v11 offset:49152
    ds_read_b64_tr_b16 v[40:41], v12 offset:61440
    ds_read_b64_tr_b16 v[42:43], v12 offset:62464
    v_lshlrev_b32 v136, 16, v16
    v_and_b32 v137, s47, v16
    v_add_f32 v132, v132, v136
    v_add_f32 v133, v133, v137
    v_fmac_f32 v134, v136, v136
    v_mfma_f32_32x32x16_bf16 v[64:79], v[32:35], v[20:23], v[64:79]
    ds_read_b128 v[28:31], v131 offset:49152
    ds_read_b64_tr_b16 v[44:45], v13 offset:61440
    ds_read_b64_tr_b16 v[46:47], v13 offset:62464
    v_fmac_f32 v135, v137, v137
    v_lshlrev_b32 v138, 16, v17
    v_and_b32 v139, s47, v17
    v_add_f32 v132, v132, v138
    v_add_f32 v133, v133, v139
    v_mfma_f32_32x32x16_bf16 v[96:111], v[36:39], v[20:23], v[96:111]
    v_fmac_f32 v134, v138, v138
    v_fmac_f32 v135, v139, v139
    v_lshlrev_b32 v136, 16, v18
    v_and_b32 v137, s47, v18
    v_add_f32 v132, v132, v136
    v_add_f32 v133, v133, v137
    v_fmac_f32 v134, v136, v136
    v_mfma_f32_32x32x16_bf16 v[80:95], v[36:39], v[16:19], v[80:95]
    v_fmac_f32 v135, v137, v137
    v_lshlrev_b32 v138, 16, v19
    v_and_b32 v139, s47, v19
    v_add_f32 v132, v132, v138
    v_add_f32 v133, v133, v139
    v_fmac_f32 v134, v138, v138
    v_fmac_f32 v135, v139, v139
    v_mfma_f32_16x16x32_bf16 v[112:115], v[116:119], v[32:35], v[112:115]
    s_waitcnt lgkmcnt(0)
    v_mfma_f32_32x32x16_bf16 v[48:63], v[40:43], v[24:27], v[48:63]
    v_lshlrev_b32 v136, 16, v24
    v_and_b32 v137, s47, v24
    v_add_f32 v132, v132, v136
    v_add_f32 v133, v133, v137
    v_fmac_f32 v134, v136, v136
    v_fmac_f32 v135, v137, v137
    v_lshlrev_b32 v138, 16, v25
    v_and_b32 v139, s47, v25
    v_mfma_f32_32x32x16_bf16 v[64:79], v[40:43], v[28:31], v[64:79]
    s_barrier
    ds_read_b128 v[16:19], v8 offset:0
    ds_read_b64_tr_b16 v[32:33], v12 offset:0
    ds_read_b64_tr_b16 v[34:35], v12 offset:1024
    v_add_f32 v132, v132, v138
    v_add_f32 v133, v133, v139
    v_fmac_f32 v134, v138, v138
    v_fmac_f32 v135, v139, v139
    v_lshlrev_b32 v136, 16, v26
    v_mfma_f32_32x32x16_bf16 v[96:111], v[44:47], v[28:31], v[96:111]
    ds_read_b128 v[20:23], v128 offset:0
    ds_read_b64_tr_b16 v[36:37], v13 offset:0
    ds_read_b64_tr_b16 v[38:39], v13 offset:1024
    v_and_b32 v137, s47, v26
    v_add_f32 v132, v132, v136
    v_add_f32 v133, v133, v137
    v_fmac_f32 v134, v136, v136
    v_mfma_f32_32x32x16_bf16 v[80:95], v[44:47], v[24:27], v[80:95]
    v_fmac_f32 v135, v137, v137
    v_lshlrev_b32 v138, 16, v27
    v_and_b32 v139, s47, v27
    v_add_f32 v132, v132, v138
    v_add_f32 v133, v133, v139
    v_fmac_f32 v134, v138, v138
    v_fmac_f32 v135, v139, v139
    v_mfma_f32_16x16x32_bf16 v[112:115], v[116:119], v[40:43], v[112:115]
    s_waitcnt lgkmcnt(0)
    v_mfma_f32_32x32x16_bf16 v[48:63], v[32:35], v[16:19], v[48:63]
    ds_read_b128 v[24:27], v9 offset:0
    ds_read_b64_tr_b16 v[40:41], v12 offset:4096
    ds_read_b64_tr_b16 v[42:43], v12 offset:5120
    v_lshlrev_b32 v136, 16, v16
    v_and_b32 v137, s47, v16
    v_add_f32 v132, v132, v136
    v_add_f32 v133, v133, v137
    v_fmac_f32 v134, v136, v136
    v_mfma_f32_32x32x16_bf16 v[64:79], v[32:35], v[20:23], v[64:79]
    ds_read_b128 v[28:31], v129 offset:0
    ds_read_b64_tr_b16 v[44:45], v13 offset:4096
    ds_read_b64_tr_b16 v[46:47], v13 offset:5120
    v_fmac_f32 v135, v137, v137
    v_lshlrev_b32 v138, 16, v17
    v_and_b32 v139, s47, v17
    v_add_f32 v132, v132, v138
    v_add_f32 v133, v133, v139
    v_mfma_f32_32x32x16_bf16 v[96:111], v[36:39], v[20:23], v[96:111]
    v_fmac_f32 v134, v138, v138
    v_fmac_f32 v135, v139, v139
    v_lshlrev_b32 v136, 16, v18
    v_and_b32 v137, s47, v18
    v_add_f32 v132, v132, v136
    v_add_f32 v133, v133, v137
    v_fmac_f32 v134, v136, v136
    v_mfma_f32_32x32x16_bf16 v[80:95], v[36:39], v[16:19], v[80:95]
    v_fmac_f32 v135, v137, v137
    v_lshlrev_b32 v138, 16, v19
    v_and_b32 v139, s47, v19
    v_add_f32 v132, v132, v138
    v_add_f32 v133, v133, v139
    v_fmac_f32 v134, v138, v138
    v_fmac_f32 v135, v139, v139
    v_mfma_f32_16x16x32_bf16 v[112:115], v[116:119], v[32:35], v[112:115]
    s_waitcnt lgkmcnt(0)
    v_mfma_f32_32x32x16_bf16 v[48:63], v[40:43], v[24:27], v[48:63]
    ds_read_b128 v[16:19], v10 offset:0
    ds_read_b64_tr_b16 v[32:33], v12 offset:8192
    ds_read_b64_tr_b16 v[34:35], v12 offset:9216
    v_lshlrev_b32 v136, 16, v24
    v_and_b32 v137, s47, v24
    v_add_f32 v132, v132, v136
    v_add_f32 v133, v133, v137
    v_fmac_f32 v134, v136, v136
    v_mfma_f32_32x32x16_bf16 v[64:79], v[40:43], v[28:31], v[64:79]
    ds_read_b128 v[20:23], v130 offset:0
    ds_read_b64_tr_b16 v[36:37], v13 offset:8192
    ds_read_b64_tr_b16 v[38:39], v13 offset:9216
    v_fmac_f32 v135, v137, v137
    v_lshlrev_b32 v138, 16, v25
    v_and_b32 v139, s47, v25
    v_add_f32 v132, v132, v138
    v_add_f32 v133, v133, v139
    v_mfma_f32_32x32x16_bf16 v[96:111], v[44:47], v[28:31], v[96:111]
    v_fmac_f32 v134, v138, v138
    v_fmac_f32 v135, v139, v139
    v_lshlrev_b32 v136, 16, v26
    v_and_b32 v137, s47, v26
    v_add_f32 v132, v132, v136
    v_add_f32 v133, v133, v137
    v_fmac_f32 v134, v136, v136
    v_mfma_f32_32x32x16_bf16 v[80:95], v[44:47], v[24:27], v[80:95]
    v_fmac_f32 v135, v137, v137
    v_lshlrev_b32 v138, 16, v27
    v_and_b32 v139, s47, v27
    v_add_f32 v132, v132, v138
    v_add_f32 v133, v133, v139
    v_fmac_f32 v134, v138, v138
    v_fmac_f32 v135, v139, v139
    v_mfma_f32_16x16x32_bf16 v[112:115], v[116:119], v[40:43], v[112:115]
    s_waitcnt lgkmcnt(0)
    v_mfma_f32_32x32x16_bf16 v[48:63], v[32:35], v[16:19], v[48:63]
    ds_read_b128 v[24:27], v11 offset:0
    ds_read_b64_tr_b16 v[40:41], v12 offset:12288
    ds_read_b64_tr_b16 v[42:43], v12 offset:13312
    v_lshlrev_b32 v136, 16, v16
    v_and_b32 v137, s47, v16
    v_add_f32 v132, v132, v136
    v_add_f32 v133, v133, v137
    v_fmac_f32 v134, v136, v136
    v_mfma_f32_32x32x16_bf16 v[64:79], v[32:35], v[20:23], v[64:79]
    ds_read_b128 v[28:31], v131 offset:0
    ds_read_b64_tr_b16 v[44:45], v13 offset:12288
    ds_read_b64_tr_b16 v[46:47], v13 offset:13312
    v_fmac_f32 v135, v137, v137
    v_lshlrev_b32 v138, 16, v17
    v_and_b32 v139, s47, v17
    v_add_f32 v132, v132, v138
    v_add_f32 v133, v133, v139
    v_mfma_f32_32x32x16_bf16 v[96:111], v[36:39], v[20:23], v[96:111]
    v_fmac_f32 v134, v138, v138
    v_fmac_f32 v135, v139, v139
    v_lshlrev_b32 v136, 16, v18
    v_and_b32 v137, s47, v18
    v_add_f32 v132, v132, v136
    v_add_f32 v133, v133, v137
    v_fmac_f32 v134, v136, v136
    v_mfma_f32_32x32x16_bf16 v[80:95], v[36:39], v[16:19], v[80:95]
    v_fmac_f32 v135, v137, v137
    v_lshlrev_b32 v138, 16, v19
    v_and_b32 v139, s47, v19
    v_add_f32 v132, v132, v138
    v_add_f32 v133, v133, v139
    v_fmac_f32 v134, v138, v138
    v_fmac_f32 v135, v139, v139
    v_mfma_f32_16x16x32_bf16 v[112:115], v[116:119], v[32:35], v[112:115]
    s_waitcnt lgkmcnt(0)
    v_mfma_f32_32x32x16_bf16 v[48:63], v[40:43], v[24:27], v[48:63]
    v_lshlrev_b32 v136, 16, v24
    v_and_b32 v137, s47, v24
    v_add_f32 v132, v132, v136
    v_add_f32 v133, v133, v137
    v_fmac_f32 v134, v136, v136
    v_fmac_f32 v135, v137, v137
    v_lshlrev_b32 v138, 16, v25
    v_and_b32 v139, s47, v25
    v_mfma_f32_32x32x16_bf16 v[64:79], v[40:43], v[28:31], v[64:79]
    s_barrier
    ds_read_b128 v[16:19], v8 offset:16384
    ds_read_b64_tr_b16 v[32:33], v12 offset:16384
    ds_read_b64_tr_b16 v[34:35], v12 offset:17408
    v_add_f32 v132, v132, v138
    v_add_f32 v133, v133, v139
    v_fmac_f32 v134, v138, v138
    v_fmac_f32 v135, v139, v139
    v_lshlrev_b32 v136, 16, v26
    v_mfma_f32_32x32x16_bf16 v[96:111], v[44:47], v[28:31], v[96:111]
    ds_read_b128 v[20:23], v128 offset:16384
    ds_read_b64_tr_b16 v[36:37], v13 offset:16384
    ds_read_b64_tr_b16 v[38:39], v13 offset:17408
    v_and_b32 v137, s47, v26
    v_add_f32 v132, v132, v136
    v_add_f32 v133, v133, v137
    v_fmac_f32 v134, v136, v136
    v_mfma_f32_32x32x16_bf16 v[80:95], v[44:47], v[24:27], v[80:95]
    v_fmac_f32 v135, v137, v137
    v_lshlrev_b32 v138, 16, v27
    v_and_b32 v139, s47, v27
    v_add_f32 v132, v132, v138
    v_add_f32 v133, v133, v139
    v_fmac_f32 v134, v138, v138
    v_fmac_f32 v135, v139, v139
    v_mfma_f32_16x16x32_bf16 v[112:115], v[116:119], v[40:43], v[112:115]
    s_waitcnt lgkmcnt(0)
    v_mfma_f32_32x32x16_bf16 v[48:63], v[32:35], v[16:19], v[48:63]
    ds_read_b128 v[24:27], v9 offset:16384
    ds_read_b64_tr_b16 v[40:41], v12 offset:20480
    ds_read_b64_tr_b16 v[42:43], v12 offset:21504
    v_lshlrev_b32 v136, 16, v16
    v_and_b32 v137, s47, v16
    v_add_f32 v132, v132, v136
    v_add_f32 v133, v133, v137
    v_fmac_f32 v134, v136, v136
    v_mfma_f32_32x32x16_bf16 v[64:79], v[32:35], v[20:23], v[64:79]
    ds_read_b128 v[28:31], v129 offset:16384
    ds_read_b64_tr_b16 v[44:45], v13 offset:20480
    ds_read_b64_tr_b16 v[46:47], v13 offset:21504
    v_fmac_f32 v135, v137, v137
    v_lshlrev_b32 v138, 16, v17
    v_and_b32 v139, s47, v17
    v_add_f32 v132, v132, v138
    v_add_f32 v133, v133, v139
    v_mfma_f32_32x32x16_bf16 v[96:111], v[36:39], v[20:23], v[96:111]
    v_fmac_f32 v134, v138, v138
    v_fmac_f32 v135, v139, v139
    v_lshlrev_b32 v136, 16, v18
    v_and_b32 v137, s47, v18
    v_add_f32 v132, v132, v136
    v_add_f32 v133, v133, v137
    v_fmac_f32 v134, v136, v136
    v_mfma_f32_32x32x16_bf16 v[80:95], v[36:39], v[16:19], v[80:95]
    v_fmac_f32 v135, v137, v137
    v_lshlrev_b32 v138, 16, v19
    v_and_b32 v139, s47, v19
    v_add_f32 v132, v132, v138
    v_add_f32 v133, v133, v139
    v_fmac_f32 v134, v138, v138
    v_fmac_f32 v135, v139, v139
    v_mfma_f32_16x16x32_bf16 v[112:115], v[116:119], v[32:35], v[112:115]
    s_waitcnt lgkmcnt(0)
    v_mfma_f32_32x32x16_bf16 v[48:63], v[40:43], v[24:27], v[48:63]
    ds_read_b128 v[16:19], v10 offset:16384
    ds_read_b64_tr_b16 v[32:33], v12 offset:24576
    ds_read_b64_tr_b16 v[34:35], v12 offset:25600
    v_lshlrev_b32 v136, 16, v24
    v_and_b32 v137, s47, v24
    v_add_f32 v132, v132, v136
    v_add_f32 v133, v133, v137
    v_fmac_f32 v134, v136, v136
    v_mfma_f32_32x32x16_bf16 v[64:79], v[40:43], v[28:31], v[64:79]
    ds_read_b128 v[20:23], v130 offset:16384
    ds_read_b64_tr_b16 v[36:37], v13 offset:24576
    ds_read_b64_tr_b16 v[38:39], v13 offset:25600
    v_fmac_f32 v135, v137, v137
    v_lshlrev_b32 v138, 16, v25
    v_and_b32 v139, s47, v25
    v_add_f32 v132, v132, v138
    v_add_f32 v133, v133, v139
    v_mfma_f32_32x32x16_bf16 v[96:111], v[44:47], v[28:31], v[96:111]
    v_fmac_f32 v134, v138, v138
    v_fmac_f32 v135, v139, v139
    v_lshlrev_b32 v136, 16, v26
    v_and_b32 v137, s47, v26
    v_add_f32 v132, v132, v136
    v_add_f32 v133, v133, v137
    v_fmac_f32 v134, v136, v136
    v_mfma_f32_32x32x16_bf16 v[80:95], v[44:47], v[24:27], v[80:95]
    v_fmac_f32 v135, v137, v137
    v_lshlrev_b32 v138, 16, v27
    v_and_b32 v139, s47, v27
    v_add_f32 v132, v132, v138
    v_add_f32 v133, v133, v139
    v_fmac_f32 v134, v138, v138
    v_fmac_f32 v135, v139, v139
    v_mfma_f32_16x16x32_bf16 v[112:115], v[116:119], v[40:43], v[112:115]
    s_waitcnt lgkmcnt(0)
    v_mfma_f32_32x32x16_bf16 v[48:63], v[32:35], v[16:19], v[48:63]
    ds_read_b128 v[24:27], v11 offset:16384
    ds_read_b64_tr_b16 v[40:41], v12 offset:28672
    ds_read_b64_tr_b16 v[42:43], v12 offset:29696
    v_lshlrev_b32 v136, 16, v16
    v_and_b32 v137, s47, v16
    v_add_f32 v132, v132, v136
    v_add_f32 v133, v133, v137
    v_fmac_f32 v134, v136, v136
    v_mfma_f32_32x32x16_bf16 v[64:79], v[32:35], v[20:23], v[64:79]
    ds_read_b128 v[28:31], v131 offset:16384
    ds_read_b64_tr_b16 v[44:45], v13 offset:28672
    ds_read_b64_tr_b16 v[46:47], v13 offset:29696
    v_fmac_f32 v135, v137, v137
    v_lshlrev_b32 v138, 16, v17
    v_and_b32 v139, s47, v17
    v_add_f32 v132, v132, v138
    v_add_f32 v133, v133, v139
    v_mfma_f32_32x32x16_bf16 v[96:111], v[36:39], v[20:23], v[96:111]
    v_fmac_f32 v134, v138, v138
    v_fmac_f32 v135, v139, v139
    v_lshlrev_b32 v136, 16, v18
    v_and_b32 v137, s47, v18
    v_add_f32 v132, v132, v136
    v_add_f32 v133, v133, v137
    v_fmac_f32 v134, v136, v136
    v_mfma_f32_32x32x16_bf16 v[80:95], v[36:39], v[16:19], v[80:95]
    v_fmac_f32 v135, v137, v137
    v_lshlrev_b32 v138, 16, v19
    v_and_b32 v139, s47, v19
    v_add_f32 v132, v132, v138
    v_add_f32 v133, v133, v139
    v_fmac_f32 v134, v138, v138
    v_fmac_f32 v135, v139, v139
    v_mfma_f32_16x16x32_bf16 v[112:115], v[116:119], v[32:35], v[112:115]
    s_waitcnt lgkmcnt(0)
    v_mfma_f32_32x32x16_bf16 v[48:63], v[40:43], v[24:27], v[48:63]
    v_lshlrev_b32 v136, 16, v24
    v_and_b32 v137, s47, v24
    v_add_f32 v132, v132, v136
    v_add_f32 v133, v133, v137
    v_fmac_f32 v134, v136, v136
    v_fmac_f32 v135, v137, v137
    v_mfma_f32_32x32x16_bf16 v[64:79], v[40:43], v[28:31], v[64:79]
    s_barrier
    v_lshlrev_b32 v138, 16, v25
    v_and_b32 v139, s47, v25
    v_add_f32 v132, v132, v138
    v_add_f32 v133, v133, v139
    v_fmac_f32 v134, v138, v138
    v_fmac_f32 v135, v139, v139
    v_mfma_f32_32x32x16_bf16 v[96:111], v[44:47], v[28:31], v[96:111]
    v_lshlrev_b32 v136, 16, v26
    v_and_b32 v137, s47, v26
    v_add_f32 v132, v132, v136
    v_add_f32 v133, v133, v137
    v_fmac_f32 v134, v136, v136
    v_fmac_f32 v135, v137, v137
    v_mfma_f32_32x32x16_bf16 v[80:95], v[44:47], v[24:27], v[80:95]
    v_lshlrev_b32 v138, 16, v27
    v_and_b32 v139, s47, v27
    v_add_f32 v132, v132, v138
    v_add_f32 v133, v133, v139
    v_fmac_f32 v134, v138, v138
    v_fmac_f32 v135, v139, v139
    v_mfma_f32_16x16x32_bf16 v[112:115], v[116:119], v[40:43], v[112:115]
    s_lshl_b32 s46, s32, 1
    s_add_u32 s46, s46, s33
    s_lshl_b32 s46, s46, 7
    s_add_u32 s48, s46, 131584
    v_lshlrev_b32 v1, 2, v2
    v_add_u32 v1, s48, v1
    v_add_f32 v132, v132, v133
    v_add_f32 v134, v134, v135
    v_mov_b32 v136, v132
    s_nop 1
    v_permlane32_swap_b32 v132, v136
    v_add_f32 v132, v132, v136
    v_mov_b32 v137, v134
    s_nop 1
    v_permlane32_swap_b32 v134, v137
    v_add_f32 v134, v134, v137
    v_mul_f32 v132, 0x3acccccd, v132
    v_mul_f32 v134, 0x3acccccd, v134
    v_fma_f32 v134, -v132, v132, v134
    v_max_f32 v134, 0, v134
    v_cvt_pk_bf16_f32 v134, v134, v134
    v_and_b32 v134, 0xffff0000, v134
    v_add_f32 v134, 0x3727c5ac, v134
    v_cvt_pk_bf16_f32 v134, v134, v134
    v_and_b32 v134, 0xffff0000, v134
    v_sqrt_f32 v134, v134
    s_nop 0
    v_cvt_pk_bf16_f32 v134, v134, v134
    v_and_b32 v134, 0xffff0000, v134
    v_rcp_f32 v134, v134
    v_cvt_pk_bf16_f32 v132, v132, v132
    v_and_b32 v132, 0xffff0000, v132
    v_sub_f32 v132, 0, v132
    ds_write2_b32 v1, v132, v134 offset0:0 offset1:128
    s_lshl_b32 s46, s33, 1
    s_add_u32 s46, s46, s32
    s_lshl_b32 s46, s46, 7
    s_add_u32 s46, s46, 131072
    v_lshlrev_b32 v1, 2, v0
    v_add_u32 v1, s46, v1
    s_mov_b64 exec, 0xffff
    ds_write2_b32 v1, v112, v113 offset0:0 offset1:16
    s_mov_b64 exec, -1
    s_waitcnt vmcnt(0) lgkmcnt(0)
    s_barrier
    v_lshlrev_b32 v1, 4, v3
    v_add_u32 v1, s46, v1
    v_xor_b32 v4, 128, v1
    ds_read_b128 v[128:131], v1 offset:0
    ds_read_b128 v[132:135], v1 offset:32
    ds_read_b128 v[136:139], v1 offset:64
    ds_read_b128 v[140:143], v1 offset:96
    ds_read_b128 v[144:147], v4 offset:0
    ds_read_b128 v[148:151], v4 offset:32
    ds_read_b128 v[152:155], v4 offset:64
    ds_read_b128 v[156:159], v4 offset:96
    v_lshlrev_b32 v1, 2, v2
    v_add_u32 v1, s48, v1
    v_xor_b32 v4, 128, v1
    ds_read2_b32 v[16:17], v1 offset0:0 offset1:128
    ds_read2_b32 v[18:19], v4 offset0:0 offset1:128
    s_waitcnt lgkmcnt(0)
    v_mul_f32 v17, s40, v17
    v_mul_f32 v19, s40, v19
    v_pk_fma_f32 v[48:49], v[128:129], v[16:17], v[48:49] op_sel_hi:[1,0,1]
    v_pk_fma_f32 v[50:51], v[130:131], v[16:17], v[50:51] op_sel_hi:[1,0,1]
    v_pk_mul_f32 v[48:49], v[48:49], v[16:17] op_sel:[0,1] op_sel_hi:[1,1]
    v_pk_mul_f32 v[50:51], v[50:51], v[16:17] op_sel:[0,1] op_sel_hi:[1,1]
    v_cvt_pk_bf16_f32 v20, v48, v49
    v_cvt_pk_bf16_f32 v21, v50, v51
    buffer_store_dwordx2 v[20:21], v120, s[20:23], s42 offen
    v_pk_fma_f32 v[52:53], v[132:133], v[16:17], v[52:53] op_sel_hi:[1,0,1]
    v_pk_fma_f32 v[54:55], v[134:135], v[16:17], v[54:55] op_sel_hi:[1,0,1]
    v_pk_mul_f32 v[52:53], v[52:53], v[16:17] op_sel:[0,1] op_sel_hi:[1,1]
    v_pk_mul_f32 v[54:55], v[54:55], v[16:17] op_sel:[0,1] op_sel_hi:[1,1]
    v_cvt_pk_bf16_f32 v22, v52, v53
    v_cvt_pk_bf16_f32 v23, v54, v55
    buffer_store_dwordx2 v[22:23], v121, s[20:23], s42 offen
    v_pk_fma_f32 v[56:57], v[136:137], v[16:17], v[56:57] op_sel_hi:[1,0,1]
    v_pk_fma_f32 v[58:59], v[138:139], v[16:17], v[58:59] op_sel_hi:[1,0,1]
    v_pk_mul_f32 v[56:57], v[56:57], v[16:17] op_sel:[0,1] op_sel_hi:[1,1]
    v_pk_mul_f32 v[58:59], v[58:59], v[16:17] op_sel:[0,1] op_sel_hi:[1,1]
    v_cvt_pk_bf16_f32 v24, v56, v57
    v_cvt_pk_bf16_f32 v25, v58, v59
    buffer_store_dwordx2 v[24:25], v122, s[20:23], s42 offen
    v_pk_fma_f32 v[60:61], v[140:141], v[16:17], v[60:61] op_sel_hi:[1,0,1]
    v_pk_fma_f32 v[62:63], v[142:143], v[16:17], v[62:63] op_sel_hi:[1,0,1]
    v_pk_mul_f32 v[60:61], v[60:61], v[16:17] op_sel:[0,1] op_sel_hi:[1,1]
    v_pk_mul_f32 v[62:63], v[62:63], v[16:17] op_sel:[0,1] op_sel_hi:[1,1]
    v_cvt_pk_bf16_f32 v26, v60, v61
    v_cvt_pk_bf16_f32 v27, v62, v63
    buffer_store_dwordx2 v[26:27], v123, s[20:23], s42 offen
    v_pk_fma_f32 v[64:65], v[128:129], v[18:19], v[64:65] op_sel_hi:[1,0,1]
    v_pk_fma_f32 v[66:67], v[130:131], v[18:19], v[66:67] op_sel_hi:[1,0,1]
    v_pk_mul_f32 v[64:65], v[64:65], v[18:19] op_sel:[0,1] op_sel_hi:[1,1]
    v_pk_mul_f32 v[66:67], v[66:67], v[18:19] op_sel:[0,1] op_sel_hi:[1,1]
    v_cvt_pk_bf16_f32 v28, v64, v65
    v_cvt_pk_bf16_f32 v29, v66, v67
    buffer_store_dwordx2 v[28:29], v120, s[20:23], s43 offen
    v_pk_fma_f32 v[68:69], v[132:133], v[18:19], v[68:69] op_sel_hi:[1,0,1]
    v_pk_fma_f32 v[70:71], v[134:135], v[18:19], v[70:71] op_sel_hi:[1,0,1]
    v_pk_mul_f32 v[68:69], v[68:69], v[18:19] op_sel:[0,1] op_sel_hi:[1,1]
    v_pk_mul_f32 v[70:71], v[70:71], v[18:19] op_sel:[0,1] op_sel_hi:[1,1]
    v_cvt_pk_bf16_f32 v30, v68, v69
    v_cvt_pk_bf16_f32 v31, v70, v71
    buffer_store_dwordx2 v[30:31], v121, s[20:23], s43 offen
    v_pk_fma_f32 v[72:73], v[136:137], v[18:19], v[72:73] op_sel_hi:[1,0,1]
    v_pk_fma_f32 v[74:75], v[138:139], v[18:19], v[74:75] op_sel_hi:[1,0,1]
    v_pk_mul_f32 v[72:73], v[72:73], v[18:19] op_sel:[0,1] op_sel_hi:[1,1]
    v_pk_mul_f32 v[74:75], v[74:75], v[18:19] op_sel:[0,1] op_sel_hi:[1,1]
    v_cvt_pk_bf16_f32 v32, v72, v73
    v_cvt_pk_bf16_f32 v33, v74, v75
    buffer_store_dwordx2 v[32:33], v122, s[20:23], s43 offen
    v_pk_fma_f32 v[76:77], v[140:141], v[18:19], v[76:77] op_sel_hi:[1,0,1]
    v_pk_fma_f32 v[78:79], v[142:143], v[18:19], v[78:79] op_sel_hi:[1,0,1]
    v_pk_mul_f32 v[76:77], v[76:77], v[18:19] op_sel:[0,1] op_sel_hi:[1,1]
    v_pk_mul_f32 v[78:79], v[78:79], v[18:19] op_sel:[0,1] op_sel_hi:[1,1]
    v_cvt_pk_bf16_f32 v34, v76, v77
    v_cvt_pk_bf16_f32 v35, v78, v79
    buffer_store_dwordx2 v[34:35], v123, s[20:23], s43 offen
    v_pk_fma_f32 v[80:81], v[144:145], v[16:17], v[80:81] op_sel_hi:[1,0,1]
    v_pk_fma_f32 v[82:83], v[146:147], v[16:17], v[82:83] op_sel_hi:[1,0,1]
    v_pk_mul_f32 v[80:81], v[80:81], v[16:17] op_sel:[0,1] op_sel_hi:[1,1]
    v_pk_mul_f32 v[82:83], v[82:83], v[16:17] op_sel:[0,1] op_sel_hi:[1,1]
    v_cvt_pk_bf16_f32 v20, v80, v81
    v_cvt_pk_bf16_f32 v21, v82, v83
    buffer_store_dwordx2 v[20:21], v124, s[20:23], s42 offen
    v_pk_fma_f32 v[84:85], v[148:149], v[16:17], v[84:85] op_sel_hi:[1,0,1]
    v_pk_fma_f32 v[86:87], v[150:151], v[16:17], v[86:87] op_sel_hi:[1,0,1]
    v_pk_mul_f32 v[84:85], v[84:85], v[16:17] op_sel:[0,1] op_sel_hi:[1,1]
    v_pk_mul_f32 v[86:87], v[86:87], v[16:17] op_sel:[0,1] op_sel_hi:[1,1]
    v_cvt_pk_bf16_f32 v22, v84, v85
    v_cvt_pk_bf16_f32 v23, v86, v87
    buffer_store_dwordx2 v[22:23], v125, s[20:23], s42 offen
    v_pk_fma_f32 v[88:89], v[152:153], v[16:17], v[88:89] op_sel_hi:[1,0,1]
    v_pk_fma_f32 v[90:91], v[154:155], v[16:17], v[90:91] op_sel_hi:[1,0,1]
    v_pk_mul_f32 v[88:89], v[88:89], v[16:17] op_sel:[0,1] op_sel_hi:[1,1]
    v_pk_mul_f32 v[90:91], v[90:91], v[16:17] op_sel:[0,1] op_sel_hi:[1,1]
    v_cvt_pk_bf16_f32 v24, v88, v89
    v_cvt_pk_bf16_f32 v25, v90, v91
    buffer_store_dwordx2 v[24:25], v126, s[20:23], s42 offen
    v_pk_fma_f32 v[92:93], v[156:157], v[16:17], v[92:93] op_sel_hi:[1,0,1]
    v_pk_fma_f32 v[94:95], v[158:159], v[16:17], v[94:95] op_sel_hi:[1,0,1]
    v_pk_mul_f32 v[92:93], v[92:93], v[16:17] op_sel:[0,1] op_sel_hi:[1,1]
    v_pk_mul_f32 v[94:95], v[94:95], v[16:17] op_sel:[0,1] op_sel_hi:[1,1]
    v_cvt_pk_bf16_f32 v26, v92, v93
    v_cvt_pk_bf16_f32 v27, v94, v95
    buffer_store_dwordx2 v[26:27], v127, s[20:23], s42 offen
    v_pk_fma_f32 v[96:97], v[144:145], v[18:19], v[96:97] op_sel_hi:[1,0,1]
    v_pk_fma_f32 v[98:99], v[146:147], v[18:19], v[98:99] op_sel_hi:[1,0,1]
    v_pk_mul_f32 v[96:97], v[96:97], v[18:19] op_sel:[0,1] op_sel_hi:[1,1]
    v_pk_mul_f32 v[98:99], v[98:99], v[18:19] op_sel:[0,1] op_sel_hi:[1,1]
    v_cvt_pk_bf16_f32 v28, v96, v97
    v_cvt_pk_bf16_f32 v29, v98, v99
    buffer_store_dwordx2 v[28:29], v124, s[20:23], s43 offen
    v_pk_fma_f32 v[100:101], v[148:149], v[18:19], v[100:101] op_sel_hi:[1,0,1]
    v_pk_fma_f32 v[102:103], v[150:151], v[18:19], v[102:103] op_sel_hi:[1,0,1]
    v_pk_mul_f32 v[100:101], v[100:101], v[18:19] op_sel:[0,1] op_sel_hi:[1,1]
    v_pk_mul_f32 v[102:103], v[102:103], v[18:19] op_sel:[0,1] op_sel_hi:[1,1]
    v_cvt_pk_bf16_f32 v30, v100, v101
    v_cvt_pk_bf16_f32 v31, v102, v103
    buffer_store_dwordx2 v[30:31], v125, s[20:23], s43 offen
    v_pk_fma_f32 v[104:105], v[152:153], v[18:19], v[104:105] op_sel_hi:[1,0,1]
    v_pk_fma_f32 v[106:107], v[154:155], v[18:19], v[106:107] op_sel_hi:[1,0,1]
    v_pk_mul_f32 v[104:105], v[104:105], v[18:19] op_sel:[0,1] op_sel_hi:[1,1]
    v_pk_mul_f32 v[106:107], v[106:107], v[18:19] op_sel:[0,1] op_sel_hi:[1,1]
    v_cvt_pk_bf16_f32 v32, v104, v105
    v_cvt_pk_bf16_f32 v33, v106, v107
    buffer_store_dwordx2 v[32:33], v126, s[20:23], s43 offen
    v_pk_fma_f32 v[108:109], v[156:157], v[18:19], v[108:109] op_sel_hi:[1,0,1]
    v_pk_fma_f32 v[110:111], v[158:159], v[18:19], v[110:111] op_sel_hi:[1,0,1]
    v_pk_mul_f32 v[108:109], v[108:109], v[18:19] op_sel:[0,1] op_sel_hi:[1,1]
    v_pk_mul_f32 v[110:111], v[110:111], v[18:19] op_sel:[0,1] op_sel_hi:[1,1]
    v_cvt_pk_bf16_f32 v34, v108, v109
    v_cvt_pk_bf16_f32 v35, v110, v111
    buffer_store_dwordx2 v[34:35], v127, s[20:23], s43 offen
    s_endpgm
k_qkv_kernel_vsetup:
    s_add_u32 s20, s8, 0x300000
    s_addc_u32 s21, s9, 0
    s_mov_b32 s22, 0x500000
    s_mov_b32 s23, 0x00020000
    s_sub_u32 s37, s31, 10
    s_lshl_b32 s42, s30, 2
    s_lshl_b32 s43, s32, 1
    s_add_u32 s42, s42, s43
    s_add_u32 s42, s42, s33
    s_xor_b32 s43, s42, 1
    s_mul_i32 s42, s42, 2560
    s_mul_i32 s43, s43, 2560
    s_lshl_b32 s44, s37, 7
    s_lshl_b32 s45, s33, 6
    s_add_u32 s44, s44, s45
    s_mov_b32 s41, 163840
    s_xor_b32 s45, s32, 0
    s_lshl_b32 s45, s45, 5
    s_add_u32 s45, s45, s44
    v_add_u32 v7, s45, v2
    v_mul_u32_u24 v1, 3277, v7
    v_lshrrev_b32 v1, 16, v1
    v_mul_u32_u24 v4, 20, v1
    v_sub_u32 v7, v7, v4
    v_mul_lo_u32 v120, v1, s41
    v_lshl_add_u32 v120, v7, 4, v120
    v_lshl_add_u32 v120, v3, 3, v120
    v_add_u32 v120, 1280, v120
    s_xor_b32 s45, s32, 1
    s_lshl_b32 s45, s45, 5
    s_add_u32 s45, s45, s44
    v_add_u32 v7, s45, v2
    v_mul_u32_u24 v1, 3277, v7
    v_lshrrev_b32 v1, 16, v1
    v_mul_u32_u24 v4, 20, v1
    v_sub_u32 v7, v7, v4
    v_mul_lo_u32 v121, v1, s41
    v_lshl_add_u32 v121, v7, 4, v121
    v_lshl_add_u32 v121, v3, 3, v121
    v_add_u32 v121, 1280, v121
    s_barrier
    ds_read_b128 v[16:19], v8 offset:0
    ds_read_b64_tr_b16 v[32:33], v12 offset:0
    ds_read_b64_tr_b16 v[34:35], v12 offset:1024
    ds_read_b128 v[20:23], v128 offset:0
    ds_read_b64_tr_b16 v[36:37], v13 offset:0
    ds_read_b64_tr_b16 v[38:39], v13 offset:1024
    s_waitcnt lgkmcnt(0)
    v_mfma_f32_32x32x16_bf16 v[48:63], v[16:19], v[32:35], v[48:63]
    ds_read_b128 v[24:27], v9 offset:0
    ds_read_b64_tr_b16 v[40:41], v12 offset:4096
    ds_read_b64_tr_b16 v[42:43], v12 offset:5120
    v_lshlrev_b32 v136, 16, v16
    v_and_b32 v137, s47, v16
    v_add_f32 v132, v132, v136
    v_add_f32 v133, v133, v137
    v_fmac_f32 v134, v136, v136
    v_mfma_f32_32x32x16_bf16 v[64:79], v[20:23], v[32:35], v[64:79]
    ds_read_b128 v[28:31], v129 offset:0
    ds_read_b64_tr_b16 v[44:45], v13 offset:4096
    ds_read_b64_tr_b16 v[46:47], v13 offset:5120
    v_fmac_f32 v135, v137, v137
    v_lshlrev_b32 v138, 16, v17
    v_and_b32 v139, s47, v17
    v_add_f32 v132, v132, v138
    v_add_f32 v133, v133, v139
    v_mfma_f32_32x32x16_bf16 v[96:111], v[20:23], v[36:39], v[96:111]
    v_fmac_f32 v134, v138, v138
    v_fmac_f32 v135, v139, v139
    v_lshlrev_b32 v136, 16, v18
    v_and_b32 v137, s47, v18
    v_add_f32 v132, v132, v136
    v_add_f32 v133, v133, v137
    v_fmac_f32 v134, v136, v136
    v_mfma_f32_32x32x16_bf16 v[80:95], v[16:19], v[36:39], v[80:95]
    v_fmac_f32 v135, v137, v137
    v_lshlrev_b32 v138, 16, v19
    v_and_b32 v139, s47, v19
    v_add_f32 v132, v132, v138
    v_add_f32 v133, v133, v139
    v_fmac_f32 v134, v138, v138
    v_fmac_f32 v135, v139, v139
    v_mfma_f32_16x16x32_bf16 v[112:115], v[116:119], v[32:35], v[112:115]
    s_waitcnt lgkmcnt(0)
    v_mfma_f32_32x32x16_bf16 v[48:63], v[24:27], v[40:43], v[48:63]
    ds_read_b128 v[16:19], v10 offset:0
    ds_read_b64_tr_b16 v[32:33], v12 offset:8192
    ds_read_b64_tr_b16 v[34:35], v12 offset:9216
    v_lshlrev_b32 v136, 16, v24
    v_and_b32 v137, s47, v24
    v_add_f32 v132, v132, v136
    v_add_f32 v133, v133, v137
    v_fmac_f32 v134, v136, v136
    v_mfma_f32_32x32x16_bf16 v[64:79], v[28:31], v[40:43], v[64:79]
    ds_read_b128 v[20:23], v130 offset:0
    ds_read_b64_tr_b16 v[36:37], v13 offset:8192
    ds_read_b64_tr_b16 v[38:39], v13 offset:9216
    v_fmac_f32 v135, v137, v137
    v_lshlrev_b32 v138, 16, v25
    v_and_b32 v139, s47, v25
    v_add_f32 v132, v132, v138
    v_add_f32 v133, v133, v139
    v_mfma_f32_32x32x16_bf16 v[96:111], v[28:31], v[44:47], v[96:111]
    v_fmac_f32 v134, v138, v138
    v_fmac_f32 v135, v139, v139
    v_lshlrev_b32 v136, 16, v26
    v_and_b32 v137, s47, v26
    v_add_f32 v132, v132, v136
    v_add_f32 v133, v133, v137
    v_fmac_f32 v134, v136, v136
    v_mfma_f32_32x32x16_bf16 v[80:95], v[24:27], v[44:47], v[80:95]
    v_fmac_f32 v135, v137, v137
    v_lshlrev_b32 v138, 16, v27
    v_and_b32 v139, s47, v27
    v_add_f32 v132, v132, v138
    v_add_f32 v133, v133, v139
    v_fmac_f32 v134, v138, v138
    v_fmac_f32 v135, v139, v139
    v_mfma_f32_16x16x32_bf16 v[112:115], v[116:119], v[40:43], v[112:115]
    s_waitcnt lgkmcnt(0)
    v_mfma_f32_32x32x16_bf16 v[48:63], v[16:19], v[32:35], v[48:63]
    ds_read_b128 v[24:27], v11 offset:0
    ds_read_b64_tr_b16 v[40:41], v12 offset:12288
    ds_read_b64_tr_b16 v[42:43], v12 offset:13312
    v_lshlrev_b32 v136, 16, v16
    v_and_b32 v137, s47, v16
    v_add_f32 v132, v132, v136
    v_add_f32 v133, v133, v137
    v_fmac_f32 v134, v136, v136
    v_mfma_f32_32x32x16_bf16 v[64:79], v[20:23], v[32:35], v[64:79]
    ds_read_b128 v[28:31], v131 offset:0
    ds_read_b64_tr_b16 v[44:45], v13 offset:12288
    ds_read_b64_tr_b16 v[46:47], v13 offset:13312
    v_fmac_f32 v135, v137, v137
    v_lshlrev_b32 v138, 16, v17
    v_and_b32 v139, s47, v17
    v_add_f32 v132, v132, v138
    v_add_f32 v133, v133, v139
    v_mfma_f32_32x32x16_bf16 v[96:111], v[20:23], v[36:39], v[96:111]
    v_fmac_f32 v134, v138, v138
    v_fmac_f32 v135, v139, v139
    v_lshlrev_b32 v136, 16, v18
    v_and_b32 v137, s47, v18
    v_add_f32 v132, v132, v136
    v_add_f32 v133, v133, v137
    v_fmac_f32 v134, v136, v136
    v_mfma_f32_32x32x16_bf16 v[80:95], v[16:19], v[36:39], v[80:95]
    v_fmac_f32 v135, v137, v137
    v_lshlrev_b32 v138, 16, v19
    v_and_b32 v139, s47, v19
    v_add_f32 v132, v132, v138
    v_add_f32 v133, v133, v139
    v_fmac_f32 v134, v138, v138
    v_fmac_f32 v135, v139, v139
    v_mfma_f32_16x16x32_bf16 v[112:115], v[116:119], v[32:35], v[112:115]
    s_waitcnt lgkmcnt(0)
    v_mfma_f32_32x32x16_bf16 v[48:63], v[24:27], v[40:43], v[48:63]
    v_lshlrev_b32 v136, 16, v24
    v_and_b32 v137, s47, v24
    v_add_f32 v132, v132, v136
    v_add_f32 v133, v133, v137
    v_fmac_f32 v134, v136, v136
    v_fmac_f32 v135, v137, v137
    v_lshlrev_b32 v138, 16, v25
    v_and_b32 v139, s47, v25
    v_mfma_f32_32x32x16_bf16 v[64:79], v[28:31], v[40:43], v[64:79]
    s_barrier
    ds_read_b128 v[16:19], v8 offset:16384
    ds_read_b64_tr_b16 v[32:33], v12 offset:16384
    ds_read_b64_tr_b16 v[34:35], v12 offset:17408
    v_add_f32 v132, v132, v138
    v_add_f32 v133, v133, v139
    v_fmac_f32 v134, v138, v138
    v_fmac_f32 v135, v139, v139
    v_lshlrev_b32 v136, 16, v26
    v_mfma_f32_32x32x16_bf16 v[96:111], v[28:31], v[44:47], v[96:111]
    ds_read_b128 v[20:23], v128 offset:16384
    ds_read_b64_tr_b16 v[36:37], v13 offset:16384
    ds_read_b64_tr_b16 v[38:39], v13 offset:17408
    v_and_b32 v137, s47, v26
    v_add_f32 v132, v132, v136
    v_add_f32 v133, v133, v137
    v_fmac_f32 v134, v136, v136
    v_mfma_f32_32x32x16_bf16 v[80:95], v[24:27], v[44:47], v[80:95]
    v_fmac_f32 v135, v137, v137
    v_lshlrev_b32 v138, 16, v27
    v_and_b32 v139, s47, v27
    v_add_f32 v132, v132, v138
    v_add_f32 v133, v133, v139
    v_fmac_f32 v134, v138, v138
    v_fmac_f32 v135, v139, v139
    v_mfma_f32_16x16x32_bf16 v[112:115], v[116:119], v[40:43], v[112:115]
    s_waitcnt lgkmcnt(0)
    v_mfma_f32_32x32x16_bf16 v[48:63], v[16:19], v[32:35], v[48:63]
    ds_read_b128 v[24:27], v9 offset:16384
    ds_read_b64_tr_b16 v[40:41], v12 offset:20480
    ds_read_b64_tr_b16 v[42:43], v12 offset:21504
    v_lshlrev_b32 v136, 16, v16
    v_and_b32 v137, s47, v16
    v_add_f32 v132, v132, v136
    v_add_f32 v133, v133, v137
    v_fmac_f32 v134, v136, v136
    v_mfma_f32_32x32x16_bf16 v[64:79], v[20:23], v[32:35], v[64:79]
    ds_read_b128 v[28:31], v129 offset:16384
    ds_read_b64_tr_b16 v[44:45], v13 offset:20480
    ds_read_b64_tr_b16 v[46:47], v13 offset:21504
    v_fmac_f32 v135, v137, v137
    v_lshlrev_b32 v138, 16, v17
    v_and_b32 v139, s47, v17
    v_add_f32 v132, v132, v138
    v_add_f32 v133, v133, v139
    v_mfma_f32_32x32x16_bf16 v[96:111], v[20:23], v[36:39], v[96:111]
    v_fmac_f32 v134, v138, v138
    v_fmac_f32 v135, v139, v139
    v_lshlrev_b32 v136, 16, v18
    v_and_b32 v137, s47, v18
    v_add_f32 v132, v132, v136
    v_add_f32 v133, v133, v137
    v_fmac_f32 v134, v136, v136
    v_mfma_f32_32x32x16_bf16 v[80:95], v[16:19], v[36:39], v[80:95]
    v_fmac_f32 v135, v137, v137
    v_lshlrev_b32 v138, 16, v19
    v_and_b32 v139, s47, v19
    v_add_f32 v132, v132, v138
    v_add_f32 v133, v133, v139
    v_fmac_f32 v134, v138, v138
    v_fmac_f32 v135, v139, v139
    v_mfma_f32_16x16x32_bf16 v[112:115], v[116:119], v[32:35], v[112:115]
    s_waitcnt lgkmcnt(0)
    v_mfma_f32_32x32x16_bf16 v[48:63], v[24:27], v[40:43], v[48:63]
    ds_read_b128 v[16:19], v10 offset:16384
    ds_read_b64_tr_b16 v[32:33], v12 offset:24576
    ds_read_b64_tr_b16 v[34:35], v12 offset:25600
    v_lshlrev_b32 v136, 16, v24
    v_and_b32 v137, s47, v24
    v_add_f32 v132, v132, v136
    v_add_f32 v133, v133, v137
    v_fmac_f32 v134, v136, v136
    v_mfma_f32_32x32x16_bf16 v[64:79], v[28:31], v[40:43], v[64:79]
    ds_read_b128 v[20:23], v130 offset:16384
    ds_read_b64_tr_b16 v[36:37], v13 offset:24576
    ds_read_b64_tr_b16 v[38:39], v13 offset:25600
    v_fmac_f32 v135, v137, v137
    v_lshlrev_b32 v138, 16, v25
    v_and_b32 v139, s47, v25
    v_add_f32 v132, v132, v138
    v_add_f32 v133, v133, v139
    v_mfma_f32_32x32x16_bf16 v[96:111], v[28:31], v[44:47], v[96:111]
    v_fmac_f32 v134, v138, v138
    v_fmac_f32 v135, v139, v139
    v_lshlrev_b32 v136, 16, v26
    v_and_b32 v137, s47, v26
    v_add_f32 v132, v132, v136
    v_add_f32 v133, v133, v137
    v_fmac_f32 v134, v136, v136
    v_mfma_f32_32x32x16_bf16 v[80:95], v[24:27], v[44:47], v[80:95]
    v_fmac_f32 v135, v137, v137
    v_lshlrev_b32 v138, 16, v27
    v_and_b32 v139, s47, v27
    v_add_f32 v132, v132, v138
    v_add_f32 v133, v133, v139
    v_fmac_f32 v134, v138, v138
    v_fmac_f32 v135, v139, v139
    v_mfma_f32_16x16x32_bf16 v[112:115], v[116:119], v[40:43], v[112:115]
    s_waitcnt lgkmcnt(0)
    v_mfma_f32_32x32x16_bf16 v[48:63], v[16:19], v[32:35], v[48:63]
    ds_read_b128 v[24:27], v11 offset:16384
    ds_read_b64_tr_b16 v[40:41], v12 offset:28672
    ds_read_b64_tr_b16 v[42:43], v12 offset:29696
    v_lshlrev_b32 v136, 16, v16
    v_and_b32 v137, s47, v16
    v_add_f32 v132, v132, v136
    v_add_f32 v133, v133, v137
    v_fmac_f32 v134, v136, v136
    v_mfma_f32_32x32x16_bf16 v[64:79], v[20:23], v[32:35], v[64:79]
    ds_read_b128 v[28:31], v131 offset:16384
    ds_read_b64_tr_b16 v[44:45], v13 offset:28672
    ds_read_b64_tr_b16 v[46:47], v13 offset:29696
    v_fmac_f32 v135, v137, v137
    v_lshlrev_b32 v138, 16, v17
    v_and_b32 v139, s47, v17
    v_add_f32 v132, v132, v138
    v_add_f32 v133, v133, v139
    v_mfma_f32_32x32x16_bf16 v[96:111], v[20:23], v[36:39], v[96:111]
    v_fmac_f32 v134, v138, v138
    v_fmac_f32 v135, v139, v139
    v_lshlrev_b32 v136, 16, v18
    v_and_b32 v137, s47, v18
    v_add_f32 v132, v132, v136
    v_add_f32 v133, v133, v137
    v_fmac_f32 v134, v136, v136
    v_mfma_f32_32x32x16_bf16 v[80:95], v[16:19], v[36:39], v[80:95]
    v_fmac_f32 v135, v137, v137
    v_lshlrev_b32 v138, 16, v19
    v_and_b32 v139, s47, v19
    v_add_f32 v132, v132, v138
    v_add_f32 v133, v133, v139
    v_fmac_f32 v134, v138, v138
    v_fmac_f32 v135, v139, v139
    v_mfma_f32_16x16x32_bf16 v[112:115], v[116:119], v[32:35], v[112:115]
    s_waitcnt lgkmcnt(0)
    v_mfma_f32_32x32x16_bf16 v[48:63], v[24:27], v[40:43], v[48:63]
    v_lshlrev_b32 v136, 16, v24
    v_and_b32 v137, s47, v24
    v_add_f32 v132, v132, v136
    v_add_f32 v133, v133, v137
    v_fmac_f32 v134, v136, v136
    v_fmac_f32 v135, v137, v137
    v_lshlrev_b32 v138, 16, v25
    v_and_b32 v139, s47, v25
    v_mfma_f32_32x32x16_bf16 v[64:79], v[28:31], v[40:43], v[64:79]
    s_barrier
    ds_read_b128 v[16:19], v8 offset:32768
    ds_read_b64_tr_b16 v[32:33], v12 offset:32768
    ds_read_b64_tr_b16 v[34:35], v12 offset:33792
    v_add_f32 v132, v132, v138
    v_add_f32 v133, v133, v139
    v_fmac_f32 v134, v138, v138
    v_fmac_f32 v135, v139, v139
    v_lshlrev_b32 v136, 16, v26
    v_mfma_f32_32x32x16_bf16 v[96:111], v[28:31], v[44:47], v[96:111]
    ds_read_b128 v[20:23], v128 offset:32768
    ds_read_b64_tr_b16 v[36:37], v13 offset:32768
    ds_read_b64_tr_b16 v[38:39], v13 offset:33792
    v_and_b32 v137, s47, v26
    v_add_f32 v132, v132, v136
    v_add_f32 v133, v133, v137
    v_fmac_f32 v134, v136, v136
    v_mfma_f32_32x32x16_bf16 v[80:95], v[24:27], v[44:47], v[80:95]
    v_fmac_f32 v135, v137, v137
    v_lshlrev_b32 v138, 16, v27
    v_and_b32 v139, s47, v27
    v_add_f32 v132, v132, v138
    v_add_f32 v133, v133, v139
    v_fmac_f32 v134, v138, v138
    v_fmac_f32 v135, v139, v139
    v_mfma_f32_16x16x32_bf16 v[112:115], v[116:119], v[40:43], v[112:115]
    s_waitcnt lgkmcnt(0)
    v_mfma_f32_32x32x16_bf16 v[48:63], v[16:19], v[32:35], v[48:63]
    ds_read_b128 v[24:27], v9 offset:32768
    ds_read_b64_tr_b16 v[40:41], v12 offset:36864
    ds_read_b64_tr_b16 v[42:43], v12 offset:37888
    v_lshlrev_b32 v136, 16, v16
    v_and_b32 v137, s47, v16
    v_add_f32 v132, v132, v136
    v_add_f32 v133, v133, v137
    v_fmac_f32 v134, v136, v136
    v_mfma_f32_32x32x16_bf16 v[64:79], v[20:23], v[32:35], v[64:79]
    ds_read_b128 v[28:31], v129 offset:32768
    ds_read_b64_tr_b16 v[44:45], v13 offset:36864
    ds_read_b64_tr_b16 v[46:47], v13 offset:37888
    v_fmac_f32 v135, v137, v137
    v_lshlrev_b32 v138, 16, v17
    v_and_b32 v139, s47, v17
    v_add_f32 v132, v132, v138
    v_add_f32 v133, v133, v139
    v_mfma_f32_32x32x16_bf16 v[96:111], v[20:23], v[36:39], v[96:111]
    v_fmac_f32 v134, v138, v138
    v_fmac_f32 v135, v139, v139
    v_lshlrev_b32 v136, 16, v18
    v_and_b32 v137, s47, v18
    v_add_f32 v132, v132, v136
    v_add_f32 v133, v133, v137
    v_fmac_f32 v134, v136, v136
    v_mfma_f32_32x32x16_bf16 v[80:95], v[16:19], v[36:39], v[80:95]
    v_fmac_f32 v135, v137, v137
    v_lshlrev_b32 v138, 16, v19
    v_and_b32 v139, s47, v19
    v_add_f32 v132, v132, v138
    v_add_f32 v133, v133, v139
    v_fmac_f32 v134, v138, v138
    v_fmac_f32 v135, v139, v139
    v_mfma_f32_16x16x32_bf16 v[112:115], v[116:119], v[32:35], v[112:115]
    s_waitcnt lgkmcnt(0)
    v_mfma_f32_32x32x16_bf16 v[48:63], v[24:27], v[40:43], v[48:63]
    ds_read_b128 v[16:19], v10 offset:32768
    ds_read_b64_tr_b16 v[32:33], v12 offset:40960
    ds_read_b64_tr_b16 v[34:35], v12 offset:41984
    v_lshlrev_b32 v136, 16, v24
    v_and_b32 v137, s47, v24
    v_add_f32 v132, v132, v136
    v_add_f32 v133, v133, v137
    v_fmac_f32 v134, v136, v136
    v_mfma_f32_32x32x16_bf16 v[64:79], v[28:31], v[40:43], v[64:79]
    ds_read_b128 v[20:23], v130 offset:32768
    ds_read_b64_tr_b16 v[36:37], v13 offset:40960
    ds_read_b64_tr_b16 v[38:39], v13 offset:41984
    v_fmac_f32 v135, v137, v137
    v_lshlrev_b32 v138, 16, v25
    v_and_b32 v139, s47, v25
    v_add_f32 v132, v132, v138
    v_add_f32 v133, v133, v139
    v_mfma_f32_32x32x16_bf16 v[96:111], v[28:31], v[44:47], v[96:111]
    v_fmac_f32 v134, v138, v138
    v_fmac_f32 v135, v139, v139
    v_lshlrev_b32 v136, 16, v26
    v_and_b32 v137, s47, v26
    v_add_f32 v132, v132, v136
    v_add_f32 v133, v133, v137
    v_fmac_f32 v134, v136, v136
    v_mfma_f32_32x32x16_bf16 v[80:95], v[24:27], v[44:47], v[80:95]
    v_fmac_f32 v135, v137, v137
    v_lshlrev_b32 v138, 16, v27
    v_and_b32 v139, s47, v27
    v_add_f32 v132, v132, v138
    v_add_f32 v133, v133, v139
    v_fmac_f32 v134, v138, v138
    v_fmac_f32 v135, v139, v139
    v_mfma_f32_16x16x32_bf16 v[112:115], v[116:119], v[40:43], v[112:115]
    s_waitcnt lgkmcnt(0)
    v_mfma_f32_32x32x16_bf16 v[48:63], v[16:19], v[32:35], v[48:63]
    ds_read_b128 v[24:27], v11 offset:32768
    ds_read_b64_tr_b16 v[40:41], v12 offset:45056
    ds_read_b64_tr_b16 v[42:43], v12 offset:46080
    v_lshlrev_b32 v136, 16, v16
    v_and_b32 v137, s47, v16
    v_add_f32 v132, v132, v136
    v_add_f32 v133, v133, v137
    v_fmac_f32 v134, v136, v136
    v_mfma_f32_32x32x16_bf16 v[64:79], v[20:23], v[32:35], v[64:79]
    ds_read_b128 v[28:31], v131 offset:32768
    ds_read_b64_tr_b16 v[44:45], v13 offset:45056
    ds_read_b64_tr_b16 v[46:47], v13 offset:46080
    v_fmac_f32 v135, v137, v137
    v_lshlrev_b32 v138, 16, v17
    v_and_b32 v139, s47, v17
    v_add_f32 v132, v132, v138
    v_add_f32 v133, v133, v139
    v_mfma_f32_32x32x16_bf16 v[96:111], v[20:23], v[36:39], v[96:111]
    v_fmac_f32 v134, v138, v138
    v_fmac_f32 v135, v139, v139
    v_lshlrev_b32 v136, 16, v18
    v_and_b32 v137, s47, v18
    v_add_f32 v132, v132, v136
    v_add_f32 v133, v133, v137
    v_fmac_f32 v134, v136, v136
    v_mfma_f32_32x32x16_bf16 v[80:95], v[16:19], v[36:39], v[80:95]
    v_fmac_f32 v135, v137, v137
    v_lshlrev_b32 v138, 16, v19
    v_and_b32 v139, s47, v19
    v_add_f32 v132, v132, v138
    v_add_f32 v133, v133, v139
    v_fmac_f32 v134, v138, v138
    v_fmac_f32 v135, v139, v139
    v_mfma_f32_16x16x32_bf16 v[112:115], v[116:119], v[32:35], v[112:115]
    s_waitcnt lgkmcnt(0)
    v_mfma_f32_32x32x16_bf16 v[48:63], v[24:27], v[40:43], v[48:63]
    v_lshlrev_b32 v136, 16, v24
    v_and_b32 v137, s47, v24
    v_add_f32 v132, v132, v136
    v_add_f32 v133, v133, v137
    v_fmac_f32 v134, v136, v136
    v_fmac_f32 v135, v137, v137
    v_lshlrev_b32 v138, 16, v25
    v_and_b32 v139, s47, v25
    v_mfma_f32_32x32x16_bf16 v[64:79], v[28:31], v[40:43], v[64:79]
    s_barrier
    ds_read_b128 v[16:19], v8 offset:49152
    ds_read_b64_tr_b16 v[32:33], v12 offset:49152
    ds_read_b64_tr_b16 v[34:35], v12 offset:50176
    v_add_f32 v132, v132, v138
    v_add_f32 v133, v133, v139
    v_fmac_f32 v134, v138, v138
    v_fmac_f32 v135, v139, v139
    v_lshlrev_b32 v136, 16, v26
    v_mfma_f32_32x32x16_bf16 v[96:111], v[28:31], v[44:47], v[96:111]
    ds_read_b128 v[20:23], v128 offset:49152
    ds_read_b64_tr_b16 v[36:37], v13 offset:49152
    ds_read_b64_tr_b16 v[38:39], v13 offset:50176
    v_and_b32 v137, s47, v26
    v_add_f32 v132, v132, v136
    v_add_f32 v133, v133, v137
    v_fmac_f32 v134, v136, v136
    v_mfma_f32_32x32x16_bf16 v[80:95], v[24:27], v[44:47], v[80:95]
    v_fmac_f32 v135, v137, v137
    v_lshlrev_b32 v138, 16, v27
    v_and_b32 v139, s47, v27
    v_add_f32 v132, v132, v138
    v_add_f32 v133, v133, v139
    v_fmac_f32 v134, v138, v138
    v_fmac_f32 v135, v139, v139
    v_mfma_f32_16x16x32_bf16 v[112:115], v[116:119], v[40:43], v[112:115]
    s_waitcnt lgkmcnt(0)
    v_mfma_f32_32x32x16_bf16 v[48:63], v[16:19], v[32:35], v[48:63]
    ds_read_b128 v[24:27], v9 offset:49152
    ds_read_b64_tr_b16 v[40:41], v12 offset:53248
    ds_read_b64_tr_b16 v[42:43], v12 offset:54272
    v_lshlrev_b32 v136, 16, v16
    v_and_b32 v137, s47, v16
    v_add_f32 v132, v132, v136
    v_add_f32 v133, v133, v137
    v_fmac_f32 v134, v136, v136
    v_mfma_f32_32x32x16_bf16 v[64:79], v[20:23], v[32:35], v[64:79]
    ds_read_b128 v[28:31], v129 offset:49152
    ds_read_b64_tr_b16 v[44:45], v13 offset:53248
    ds_read_b64_tr_b16 v[46:47], v13 offset:54272
    v_fmac_f32 v135, v137, v137
    v_lshlrev_b32 v138, 16, v17
    v_and_b32 v139, s47, v17
    v_add_f32 v132, v132, v138
    v_add_f32 v133, v133, v139
    v_mfma_f32_32x32x16_bf16 v[96:111], v[20:23], v[36:39], v[96:111]
    v_fmac_f32 v134, v138, v138
    v_fmac_f32 v135, v139, v139
    v_lshlrev_b32 v136, 16, v18
    v_and_b32 v137, s47, v18
    v_add_f32 v132, v132, v136
    v_add_f32 v133, v133, v137
    v_fmac_f32 v134, v136, v136
    v_mfma_f32_32x32x16_bf16 v[80:95], v[16:19], v[36:39], v[80:95]
    v_fmac_f32 v135, v137, v137
    v_lshlrev_b32 v138, 16, v19
    v_and_b32 v139, s47, v19
    v_add_f32 v132, v132, v138
    v_add_f32 v133, v133, v139
    v_fmac_f32 v134, v138, v138
    v_fmac_f32 v135, v139, v139
    v_mfma_f32_16x16x32_bf16 v[112:115], v[116:119], v[32:35], v[112:115]
    s_waitcnt lgkmcnt(0)
    v_mfma_f32_32x32x16_bf16 v[48:63], v[24:27], v[40:43], v[48:63]
    ds_read_b128 v[16:19], v10 offset:49152
    ds_read_b64_tr_b16 v[32:33], v12 offset:57344
    ds_read_b64_tr_b16 v[34:35], v12 offset:58368
    v_lshlrev_b32 v136, 16, v24
    v_and_b32 v137, s47, v24
    v_add_f32 v132, v132, v136
    v_add_f32 v133, v133, v137
    v_fmac_f32 v134, v136, v136
    v_mfma_f32_32x32x16_bf16 v[64:79], v[28:31], v[40:43], v[64:79]
    ds_read_b128 v[20:23], v130 offset:49152
    ds_read_b64_tr_b16 v[36:37], v13 offset:57344
    ds_read_b64_tr_b16 v[38:39], v13 offset:58368
    v_fmac_f32 v135, v137, v137
    v_lshlrev_b32 v138, 16, v25
    v_and_b32 v139, s47, v25
    v_add_f32 v132, v132, v138
    v_add_f32 v133, v133, v139
    v_mfma_f32_32x32x16_bf16 v[96:111], v[28:31], v[44:47], v[96:111]
    v_fmac_f32 v134, v138, v138
    v_fmac_f32 v135, v139, v139
    v_lshlrev_b32 v136, 16, v26
    v_and_b32 v137, s47, v26
    v_add_f32 v132, v132, v136
    v_add_f32 v133, v133, v137
    v_fmac_f32 v134, v136, v136
    v_mfma_f32_32x32x16_bf16 v[80:95], v[24:27], v[44:47], v[80:95]
    v_fmac_f32 v135, v137, v137
    v_lshlrev_b32 v138, 16, v27
    v_and_b32 v139, s47, v27
    v_add_f32 v132, v132, v138
    v_add_f32 v133, v133, v139
    v_fmac_f32 v134, v138, v138
    v_fmac_f32 v135, v139, v139
    v_mfma_f32_16x16x32_bf16 v[112:115], v[116:119], v[40:43], v[112:115]
    s_waitcnt lgkmcnt(0)
    v_mfma_f32_32x32x16_bf16 v[48:63], v[16:19], v[32:35], v[48:63]
    ds_read_b128 v[24:27], v11 offset:49152
    ds_read_b64_tr_b16 v[40:41], v12 offset:61440
    ds_read_b64_tr_b16 v[42:43], v12 offset:62464
    v_lshlrev_b32 v136, 16, v16
    v_and_b32 v137, s47, v16
    v_add_f32 v132, v132, v136
    v_add_f32 v133, v133, v137
    v_fmac_f32 v134, v136, v136
    v_mfma_f32_32x32x16_bf16 v[64:79], v[20:23], v[32:35], v[64:79]
    ds_read_b128 v[28:31], v131 offset:49152
    ds_read_b64_tr_b16 v[44:45], v13 offset:61440
    ds_read_b64_tr_b16 v[46:47], v13 offset:62464
    v_fmac_f32 v135, v137, v137
    v_lshlrev_b32 v138, 16, v17
    v_and_b32 v139, s47, v17
    v_add_f32 v132, v132, v138
    v_add_f32 v133, v133, v139
    v_mfma_f32_32x32x16_bf16 v[96:111], v[20:23], v[36:39], v[96:111]
    v_fmac_f32 v134, v138, v138
    v_fmac_f32 v135, v139, v139
    v_lshlrev_b32 v136, 16, v18
    v_and_b32 v137, s47, v18
    v_add_f32 v132, v132, v136
    v_add_f32 v133, v133, v137
    v_fmac_f32 v134, v136, v136
    v_mfma_f32_32x32x16_bf16 v[80:95], v[16:19], v[36:39], v[80:95]
    v_fmac_f32 v135, v137, v137
    v_lshlrev_b32 v138, 16, v19
    v_and_b32 v139, s47, v19
    v_add_f32 v132, v132, v138
    v_add_f32 v133, v133, v139
    v_fmac_f32 v134, v138, v138
    v_fmac_f32 v135, v139, v139
    v_mfma_f32_16x16x32_bf16 v[112:115], v[116:119], v[32:35], v[112:115]
    s_waitcnt lgkmcnt(0)
    v_mfma_f32_32x32x16_bf16 v[48:63], v[24:27], v[40:43], v[48:63]
    v_lshlrev_b32 v136, 16, v24
    v_and_b32 v137, s47, v24
    v_add_f32 v132, v132, v136
    v_add_f32 v133, v133, v137
    v_fmac_f32 v134, v136, v136
    v_fmac_f32 v135, v137, v137
    v_lshlrev_b32 v138, 16, v25
    v_and_b32 v139, s47, v25
    v_mfma_f32_32x32x16_bf16 v[64:79], v[28:31], v[40:43], v[64:79]
    s_barrier
    ds_read_b128 v[16:19], v8 offset:0
    ds_read_b64_tr_b16 v[32:33], v12 offset:0
    ds_read_b64_tr_b16 v[34:35], v12 offset:1024
    v_add_f32 v132, v132, v138
    v_add_f32 v133, v133, v139
    v_fmac_f32 v134, v138, v138
    v_fmac_f32 v135, v139, v139
    v_lshlrev_b32 v136, 16, v26
    v_mfma_f32_32x32x16_bf16 v[96:111], v[28:31], v[44:47], v[96:111]
    ds_read_b128 v[20:23], v128 offset:0
    ds_read_b64_tr_b16 v[36:37], v13 offset:0
    ds_read_b64_tr_b16 v[38:39], v13 offset:1024
    v_and_b32 v137, s47, v26
    v_add_f32 v132, v132, v136
    v_add_f32 v133, v133, v137
    v_fmac_f32 v134, v136, v136
    v_mfma_f32_32x32x16_bf16 v[80:95], v[24:27], v[44:47], v[80:95]
    v_fmac_f32 v135, v137, v137
    v_lshlrev_b32 v138, 16, v27
    v_and_b32 v139, s47, v27
    v_add_f32 v132, v132, v138
    v_add_f32 v133, v133, v139
    v_fmac_f32 v134, v138, v138
    v_fmac_f32 v135, v139, v139
    v_mfma_f32_16x16x32_bf16 v[112:115], v[116:119], v[40:43], v[112:115]
    s_waitcnt lgkmcnt(0)
    v_mfma_f32_32x32x16_bf16 v[48:63], v[16:19], v[32:35], v[48:63]
    ds_read_b128 v[24:27], v9 offset:0
    ds_read_b64_tr_b16 v[40:41], v12 offset:4096
    ds_read_b64_tr_b16 v[42:43], v12 offset:5120
    v_lshlrev_b32 v136, 16, v16
    v_and_b32 v137, s47, v16
    v_add_f32 v132, v132, v136
    v_add_f32 v133, v133, v137
    v_fmac_f32 v134, v136, v136
    v_mfma_f32_32x32x16_bf16 v[64:79], v[20:23], v[32:35], v[64:79]
    ds_read_b128 v[28:31], v129 offset:0
    ds_read_b64_tr_b16 v[44:45], v13 offset:4096
    ds_read_b64_tr_b16 v[46:47], v13 offset:5120
    v_fmac_f32 v135, v137, v137
    v_lshlrev_b32 v138, 16, v17
    v_and_b32 v139, s47, v17
    v_add_f32 v132, v132, v138
    v_add_f32 v133, v133, v139
    v_mfma_f32_32x32x16_bf16 v[96:111], v[20:23], v[36:39], v[96:111]
    v_fmac_f32 v134, v138, v138
    v_fmac_f32 v135, v139, v139
    v_lshlrev_b32 v136, 16, v18
    v_and_b32 v137, s47, v18
    v_add_f32 v132, v132, v136
    v_add_f32 v133, v133, v137
    v_fmac_f32 v134, v136, v136
    v_mfma_f32_32x32x16_bf16 v[80:95], v[16:19], v[36:39], v[80:95]
    v_fmac_f32 v135, v137, v137
    v_lshlrev_b32 v138, 16, v19
    v_and_b32 v139, s47, v19
    v_add_f32 v132, v132, v138
    v_add_f32 v133, v133, v139
    v_fmac_f32 v134, v138, v138
    v_fmac_f32 v135, v139, v139
    v_mfma_f32_16x16x32_bf16 v[112:115], v[116:119], v[32:35], v[112:115]
    s_waitcnt lgkmcnt(0)
    v_mfma_f32_32x32x16_bf16 v[48:63], v[24:27], v[40:43], v[48:63]
    ds_read_b128 v[16:19], v10 offset:0
    ds_read_b64_tr_b16 v[32:33], v12 offset:8192
    ds_read_b64_tr_b16 v[34:35], v12 offset:9216
    v_lshlrev_b32 v136, 16, v24
    v_and_b32 v137, s47, v24
    v_add_f32 v132, v132, v136
    v_add_f32 v133, v133, v137
    v_fmac_f32 v134, v136, v136
    v_mfma_f32_32x32x16_bf16 v[64:79], v[28:31], v[40:43], v[64:79]
    ds_read_b128 v[20:23], v130 offset:0
    ds_read_b64_tr_b16 v[36:37], v13 offset:8192
    ds_read_b64_tr_b16 v[38:39], v13 offset:9216
    v_fmac_f32 v135, v137, v137
    v_lshlrev_b32 v138, 16, v25
    v_and_b32 v139, s47, v25
    v_add_f32 v132, v132, v138
    v_add_f32 v133, v133, v139
    v_mfma_f32_32x32x16_bf16 v[96:111], v[28:31], v[44:47], v[96:111]
    v_fmac_f32 v134, v138, v138
    v_fmac_f32 v135, v139, v139
    v_lshlrev_b32 v136, 16, v26
    v_and_b32 v137, s47, v26
    v_add_f32 v132, v132, v136
    v_add_f32 v133, v133, v137
    v_fmac_f32 v134, v136, v136
    v_mfma_f32_32x32x16_bf16 v[80:95], v[24:27], v[44:47], v[80:95]
    v_fmac_f32 v135, v137, v137
    v_lshlrev_b32 v138, 16, v27
    v_and_b32 v139, s47, v27
    v_add_f32 v132, v132, v138
    v_add_f32 v133, v133, v139
    v_fmac_f32 v134, v138, v138
    v_fmac_f32 v135, v139, v139
    v_mfma_f32_16x16x32_bf16 v[112:115], v[116:119], v[40:43], v[112:115]
    s_waitcnt lgkmcnt(0)
    v_mfma_f32_32x32x16_bf16 v[48:63], v[16:19], v[32:35], v[48:63]
    ds_read_b128 v[24:27], v11 offset:0
    ds_read_b64_tr_b16 v[40:41], v12 offset:12288
    ds_read_b64_tr_b16 v[42:43], v12 offset:13312
    v_lshlrev_b32 v136, 16, v16
    v_and_b32 v137, s47, v16
    v_add_f32 v132, v132, v136
    v_add_f32 v133, v133, v137
    v_fmac_f32 v134, v136, v136
    v_mfma_f32_32x32x16_bf16 v[64:79], v[20:23], v[32:35], v[64:79]
    ds_read_b128 v[28:31], v131 offset:0
    ds_read_b64_tr_b16 v[44:45], v13 offset:12288
    ds_read_b64_tr_b16 v[46:47], v13 offset:13312
    v_fmac_f32 v135, v137, v137
    v_lshlrev_b32 v138, 16, v17
    v_and_b32 v139, s47, v17
    v_add_f32 v132, v132, v138
    v_add_f32 v133, v133, v139
    v_mfma_f32_32x32x16_bf16 v[96:111], v[20:23], v[36:39], v[96:111]
    v_fmac_f32 v134, v138, v138
    v_fmac_f32 v135, v139, v139
    v_lshlrev_b32 v136, 16, v18
    v_and_b32 v137, s47, v18
    v_add_f32 v132, v132, v136
    v_add_f32 v133, v133, v137
    v_fmac_f32 v134, v136, v136
    v_mfma_f32_32x32x16_bf16 v[80:95], v[16:19], v[36:39], v[80:95]
    v_fmac_f32 v135, v137, v137
    v_lshlrev_b32 v138, 16, v19
    v_and_b32 v139, s47, v19
    v_add_f32 v132, v132, v138
    v_add_f32 v133, v133, v139
    v_fmac_f32 v134, v138, v138
    v_fmac_f32 v135, v139, v139
    v_mfma_f32_16x16x32_bf16 v[112:115], v[116:119], v[32:35], v[112:115]
    s_waitcnt lgkmcnt(0)
    v_mfma_f32_32x32x16_bf16 v[48:63], v[24:27], v[40:43], v[48:63]
    v_lshlrev_b32 v136, 16, v24
    v_and_b32 v137, s47, v24
    v_add_f32 v132, v132, v136
    v_add_f32 v133, v133, v137
    v_fmac_f32 v134, v136, v136
    v_fmac_f32 v135, v137, v137
    v_lshlrev_b32 v138, 16, v25
    v_and_b32 v139, s47, v25
    v_mfma_f32_32x32x16_bf16 v[64:79], v[28:31], v[40:43], v[64:79]
    s_barrier
    ds_read_b128 v[16:19], v8 offset:16384
    ds_read_b64_tr_b16 v[32:33], v12 offset:16384
    ds_read_b64_tr_b16 v[34:35], v12 offset:17408
    v_add_f32 v132, v132, v138
    v_add_f32 v133, v133, v139
    v_fmac_f32 v134, v138, v138
    v_fmac_f32 v135, v139, v139
    v_lshlrev_b32 v136, 16, v26
    v_mfma_f32_32x32x16_bf16 v[96:111], v[28:31], v[44:47], v[96:111]
    ds_read_b128 v[20:23], v128 offset:16384
    ds_read_b64_tr_b16 v[36:37], v13 offset:16384
    ds_read_b64_tr_b16 v[38:39], v13 offset:17408
    v_and_b32 v137, s47, v26
    v_add_f32 v132, v132, v136
    v_add_f32 v133, v133, v137
    v_fmac_f32 v134, v136, v136
    v_mfma_f32_32x32x16_bf16 v[80:95], v[24:27], v[44:47], v[80:95]
    v_fmac_f32 v135, v137, v137
    v_lshlrev_b32 v138, 16, v27
    v_and_b32 v139, s47, v27
    v_add_f32 v132, v132, v138
    v_add_f32 v133, v133, v139
    v_fmac_f32 v134, v138, v138
    v_fmac_f32 v135, v139, v139
    v_mfma_f32_16x16x32_bf16 v[112:115], v[116:119], v[40:43], v[112:115]
    s_waitcnt lgkmcnt(0)
    v_mfma_f32_32x32x16_bf16 v[48:63], v[16:19], v[32:35], v[48:63]
    ds_read_b128 v[24:27], v9 offset:16384
    ds_read_b64_tr_b16 v[40:41], v12 offset:20480
    ds_read_b64_tr_b16 v[42:43], v12 offset:21504
    v_lshlrev_b32 v136, 16, v16
    v_and_b32 v137, s47, v16
    v_add_f32 v132, v132, v136
    v_add_f32 v133, v133, v137
    v_fmac_f32 v134, v136, v136
    v_mfma_f32_32x32x16_bf16 v[64:79], v[20:23], v[32:35], v[64:79]
    ds_read_b128 v[28:31], v129 offset:16384
    ds_read_b64_tr_b16 v[44:45], v13 offset:20480
    ds_read_b64_tr_b16 v[46:47], v13 offset:21504
    v_fmac_f32 v135, v137, v137
    v_lshlrev_b32 v138, 16, v17
    v_and_b32 v139, s47, v17
    v_add_f32 v132, v132, v138
    v_add_f32 v133, v133, v139
    v_mfma_f32_32x32x16_bf16 v[96:111], v[20:23], v[36:39], v[96:111]
    v_fmac_f32 v134, v138, v138
    v_fmac_f32 v135, v139, v139
    v_lshlrev_b32 v136, 16, v18
    v_and_b32 v137, s47, v18
    v_add_f32 v132, v132, v136
    v_add_f32 v133, v133, v137
    v_fmac_f32 v134, v136, v136
    v_mfma_f32_32x32x16_bf16 v[80:95], v[16:19], v[36:39], v[80:95]
    v_fmac_f32 v135, v137, v137
    v_lshlrev_b32 v138, 16, v19
    v_and_b32 v139, s47, v19
    v_add_f32 v132, v132, v138
    v_add_f32 v133, v133, v139
    v_fmac_f32 v134, v138, v138
    v_fmac_f32 v135, v139, v139
    v_mfma_f32_16x16x32_bf16 v[112:115], v[116:119], v[32:35], v[112:115]
    s_waitcnt lgkmcnt(0)
    v_mfma_f32_32x32x16_bf16 v[48:63], v[24:27], v[40:43], v[48:63]
    ds_read_b128 v[16:19], v10 offset:16384
    ds_read_b64_tr_b16 v[32:33], v12 offset:24576
    ds_read_b64_tr_b16 v[34:35], v12 offset:25600
    v_lshlrev_b32 v136, 16, v24
    v_and_b32 v137, s47, v24
    v_add_f32 v132, v132, v136
    v_add_f32 v133, v133, v137
    v_fmac_f32 v134, v136, v136
    v_mfma_f32_32x32x16_bf16 v[64:79], v[28:31], v[40:43], v[64:79]
    ds_read_b128 v[20:23], v130 offset:16384
    ds_read_b64_tr_b16 v[36:37], v13 offset:24576
    ds_read_b64_tr_b16 v[38:39], v13 offset:25600
    v_fmac_f32 v135, v137, v137
    v_lshlrev_b32 v138, 16, v25
    v_and_b32 v139, s47, v25
    v_add_f32 v132, v132, v138
    v_add_f32 v133, v133, v139
    v_mfma_f32_32x32x16_bf16 v[96:111], v[28:31], v[44:47], v[96:111]
    v_fmac_f32 v134, v138, v138
    v_fmac_f32 v135, v139, v139
    v_lshlrev_b32 v136, 16, v26
    v_and_b32 v137, s47, v26
    v_add_f32 v132, v132, v136
    v_add_f32 v133, v133, v137
    v_fmac_f32 v134, v136, v136
    v_mfma_f32_32x32x16_bf16 v[80:95], v[24:27], v[44:47], v[80:95]
    v_fmac_f32 v135, v137, v137
    v_lshlrev_b32 v138, 16, v27
    v_and_b32 v139, s47, v27
    v_add_f32 v132, v132, v138
    v_add_f32 v133, v133, v139
    v_fmac_f32 v134, v138, v138
    v_fmac_f32 v135, v139, v139
    v_mfma_f32_16x16x32_bf16 v[112:115], v[116:119], v[40:43], v[112:115]
    s_waitcnt lgkmcnt(0)
    v_mfma_f32_32x32x16_bf16 v[48:63], v[16:19], v[32:35], v[48:63]
    ds_read_b128 v[24:27], v11 offset:16384
    ds_read_b64_tr_b16 v[40:41], v12 offset:28672
    ds_read_b64_tr_b16 v[42:43], v12 offset:29696
    v_lshlrev_b32 v136, 16, v16
    v_and_b32 v137, s47, v16
    v_add_f32 v132, v132, v136
    v_add_f32 v133, v133, v137
    v_fmac_f32 v134, v136, v136
    v_mfma_f32_32x32x16_bf16 v[64:79], v[20:23], v[32:35], v[64:79]
    ds_read_b128 v[28:31], v131 offset:16384
    ds_read_b64_tr_b16 v[44:45], v13 offset:28672
    ds_read_b64_tr_b16 v[46:47], v13 offset:29696
    v_fmac_f32 v135, v137, v137
    v_lshlrev_b32 v138, 16, v17
    v_and_b32 v139, s47, v17
    v_add_f32 v132, v132, v138
    v_add_f32 v133, v133, v139
    v_mfma_f32_32x32x16_bf16 v[96:111], v[20:23], v[36:39], v[96:111]
    v_fmac_f32 v134, v138, v138
    v_fmac_f32 v135, v139, v139
    v_lshlrev_b32 v136, 16, v18
    v_and_b32 v137, s47, v18
    v_add_f32 v132, v132, v136
    v_add_f32 v133, v133, v137
    v_fmac_f32 v134, v136, v136
    v_mfma_f32_32x32x16_bf16 v[80:95], v[16:19], v[36:39], v[80:95]
    v_fmac_f32 v135, v137, v137
    v_lshlrev_b32 v138, 16, v19
    v_and_b32 v139, s47, v19
    v_add_f32 v132, v132, v138
    v_add_f32 v133, v133, v139
    v_fmac_f32 v134, v138, v138
    v_fmac_f32 v135, v139, v139
    v_mfma_f32_16x16x32_bf16 v[112:115], v[116:119], v[32:35], v[112:115]
    s_waitcnt lgkmcnt(0)
    v_mfma_f32_32x32x16_bf16 v[48:63], v[24:27], v[40:43], v[48:63]
    v_lshlrev_b32 v136, 16, v24
    v_and_b32 v137, s47, v24
    v_add_f32 v132, v132, v136
    v_add_f32 v133, v133, v137
    v_fmac_f32 v134, v136, v136
    v_fmac_f32 v135, v137, v137
    v_lshlrev_b32 v138, 16, v25
    v_and_b32 v139, s47, v25
    v_mfma_f32_32x32x16_bf16 v[64:79], v[28:31], v[40:43], v[64:79]
    s_barrier
    ds_read_b128 v[16:19], v8 offset:32768
    ds_read_b64_tr_b16 v[32:33], v12 offset:32768
    ds_read_b64_tr_b16 v[34:35], v12 offset:33792
    v_add_f32 v132, v132, v138
    v_add_f32 v133, v133, v139
    v_fmac_f32 v134, v138, v138
    v_fmac_f32 v135, v139, v139
    v_lshlrev_b32 v136, 16, v26
    v_mfma_f32_32x32x16_bf16 v[96:111], v[28:31], v[44:47], v[96:111]
    ds_read_b128 v[20:23], v128 offset:32768
    ds_read_b64_tr_b16 v[36:37], v13 offset:32768
    ds_read_b64_tr_b16 v[38:39], v13 offset:33792
    v_and_b32 v137, s47, v26
    v_add_f32 v132, v132, v136
    v_add_f32 v133, v133, v137
    v_fmac_f32 v134, v136, v136
    v_mfma_f32_32x32x16_bf16 v[80:95], v[24:27], v[44:47], v[80:95]
    v_fmac_f32 v135, v137, v137
    v_lshlrev_b32 v138, 16, v27
    v_and_b32 v139, s47, v27
    v_add_f32 v132, v132, v138
    v_add_f32 v133, v133, v139
    v_fmac_f32 v134, v138, v138
    v_fmac_f32 v135, v139, v139
    v_mfma_f32_16x16x32_bf16 v[112:115], v[116:119], v[40:43], v[112:115]
    s_waitcnt lgkmcnt(0)
    v_mfma_f32_32x32x16_bf16 v[48:63], v[16:19], v[32:35], v[48:63]
    ds_read_b128 v[24:27], v9 offset:32768
    ds_read_b64_tr_b16 v[40:41], v12 offset:36864
    ds_read_b64_tr_b16 v[42:43], v12 offset:37888
    v_lshlrev_b32 v136, 16, v16
    v_and_b32 v137, s47, v16
    v_add_f32 v132, v132, v136
    v_add_f32 v133, v133, v137
    v_fmac_f32 v134, v136, v136
    v_mfma_f32_32x32x16_bf16 v[64:79], v[20:23], v[32:35], v[64:79]
    ds_read_b128 v[28:31], v129 offset:32768
    ds_read_b64_tr_b16 v[44:45], v13 offset:36864
    ds_read_b64_tr_b16 v[46:47], v13 offset:37888
    v_fmac_f32 v135, v137, v137
    v_lshlrev_b32 v138, 16, v17
    v_and_b32 v139, s47, v17
    v_add_f32 v132, v132, v138
    v_add_f32 v133, v133, v139
    v_mfma_f32_32x32x16_bf16 v[96:111], v[20:23], v[36:39], v[96:111]
    v_fmac_f32 v134, v138, v138
    v_fmac_f32 v135, v139, v139
    v_lshlrev_b32 v136, 16, v18
    v_and_b32 v137, s47, v18
    v_add_f32 v132, v132, v136
    v_add_f32 v133, v133, v137
    v_fmac_f32 v134, v136, v136
    v_mfma_f32_32x32x16_bf16 v[80:95], v[16:19], v[36:39], v[80:95]
    v_fmac_f32 v135, v137, v137
    v_lshlrev_b32 v138, 16, v19
    v_and_b32 v139, s47, v19
    v_add_f32 v132, v132, v138
    v_add_f32 v133, v133, v139
    v_fmac_f32 v134, v138, v138
    v_fmac_f32 v135, v139, v139
    v_mfma_f32_16x16x32_bf16 v[112:115], v[116:119], v[32:35], v[112:115]
    s_waitcnt lgkmcnt(0)
    v_mfma_f32_32x32x16_bf16 v[48:63], v[24:27], v[40:43], v[48:63]
    ds_read_b128 v[16:19], v10 offset:32768
    ds_read_b64_tr_b16 v[32:33], v12 offset:40960
    ds_read_b64_tr_b16 v[34:35], v12 offset:41984
    v_lshlrev_b32 v136, 16, v24
    v_and_b32 v137, s47, v24
    v_add_f32 v132, v132, v136
    v_add_f32 v133, v133, v137
    v_fmac_f32 v134, v136, v136
    v_mfma_f32_32x32x16_bf16 v[64:79], v[28:31], v[40:43], v[64:79]
    ds_read_b128 v[20:23], v130 offset:32768
    ds_read_b64_tr_b16 v[36:37], v13 offset:40960
    ds_read_b64_tr_b16 v[38:39], v13 offset:41984
    v_fmac_f32 v135, v137, v137
    v_lshlrev_b32 v138, 16, v25
    v_and_b32 v139, s47, v25
    v_add_f32 v132, v132, v138
    v_add_f32 v133, v133, v139
    v_mfma_f32_32x32x16_bf16 v[96:111], v[28:31], v[44:47], v[96:111]
    v_fmac_f32 v134, v138, v138
    v_fmac_f32 v135, v139, v139
    v_lshlrev_b32 v136, 16, v26
    v_and_b32 v137, s47, v26
    v_add_f32 v132, v132, v136
    v_add_f32 v133, v133, v137
    v_fmac_f32 v134, v136, v136
    v_mfma_f32_32x32x16_bf16 v[80:95], v[24:27], v[44:47], v[80:95]
    v_fmac_f32 v135, v137, v137
    v_lshlrev_b32 v138, 16, v27
    v_and_b32 v139, s47, v27
    v_add_f32 v132, v132, v138
    v_add_f32 v133, v133, v139
    v_fmac_f32 v134, v138, v138
    v_fmac_f32 v135, v139, v139
    v_mfma_f32_16x16x32_bf16 v[112:115], v[116:119], v[40:43], v[112:115]
    s_waitcnt lgkmcnt(0)
    v_mfma_f32_32x32x16_bf16 v[48:63], v[16:19], v[32:35], v[48:63]
    ds_read_b128 v[24:27], v11 offset:32768
    ds_read_b64_tr_b16 v[40:41], v12 offset:45056
    ds_read_b64_tr_b16 v[42:43], v12 offset:46080
    v_lshlrev_b32 v136, 16, v16
    v_and_b32 v137, s47, v16
    v_add_f32 v132, v132, v136
    v_add_f32 v133, v133, v137
    v_fmac_f32 v134, v136, v136
    v_mfma_f32_32x32x16_bf16 v[64:79], v[20:23], v[32:35], v[64:79]
    ds_read_b128 v[28:31], v131 offset:32768
    ds_read_b64_tr_b16 v[44:45], v13 offset:45056
    ds_read_b64_tr_b16 v[46:47], v13 offset:46080
    v_fmac_f32 v135, v137, v137
    v_lshlrev_b32 v138, 16, v17
    v_and_b32 v139, s47, v17
    v_add_f32 v132, v132, v138
    v_add_f32 v133, v133, v139
    v_mfma_f32_32x32x16_bf16 v[96:111], v[20:23], v[36:39], v[96:111]
    v_fmac_f32 v134, v138, v138
    v_fmac_f32 v135, v139, v139
    v_lshlrev_b32 v136, 16, v18
    v_and_b32 v137, s47, v18
    v_add_f32 v132, v132, v136
    v_add_f32 v133, v133, v137
    v_fmac_f32 v134, v136, v136
    v_mfma_f32_32x32x16_bf16 v[80:95], v[16:19], v[36:39], v[80:95]
    v_fmac_f32 v135, v137, v137
    v_lshlrev_b32 v138, 16, v19
    v_and_b32 v139, s47, v19
    v_add_f32 v132, v132, v138
    v_add_f32 v133, v133, v139
    v_fmac_f32 v134, v138, v138
    v_fmac_f32 v135, v139, v139
    v_mfma_f32_16x16x32_bf16 v[112:115], v[116:119], v[32:35], v[112:115]
    s_waitcnt lgkmcnt(0)
    v_mfma_f32_32x32x16_bf16 v[48:63], v[24:27], v[40:43], v[48:63]
    v_lshlrev_b32 v136, 16, v24
    v_and_b32 v137, s47, v24
    v_add_f32 v132, v132, v136
    v_add_f32 v133, v133, v137
    v_fmac_f32 v134, v136, v136
    v_fmac_f32 v135, v137, v137
    v_lshlrev_b32 v138, 16, v25
    v_and_b32 v139, s47, v25
    v_mfma_f32_32x32x16_bf16 v[64:79], v[28:31], v[40:43], v[64:79]
    s_barrier
    ds_read_b128 v[16:19], v8 offset:49152
    ds_read_b64_tr_b16 v[32:33], v12 offset:49152
    ds_read_b64_tr_b16 v[34:35], v12 offset:50176
    v_add_f32 v132, v132, v138
    v_add_f32 v133, v133, v139
    v_fmac_f32 v134, v138, v138
    v_fmac_f32 v135, v139, v139
    v_lshlrev_b32 v136, 16, v26
    v_mfma_f32_32x32x16_bf16 v[96:111], v[28:31], v[44:47], v[96:111]
    ds_read_b128 v[20:23], v128 offset:49152
    ds_read_b64_tr_b16 v[36:37], v13 offset:49152
    ds_read_b64_tr_b16 v[38:39], v13 offset:50176
    v_and_b32 v137, s47, v26
    v_add_f32 v132, v132, v136
    v_add_f32 v133, v133, v137
    v_fmac_f32 v134, v136, v136
    v_mfma_f32_32x32x16_bf16 v[80:95], v[24:27], v[44:47], v[80:95]
    v_fmac_f32 v135, v137, v137
    v_lshlrev_b32 v138, 16, v27
    v_and_b32 v139, s47, v27
    v_add_f32 v132, v132, v138
    v_add_f32 v133, v133, v139
    v_fmac_f32 v134, v138, v138
    v_fmac_f32 v135, v139, v139
    v_mfma_f32_16x16x32_bf16 v[112:115], v[116:119], v[40:43], v[112:115]
    s_waitcnt lgkmcnt(0)
    v_mfma_f32_32x32x16_bf16 v[48:63], v[16:19], v[32:35], v[48:63]
    ds_read_b128 v[24:27], v9 offset:49152
    ds_read_b64_tr_b16 v[40:41], v12 offset:53248
    ds_read_b64_tr_b16 v[42:43], v12 offset:54272
    v_lshlrev_b32 v136, 16, v16
    v_and_b32 v137, s47, v16
    v_add_f32 v132, v132, v136
    v_add_f32 v133, v133, v137
    v_fmac_f32 v134, v136, v136
    v_mfma_f32_32x32x16_bf16 v[64:79], v[20:23], v[32:35], v[64:79]
    ds_read_b128 v[28:31], v129 offset:49152
    ds_read_b64_tr_b16 v[44:45], v13 offset:53248
    ds_read_b64_tr_b16 v[46:47], v13 offset:54272
    v_fmac_f32 v135, v137, v137
    v_lshlrev_b32 v138, 16, v17
    v_and_b32 v139, s47, v17
    v_add_f32 v132, v132, v138
    v_add_f32 v133, v133, v139
    v_mfma_f32_32x32x16_bf16 v[96:111], v[20:23], v[36:39], v[96:111]
    v_fmac_f32 v134, v138, v138
    v_fmac_f32 v135, v139, v139
    v_lshlrev_b32 v136, 16, v18
    v_and_b32 v137, s47, v18
    v_add_f32 v132, v132, v136
    v_add_f32 v133, v133, v137
    v_fmac_f32 v134, v136, v136
    v_mfma_f32_32x32x16_bf16 v[80:95], v[16:19], v[36:39], v[80:95]
    v_fmac_f32 v135, v137, v137
    v_lshlrev_b32 v138, 16, v19
    v_and_b32 v139, s47, v19
    v_add_f32 v132, v132, v138
    v_add_f32 v133, v133, v139
    v_fmac_f32 v134, v138, v138
    v_fmac_f32 v135, v139, v139
    v_mfma_f32_16x16x32_bf16 v[112:115], v[116:119], v[32:35], v[112:115]
    s_waitcnt lgkmcnt(0)
    v_mfma_f32_32x32x16_bf16 v[48:63], v[24:27], v[40:43], v[48:63]
    ds_read_b128 v[16:19], v10 offset:49152
    ds_read_b64_tr_b16 v[32:33], v12 offset:57344
    ds_read_b64_tr_b16 v[34:35], v12 offset:58368
    v_lshlrev_b32 v136, 16, v24
    v_and_b32 v137, s47, v24
    v_add_f32 v132, v132, v136
    v_add_f32 v133, v133, v137
    v_fmac_f32 v134, v136, v136
    v_mfma_f32_32x32x16_bf16 v[64:79], v[28:31], v[40:43], v[64:79]
    ds_read_b128 v[20:23], v130 offset:49152
    ds_read_b64_tr_b16 v[36:37], v13 offset:57344
    ds_read_b64_tr_b16 v[38:39], v13 offset:58368
    v_fmac_f32 v135, v137, v137
    v_lshlrev_b32 v138, 16, v25
    v_and_b32 v139, s47, v25
    v_add_f32 v132, v132, v138
    v_add_f32 v133, v133, v139
    v_mfma_f32_32x32x16_bf16 v[96:111], v[28:31], v[44:47], v[96:111]
    v_fmac_f32 v134, v138, v138
    v_fmac_f32 v135, v139, v139
    v_lshlrev_b32 v136, 16, v26
    v_and_b32 v137, s47, v26
    v_add_f32 v132, v132, v136
    v_add_f32 v133, v133, v137
    v_fmac_f32 v134, v136, v136
    v_mfma_f32_32x32x16_bf16 v[80:95], v[24:27], v[44:47], v[80:95]
    v_fmac_f32 v135, v137, v137
    v_lshlrev_b32 v138, 16, v27
    v_and_b32 v139, s47, v27
    v_add_f32 v132, v132, v138
    v_add_f32 v133, v133, v139
    v_fmac_f32 v134, v138, v138
    v_fmac_f32 v135, v139, v139
    v_mfma_f32_16x16x32_bf16 v[112:115], v[116:119], v[40:43], v[112:115]
    s_waitcnt lgkmcnt(0)
    v_mfma_f32_32x32x16_bf16 v[48:63], v[16:19], v[32:35], v[48:63]
    ds_read_b128 v[24:27], v11 offset:49152
    ds_read_b64_tr_b16 v[40:41], v12 offset:61440
    ds_read_b64_tr_b16 v[42:43], v12 offset:62464
    v_lshlrev_b32 v136, 16, v16
    v_and_b32 v137, s47, v16
    v_add_f32 v132, v132, v136
    v_add_f32 v133, v133, v137
    v_fmac_f32 v134, v136, v136
    v_mfma_f32_32x32x16_bf16 v[64:79], v[20:23], v[32:35], v[64:79]
    ds_read_b128 v[28:31], v131 offset:49152
    ds_read_b64_tr_b16 v[44:45], v13 offset:61440
    ds_read_b64_tr_b16 v[46:47], v13 offset:62464
    v_fmac_f32 v135, v137, v137
    v_lshlrev_b32 v138, 16, v17
    v_and_b32 v139, s47, v17
    v_add_f32 v132, v132, v138
    v_add_f32 v133, v133, v139
    v_mfma_f32_32x32x16_bf16 v[96:111], v[20:23], v[36:39], v[96:111]
    v_fmac_f32 v134, v138, v138
    v_fmac_f32 v135, v139, v139
    v_lshlrev_b32 v136, 16, v18
    v_and_b32 v137, s47, v18
    v_add_f32 v132, v132, v136
    v_add_f32 v133, v133, v137
    v_fmac_f32 v134, v136, v136
    v_mfma_f32_32x32x16_bf16 v[80:95], v[16:19], v[36:39], v[80:95]
    v_fmac_f32 v135, v137, v137
    v_lshlrev_b32 v138, 16, v19
    v_and_b32 v139, s47, v19
    v_add_f32 v132, v132, v138
    v_add_f32 v133, v133, v139
    v_fmac_f32 v134, v138, v138
    v_fmac_f32 v135, v139, v139
    v_mfma_f32_16x16x32_bf16 v[112:115], v[116:119], v[32:35], v[112:115]
    s_waitcnt lgkmcnt(0)
    v_mfma_f32_32x32x16_bf16 v[48:63], v[24:27], v[40:43], v[48:63]
    v_lshlrev_b32 v136, 16, v24
    v_and_b32 v137, s47, v24
    v_add_f32 v132, v132, v136
    v_add_f32 v133, v133, v137
    v_fmac_f32 v134, v136, v136
    v_fmac_f32 v135, v137, v137
    v_lshlrev_b32 v138, 16, v25
    v_and_b32 v139, s47, v25
    v_mfma_f32_32x32x16_bf16 v[64:79], v[28:31], v[40:43], v[64:79]
    s_barrier
    ds_read_b128 v[16:19], v8 offset:0
    ds_read_b64_tr_b16 v[32:33], v12 offset:0
    ds_read_b64_tr_b16 v[34:35], v12 offset:1024
    v_add_f32 v132, v132, v138
    v_add_f32 v133, v133, v139
    v_fmac_f32 v134, v138, v138
    v_fmac_f32 v135, v139, v139
    v_lshlrev_b32 v136, 16, v26
    v_mfma_f32_32x32x16_bf16 v[96:111], v[28:31], v[44:47], v[96:111]
    ds_read_b128 v[20:23], v128 offset:0
    ds_read_b64_tr_b16 v[36:37], v13 offset:0
    ds_read_b64_tr_b16 v[38:39], v13 offset:1024
    v_and_b32 v137, s47, v26
    v_add_f32 v132, v132, v136
    v_add_f32 v133, v133, v137
    v_fmac_f32 v134, v136, v136
    v_mfma_f32_32x32x16_bf16 v[80:95], v[24:27], v[44:47], v[80:95]
    v_fmac_f32 v135, v137, v137
    v_lshlrev_b32 v138, 16, v27
    v_and_b32 v139, s47, v27
    v_add_f32 v132, v132, v138
    v_add_f32 v133, v133, v139
    v_fmac_f32 v134, v138, v138
    v_fmac_f32 v135, v139, v139
    v_mfma_f32_16x16x32_bf16 v[112:115], v[116:119], v[40:43], v[112:115]
    s_waitcnt lgkmcnt(0)
    v_mfma_f32_32x32x16_bf16 v[48:63], v[16:19], v[32:35], v[48:63]
    ds_read_b128 v[24:27], v9 offset:0
    ds_read_b64_tr_b16 v[40:41], v12 offset:4096
    ds_read_b64_tr_b16 v[42:43], v12 offset:5120
    v_lshlrev_b32 v136, 16, v16
    v_and_b32 v137, s47, v16
    v_add_f32 v132, v132, v136
    v_add_f32 v133, v133, v137
    v_fmac_f32 v134, v136, v136
    v_mfma_f32_32x32x16_bf16 v[64:79], v[20:23], v[32:35], v[64:79]
    ds_read_b128 v[28:31], v129 offset:0
    ds_read_b64_tr_b16 v[44:45], v13 offset:4096
    ds_read_b64_tr_b16 v[46:47], v13 offset:5120
    v_fmac_f32 v135, v137, v137
    v_lshlrev_b32 v138, 16, v17
    v_and_b32 v139, s47, v17
    v_add_f32 v132, v132, v138
    v_add_f32 v133, v133, v139
    v_mfma_f32_32x32x16_bf16 v[96:111], v[20:23], v[36:39], v[96:111]
    v_fmac_f32 v134, v138, v138
    v_fmac_f32 v135, v139, v139
    v_lshlrev_b32 v136, 16, v18
    v_and_b32 v137, s47, v18
    v_add_f32 v132, v132, v136
    v_add_f32 v133, v133, v137
    v_fmac_f32 v134, v136, v136
    v_mfma_f32_32x32x16_bf16 v[80:95], v[16:19], v[36:39], v[80:95]
    v_fmac_f32 v135, v137, v137
    v_lshlrev_b32 v138, 16, v19
    v_and_b32 v139, s47, v19
    v_add_f32 v132, v132, v138
    v_add_f32 v133, v133, v139
    v_fmac_f32 v134, v138, v138
    v_fmac_f32 v135, v139, v139
    v_mfma_f32_16x16x32_bf16 v[112:115], v[116:119], v[32:35], v[112:115]
    s_waitcnt lgkmcnt(0)
    v_mfma_f32_32x32x16_bf16 v[48:63], v[24:27], v[40:43], v[48:63]
    ds_read_b128 v[16:19], v10 offset:0
    ds_read_b64_tr_b16 v[32:33], v12 offset:8192
    ds_read_b64_tr_b16 v[34:35], v12 offset:9216
    v_lshlrev_b32 v136, 16, v24
    v_and_b32 v137, s47, v24
    v_add_f32 v132, v132, v136
    v_add_f32 v133, v133, v137
    v_fmac_f32 v134, v136, v136
    v_mfma_f32_32x32x16_bf16 v[64:79], v[28:31], v[40:43], v[64:79]
    ds_read_b128 v[20:23], v130 offset:0
    ds_read_b64_tr_b16 v[36:37], v13 offset:8192
    ds_read_b64_tr_b16 v[38:39], v13 offset:9216
    v_fmac_f32 v135, v137, v137
    v_lshlrev_b32 v138, 16, v25
    v_and_b32 v139, s47, v25
    v_add_f32 v132, v132, v138
    v_add_f32 v133, v133, v139
    v_mfma_f32_32x32x16_bf16 v[96:111], v[28:31], v[44:47], v[96:111]
    v_fmac_f32 v134, v138, v138
    v_fmac_f32 v135, v139, v139
    v_lshlrev_b32 v136, 16, v26
    v_and_b32 v137, s47, v26
    v_add_f32 v132, v132, v136
    v_add_f32 v133, v133, v137
    v_fmac_f32 v134, v136, v136
    v_mfma_f32_32x32x16_bf16 v[80:95], v[24:27], v[44:47], v[80:95]
    v_fmac_f32 v135, v137, v137
    v_lshlrev_b32 v138, 16, v27
    v_and_b32 v139, s47, v27
    v_add_f32 v132, v132, v138
    v_add_f32 v133, v133, v139
    v_fmac_f32 v134, v138, v138
    v_fmac_f32 v135, v139, v139
    v_mfma_f32_16x16x32_bf16 v[112:115], v[116:119], v[40:43], v[112:115]
    s_waitcnt lgkmcnt(0)
    v_mfma_f32_32x32x16_bf16 v[48:63], v[16:19], v[32:35], v[48:63]
    ds_read_b128 v[24:27], v11 offset:0
    ds_read_b64_tr_b16 v[40:41], v12 offset:12288
    ds_read_b64_tr_b16 v[42:43], v12 offset:13312
    v_lshlrev_b32 v136, 16, v16
    v_and_b32 v137, s47, v16
    v_add_f32 v132, v132, v136
    v_add_f32 v133, v133, v137
    v_fmac_f32 v134, v136, v136
    v_mfma_f32_32x32x16_bf16 v[64:79], v[20:23], v[32:35], v[64:79]
    ds_read_b128 v[28:31], v131 offset:0
    ds_read_b64_tr_b16 v[44:45], v13 offset:12288
    ds_read_b64_tr_b16 v[46:47], v13 offset:13312
    v_fmac_f32 v135, v137, v137
    v_lshlrev_b32 v138, 16, v17
    v_and_b32 v139, s47, v17
    v_add_f32 v132, v132, v138
    v_add_f32 v133, v133, v139
    v_mfma_f32_32x32x16_bf16 v[96:111], v[20:23], v[36:39], v[96:111]
    v_fmac_f32 v134, v138, v138
    v_fmac_f32 v135, v139, v139
    v_lshlrev_b32 v136, 16, v18
    v_and_b32 v137, s47, v18
    v_add_f32 v132, v132, v136
    v_add_f32 v133, v133, v137
    v_fmac_f32 v134, v136, v136
    v_mfma_f32_32x32x16_bf16 v[80:95], v[16:19], v[36:39], v[80:95]
    v_fmac_f32 v135, v137, v137
    v_lshlrev_b32 v138, 16, v19
    v_and_b32 v139, s47, v19
    v_add_f32 v132, v132, v138
    v_add_f32 v133, v133, v139
    v_fmac_f32 v134, v138, v138
    v_fmac_f32 v135, v139, v139
    v_mfma_f32_16x16x32_bf16 v[112:115], v[116:119], v[32:35], v[112:115]
    s_waitcnt lgkmcnt(0)
    v_mfma_f32_32x32x16_bf16 v[48:63], v[24:27], v[40:43], v[48:63]
    v_lshlrev_b32 v136, 16, v24
    v_and_b32 v137, s47, v24
    v_add_f32 v132, v132, v136
    v_add_f32 v133, v133, v137
    v_fmac_f32 v134, v136, v136
    v_fmac_f32 v135, v137, v137
    v_lshlrev_b32 v138, 16, v25
    v_and_b32 v139, s47, v25
    v_mfma_f32_32x32x16_bf16 v[64:79], v[28:31], v[40:43], v[64:79]
    s_barrier
    ds_read_b128 v[16:19], v8 offset:16384
    ds_read_b64_tr_b16 v[32:33], v12 offset:16384
    ds_read_b64_tr_b16 v[34:35], v12 offset:17408
    v_add_f32 v132, v132, v138
    v_add_f32 v133, v133, v139
    v_fmac_f32 v134, v138, v138
    v_fmac_f32 v135, v139, v139
    v_lshlrev_b32 v136, 16, v26
    v_mfma_f32_32x32x16_bf16 v[96:111], v[28:31], v[44:47], v[96:111]
    ds_read_b128 v[20:23], v128 offset:16384
    ds_read_b64_tr_b16 v[36:37], v13 offset:16384
    ds_read_b64_tr_b16 v[38:39], v13 offset:17408
    v_and_b32 v137, s47, v26
    v_add_f32 v132, v132, v136
    v_add_f32 v133, v133, v137
    v_fmac_f32 v134, v136, v136
    v_mfma_f32_32x32x16_bf16 v[80:95], v[24:27], v[44:47], v[80:95]
    v_fmac_f32 v135, v137, v137
    v_lshlrev_b32 v138, 16, v27
    v_and_b32 v139, s47, v27
    v_add_f32 v132, v132, v138
    v_add_f32 v133, v133, v139
    v_fmac_f32 v134, v138, v138
    v_fmac_f32 v135, v139, v139
    v_mfma_f32_16x16x32_bf16 v[112:115], v[116:119], v[40:43], v[112:115]
    s_waitcnt lgkmcnt(0)
    v_mfma_f32_32x32x16_bf16 v[48:63], v[16:19], v[32:35], v[48:63]
    ds_read_b128 v[24:27], v9 offset:16384
    ds_read_b64_tr_b16 v[40:41], v12 offset:20480
    ds_read_b64_tr_b16 v[42:43], v12 offset:21504
    v_lshlrev_b32 v136, 16, v16
    v_and_b32 v137, s47, v16
    v_add_f32 v132, v132, v136
    v_add_f32 v133, v133, v137
    v_fmac_f32 v134, v136, v136
    v_mfma_f32_32x32x16_bf16 v[64:79], v[20:23], v[32:35], v[64:79]
    ds_read_b128 v[28:31], v129 offset:16384
    ds_read_b64_tr_b16 v[44:45], v13 offset:20480
    ds_read_b64_tr_b16 v[46:47], v13 offset:21504
    v_fmac_f32 v135, v137, v137
    v_lshlrev_b32 v138, 16, v17
    v_and_b32 v139, s47, v17
    v_add_f32 v132, v132, v138
    v_add_f32 v133, v133, v139
    v_mfma_f32_32x32x16_bf16 v[96:111], v[20:23], v[36:39], v[96:111]
    v_fmac_f32 v134, v138, v138
    v_fmac_f32 v135, v139, v139
    v_lshlrev_b32 v136, 16, v18
    v_and_b32 v137, s47, v18
    v_add_f32 v132, v132, v136
    v_add_f32 v133, v133, v137
    v_fmac_f32 v134, v136, v136
    v_mfma_f32_32x32x16_bf16 v[80:95], v[16:19], v[36:39], v[80:95]
    v_fmac_f32 v135, v137, v137
    v_lshlrev_b32 v138, 16, v19
    v_and_b32 v139, s47, v19
    v_add_f32 v132, v132, v138
    v_add_f32 v133, v133, v139
    v_fmac_f32 v134, v138, v138
    v_fmac_f32 v135, v139, v139
    v_mfma_f32_16x16x32_bf16 v[112:115], v[116:119], v[32:35], v[112:115]
    s_waitcnt lgkmcnt(0)
    v_mfma_f32_32x32x16_bf16 v[48:63], v[24:27], v[40:43], v[48:63]
    ds_read_b128 v[16:19], v10 offset:16384
    ds_read_b64_tr_b16 v[32:33], v12 offset:24576
    ds_read_b64_tr_b16 v[34:35], v12 offset:25600
    v_lshlrev_b32 v136, 16, v24
    v_and_b32 v137, s47, v24
    v_add_f32 v132, v132, v136
    v_add_f32 v133, v133, v137
    v_fmac_f32 v134, v136, v136
    v_mfma_f32_32x32x16_bf16 v[64:79], v[28:31], v[40:43], v[64:79]
    ds_read_b128 v[20:23], v130 offset:16384
    ds_read_b64_tr_b16 v[36:37], v13 offset:24576
    ds_read_b64_tr_b16 v[38:39], v13 offset:25600
    v_fmac_f32 v135, v137, v137
    v_lshlrev_b32 v138, 16, v25
    v_and_b32 v139, s47, v25
    v_add_f32 v132, v132, v138
    v_add_f32 v133, v133, v139
    v_mfma_f32_32x32x16_bf16 v[96:111], v[28:31], v[44:47], v[96:111]
    v_fmac_f32 v134, v138, v138
    v_fmac_f32 v135, v139, v139
    v_lshlrev_b32 v136, 16, v26
    v_and_b32 v137, s47, v26
    v_add_f32 v132, v132, v136
    v_add_f32 v133, v133, v137
    v_fmac_f32 v134, v136, v136
    v_mfma_f32_32x32x16_bf16 v[80:95], v[24:27], v[44:47], v[80:95]
    v_fmac_f32 v135, v137, v137
    v_lshlrev_b32 v138, 16, v27
    v_and_b32 v139, s47, v27
    v_add_f32 v132, v132, v138
    v_add_f32 v133, v133, v139
    v_fmac_f32 v134, v138, v138
    v_fmac_f32 v135, v139, v139
    v_mfma_f32_16x16x32_bf16 v[112:115], v[116:119], v[40:43], v[112:115]
    s_waitcnt lgkmcnt(0)
    v_mfma_f32_32x32x16_bf16 v[48:63], v[16:19], v[32:35], v[48:63]
    ds_read_b128 v[24:27], v11 offset:16384
    ds_read_b64_tr_b16 v[40:41], v12 offset:28672
    ds_read_b64_tr_b16 v[42:43], v12 offset:29696
    v_lshlrev_b32 v136, 16, v16
    v_and_b32 v137, s47, v16
    v_add_f32 v132, v132, v136
    v_add_f32 v133, v133, v137
    v_fmac_f32 v134, v136, v136
    v_mfma_f32_32x32x16_bf16 v[64:79], v[20:23], v[32:35], v[64:79]
    ds_read_b128 v[28:31], v131 offset:16384
    ds_read_b64_tr_b16 v[44:45], v13 offset:28672
    ds_read_b64_tr_b16 v[46:47], v13 offset:29696
    v_fmac_f32 v135, v137, v137
    v_lshlrev_b32 v138, 16, v17
    v_and_b32 v139, s47, v17
    v_add_f32 v132, v132, v138
    v_add_f32 v133, v133, v139
    v_mfma_f32_32x32x16_bf16 v[96:111], v[20:23], v[36:39], v[96:111]
    v_fmac_f32 v134, v138, v138
    v_fmac_f32 v135, v139, v139
    v_lshlrev_b32 v136, 16, v18
    v_and_b32 v137, s47, v18
    v_add_f32 v132, v132, v136
    v_add_f32 v133, v133, v137
    v_fmac_f32 v134, v136, v136
    v_mfma_f32_32x32x16_bf16 v[80:95], v[16:19], v[36:39], v[80:95]
    v_fmac_f32 v135, v137, v137
    v_lshlrev_b32 v138, 16, v19
    v_and_b32 v139, s47, v19
    v_add_f32 v132, v132, v138
    v_add_f32 v133, v133, v139
    v_fmac_f32 v134, v138, v138
    v_fmac_f32 v135, v139, v139
    v_mfma_f32_16x16x32_bf16 v[112:115], v[116:119], v[32:35], v[112:115]
    s_waitcnt lgkmcnt(0)
    v_mfma_f32_32x32x16_bf16 v[48:63], v[24:27], v[40:43], v[48:63]
    v_lshlrev_b32 v136, 16, v24
    v_and_b32 v137, s47, v24
    v_add_f32 v132, v132, v136
    v_add_f32 v133, v133, v137
    v_fmac_f32 v134, v136, v136
    v_fmac_f32 v135, v137, v137
    v_mfma_f32_32x32x16_bf16 v[64:79], v[28:31], v[40:43], v[64:79]
    s_barrier
    v_lshlrev_b32 v138, 16, v25
    v_and_b32 v139, s47, v25
    v_add_f32 v132, v132, v138
    v_add_f32 v133, v133, v139
    v_fmac_f32 v134, v138, v138
    v_fmac_f32 v135, v139, v139
    v_mfma_f32_32x32x16_bf16 v[96:111], v[28:31], v[44:47], v[96:111]
    v_lshlrev_b32 v136, 16, v26
    v_and_b32 v137, s47, v26
    v_add_f32 v132, v132, v136
    v_add_f32 v133, v133, v137
    v_fmac_f32 v134, v136, v136
    v_fmac_f32 v135, v137, v137
    v_mfma_f32_32x32x16_bf16 v[80:95], v[24:27], v[44:47], v[80:95]
    v_lshlrev_b32 v138, 16, v27
    v_and_b32 v139, s47, v27
    v_add_f32 v132, v132, v138
    v_add_f32 v133, v133, v139
    v_fmac_f32 v134, v138, v138
    v_fmac_f32 v135, v139, v139
    v_mfma_f32_16x16x32_bf16 v[112:115], v[116:119], v[40:43], v[112:115]
    s_lshl_b32 s46, s32, 1
    s_add_u32 s46, s46, s33
    s_lshl_b32 s46, s46, 7
    s_add_u32 s48, s46, 131584
    v_lshlrev_b32 v1, 2, v2
    v_add_u32 v1, s48, v1
    v_add_f32 v132, v132, v133
    v_add_f32 v134, v134, v135
    v_mov_b32 v136, v132
    s_nop 1
    v_permlane32_swap_b32 v132, v136
    v_add_f32 v132, v132, v136
    v_mov_b32 v137, v134
    s_nop 1
    v_permlane32_swap_b32 v134, v137
    v_add_f32 v134, v134, v137
    v_mul_f32 v132, 0x3acccccd, v132
    v_mul_f32 v134, 0x3acccccd, v134
    v_fma_f32 v134, -v132, v132, v134
    v_max_f32 v134, 0, v134
    v_cvt_pk_bf16_f32 v134, v134, v134
    v_and_b32 v134, 0xffff0000, v134
    v_add_f32 v134, 0x3727c5ac, v134
    v_cvt_pk_bf16_f32 v134, v134, v134
    v_and_b32 v134, 0xffff0000, v134
    v_sqrt_f32 v134, v134
    s_nop 0
    v_cvt_pk_bf16_f32 v134, v134, v134
    v_and_b32 v134, 0xffff0000, v134
    v_rcp_f32 v134, v134
    v_cvt_pk_bf16_f32 v132, v132, v132
    v_and_b32 v132, 0xffff0000, v132
    v_sub_f32 v132, 0, v132
    ds_write2_b32 v1, v132, v134 offset0:0 offset1:128
    s_lshl_b32 s46, s33, 1
    s_add_u32 s46, s46, s32
    s_lshl_b32 s46, s46, 7
    s_add_u32 s46, s46, 131072
    v_lshlrev_b32 v1, 2, v0
    v_add_u32 v1, s46, v1
    s_mov_b64 exec, 0xffff
    ds_write2_b32 v1, v112, v113 offset0:0 offset1:16
    s_mov_b64 exec, -1
    s_waitcnt vmcnt(0) lgkmcnt(0)
    s_barrier
    v_lshlrev_b32 v1, 2, v2
    v_add_u32 v1, s46, v1
    v_xor_b32 v4, 128, v1
    ds_read_b32 v16, v1
    ds_read_b32 v18, v4
    v_lshlrev_b32 v1, 4, v3
    v_add_u32 v1, s48, v1
    v_xor_b32 v4, 128, v1
    ds_read_b128 v[128:131], v1 offset:0
    ds_read_b128 v[160:163], v1 offset:512
    ds_read_b128 v[132:135], v1 offset:32
    ds_read_b128 v[164:167], v1 offset:544
    ds_read_b128 v[136:139], v1 offset:64
    ds_read_b128 v[168:171], v1 offset:576
    ds_read_b128 v[140:143], v1 offset:96
    ds_read_b128 v[172:175], v1 offset:608
    ds_read_b128 v[144:147], v4 offset:0
    ds_read_b128 v[176:179], v4 offset:512
    ds_read_b128 v[148:151], v4 offset:32
    ds_read_b128 v[180:183], v4 offset:544
    ds_read_b128 v[152:155], v4 offset:64
    ds_read_b128 v[184:187], v4 offset:576
    ds_read_b128 v[156:159], v4 offset:96
    ds_read_b128 v[188:191], v4 offset:608
    s_waitcnt lgkmcnt(0)
    v_pk_fma_f32 v[48:49], v[128:129], v[16:17], v[48:49] op_sel_hi:[1,0,1]
    v_pk_fma_f32 v[50:51], v[130:131], v[16:17], v[50:51] op_sel_hi:[1,0,1]
    v_pk_mul_f32 v[48:49], v[48:49], v[160:161]
    v_pk_mul_f32 v[50:51], v[50:51], v[162:163]
    v_cvt_pk_bf16_f32 v20, v48, v49
    v_cvt_pk_bf16_f32 v21, v50, v51
    buffer_store_dwordx2 v[20:21], v120, s[20:23], s42 offen offset:0
    v_pk_fma_f32 v[52:53], v[132:133], v[16:17], v[52:53] op_sel_hi:[1,0,1]
    v_pk_fma_f32 v[54:55], v[134:135], v[16:17], v[54:55] op_sel_hi:[1,0,1]
    v_pk_mul_f32 v[52:53], v[52:53], v[164:165]
    v_pk_mul_f32 v[54:55], v[54:55], v[166:167]
    v_cvt_pk_bf16_f32 v22, v52, v53
    v_cvt_pk_bf16_f32 v23, v54, v55
    buffer_store_dwordx2 v[22:23], v120, s[20:23], s42 offen offset:320
    v_pk_fma_f32 v[56:57], v[136:137], v[16:17], v[56:57] op_sel_hi:[1,0,1]
    v_pk_fma_f32 v[58:59], v[138:139], v[16:17], v[58:59] op_sel_hi:[1,0,1]
    v_pk_mul_f32 v[56:57], v[56:57], v[168:169]
    v_pk_mul_f32 v[58:59], v[58:59], v[170:171]
    v_cvt_pk_bf16_f32 v24, v56, v57
    v_cvt_pk_bf16_f32 v25, v58, v59
    buffer_store_dwordx2 v[24:25], v120, s[20:23], s42 offen offset:640
    v_pk_fma_f32 v[60:61], v[140:141], v[16:17], v[60:61] op_sel_hi:[1,0,1]
    v_pk_fma_f32 v[62:63], v[142:143], v[16:17], v[62:63] op_sel_hi:[1,0,1]
    v_pk_mul_f32 v[60:61], v[60:61], v[172:173]
    v_pk_mul_f32 v[62:63], v[62:63], v[174:175]
    v_cvt_pk_bf16_f32 v26, v60, v61
    v_cvt_pk_bf16_f32 v27, v62, v63
    buffer_store_dwordx2 v[26:27], v120, s[20:23], s42 offen offset:960
    v_pk_fma_f32 v[64:65], v[144:145], v[16:17], v[64:65] op_sel_hi:[1,0,1]
    v_pk_fma_f32 v[66:67], v[146:147], v[16:17], v[66:67] op_sel_hi:[1,0,1]
    v_pk_mul_f32 v[64:65], v[64:65], v[176:177]
    v_pk_mul_f32 v[66:67], v[66:67], v[178:179]
    v_cvt_pk_bf16_f32 v28, v64, v65
    v_cvt_pk_bf16_f32 v29, v66, v67
    buffer_store_dwordx2 v[28:29], v120, s[20:23], s43 offen offset:0
    v_pk_fma_f32 v[68:69], v[148:149], v[16:17], v[68:69] op_sel_hi:[1,0,1]
    v_pk_fma_f32 v[70:71], v[150:151], v[16:17], v[70:71] op_sel_hi:[1,0,1]
    v_pk_mul_f32 v[68:69], v[68:69], v[180:181]
    v_pk_mul_f32 v[70:71], v[70:71], v[182:183]
    v_cvt_pk_bf16_f32 v30, v68, v69
    v_cvt_pk_bf16_f32 v31, v70, v71
    buffer_store_dwordx2 v[30:31], v120, s[20:23], s43 offen offset:320
    v_pk_fma_f32 v[72:73], v[152:153], v[16:17], v[72:73] op_sel_hi:[1,0,1]
    v_pk_fma_f32 v[74:75], v[154:155], v[16:17], v[74:75] op_sel_hi:[1,0,1]
    v_pk_mul_f32 v[72:73], v[72:73], v[184:185]
    v_pk_mul_f32 v[74:75], v[74:75], v[186:187]
    v_cvt_pk_bf16_f32 v32, v72, v73
    v_cvt_pk_bf16_f32 v33, v74, v75
    buffer_store_dwordx2 v[32:33], v120, s[20:23], s43 offen offset:640
    v_pk_fma_f32 v[76:77], v[156:157], v[16:17], v[76:77] op_sel_hi:[1,0,1]
    v_pk_fma_f32 v[78:79], v[158:159], v[16:17], v[78:79] op_sel_hi:[1,0,1]
    v_pk_mul_f32 v[76:77], v[76:77], v[188:189]
    v_pk_mul_f32 v[78:79], v[78:79], v[190:191]
    v_cvt_pk_bf16_f32 v34, v76, v77
    v_cvt_pk_bf16_f32 v35, v78, v79
    buffer_store_dwordx2 v[34:35], v120, s[20:23], s43 offen offset:960
    v_pk_fma_f32 v[80:81], v[128:129], v[18:19], v[80:81] op_sel_hi:[1,0,1]
    v_pk_fma_f32 v[82:83], v[130:131], v[18:19], v[82:83] op_sel_hi:[1,0,1]
    v_pk_mul_f32 v[80:81], v[80:81], v[160:161]
    v_pk_mul_f32 v[82:83], v[82:83], v[162:163]
    v_cvt_pk_bf16_f32 v20, v80, v81
    v_cvt_pk_bf16_f32 v21, v82, v83
    buffer_store_dwordx2 v[20:21], v121, s[20:23], s42 offen offset:0
    v_pk_fma_f32 v[84:85], v[132:133], v[18:19], v[84:85] op_sel_hi:[1,0,1]
    v_pk_fma_f32 v[86:87], v[134:135], v[18:19], v[86:87] op_sel_hi:[1,0,1]
    v_pk_mul_f32 v[84:85], v[84:85], v[164:165]
    v_pk_mul_f32 v[86:87], v[86:87], v[166:167]
    v_cvt_pk_bf16_f32 v22, v84, v85
    v_cvt_pk_bf16_f32 v23, v86, v87
    buffer_store_dwordx2 v[22:23], v121, s[20:23], s42 offen offset:320
    v_pk_fma_f32 v[88:89], v[136:137], v[18:19], v[88:89] op_sel_hi:[1,0,1]
    v_pk_fma_f32 v[90:91], v[138:139], v[18:19], v[90:91] op_sel_hi:[1,0,1]
    v_pk_mul_f32 v[88:89], v[88:89], v[168:169]
    v_pk_mul_f32 v[90:91], v[90:91], v[170:171]
    v_cvt_pk_bf16_f32 v24, v88, v89
    v_cvt_pk_bf16_f32 v25, v90, v91
    buffer_store_dwordx2 v[24:25], v121, s[20:23], s42 offen offset:640
    v_pk_fma_f32 v[92:93], v[140:141], v[18:19], v[92:93] op_sel_hi:[1,0,1]
    v_pk_fma_f32 v[94:95], v[142:143], v[18:19], v[94:95] op_sel_hi:[1,0,1]
    v_pk_mul_f32 v[92:93], v[92:93], v[172:173]
    v_pk_mul_f32 v[94:95], v[94:95], v[174:175]
    v_cvt_pk_bf16_f32 v26, v92, v93
    v_cvt_pk_bf16_f32 v27, v94, v95
    buffer_store_dwordx2 v[26:27], v121, s[20:23], s42 offen offset:960
    v_pk_fma_f32 v[96:97], v[144:145], v[18:19], v[96:97] op_sel_hi:[1,0,1]
    v_pk_fma_f32 v[98:99], v[146:147], v[18:19], v[98:99] op_sel_hi:[1,0,1]
    v_pk_mul_f32 v[96:97], v[96:97], v[176:177]
    v_pk_mul_f32 v[98:99], v[98:99], v[178:179]
    v_cvt_pk_bf16_f32 v28, v96, v97
    v_cvt_pk_bf16_f32 v29, v98, v99
    buffer_store_dwordx2 v[28:29], v121, s[20:23], s43 offen offset:0
    v_pk_fma_f32 v[100:101], v[148:149], v[18:19], v[100:101] op_sel_hi:[1,0,1]
    v_pk_fma_f32 v[102:103], v[150:151], v[18:19], v[102:103] op_sel_hi:[1,0,1]
    v_pk_mul_f32 v[100:101], v[100:101], v[180:181]
    v_pk_mul_f32 v[102:103], v[102:103], v[182:183]
    v_cvt_pk_bf16_f32 v30, v100, v101
    v_cvt_pk_bf16_f32 v31, v102, v103
    buffer_store_dwordx2 v[30:31], v121, s[20:23], s43 offen offset:320
    v_pk_fma_f32 v[104:105], v[152:153], v[18:19], v[104:105] op_sel_hi:[1,0,1]
    v_pk_fma_f32 v[106:107], v[154:155], v[18:19], v[106:107] op_sel_hi:[1,0,1]
    v_pk_mul_f32 v[104:105], v[104:105], v[184:185]
    v_pk_mul_f32 v[106:107], v[106:107], v[186:187]
    v_cvt_pk_bf16_f32 v32, v104, v105
    v_cvt_pk_bf16_f32 v33, v106, v107
    buffer_store_dwordx2 v[32:33], v121, s[20:23], s43 offen offset:640
    v_pk_fma_f32 v[108:109], v[156:157], v[18:19], v[108:109] op_sel_hi:[1,0,1]
    v_pk_fma_f32 v[110:111], v[158:159], v[18:19], v[110:111] op_sel_hi:[1,0,1]
    v_pk_mul_f32 v[108:109], v[108:109], v[188:189]
    v_pk_mul_f32 v[110:111], v[110:111], v[190:191]
    v_cvt_pk_bf16_f32 v34, v108, v109
    v_cvt_pk_bf16_f32 v35, v110, v111
    buffer_store_dwordx2 v[34:35], v121, s[20:23], s43 offen offset:960
    s_endpgm
k_qkv_kernel_helper:
    s_sub_u32 s3, s3, 4
    s_and_b32 s32, s3, 1
    s_lshl_b32 s32, s32, 2
    v_lshrrev_b32 v5, 4, v0
    v_add_u32 v6, s32, v5
    v_and_b32 v7, 7, v0
    v_xor_b32 v6, v6, v7
    v_lshlrev_b32 v6, 4, v6
    v_lshrrev_b32 v7, 3, v0
    s_lshl_b32 s33, s3, 3
    v_add_u32 v7, s33, v7
    v_mul_u32_u24 v7, 1280, v7
    v_add_u32 v8, v7, v6
    s_lshl_b32 s33, s3, 2
    v_add_u32 v7, s33, v5
    v_mul_u32_u24 v7, 3840, v7
    v_bfe_u32 v6, v0, 2, 2
    v_xor_b32 v6, v6, v5
    v_lshl_add_u32 v7, v6, 6, v7
    v_and_b32 v6, 3, v0
    v_lshl_add_u32 v9, v6, 4, v7
    s_mul_i32 s34, s30, 163840
    s_lshl_b32 s35, s31, 8
    s_lshl_b32 s36, s3, 10
    s_waitcnt lgkmcnt(0)
    s_mov_b32 s12, s4
    s_mov_b32 s13, s5
    s_mov_b32 s14, 0x280000
    s_mov_b32 s15, 0x00020000
    s_mov_b32 s16, s6
    s_mov_b32 s17, s7
    s_mov_b32 s18, 0x258000
    s_mov_b32 s19, 0x00020000
    s_add_u32 m0, s36, 0
    s_add_u32 s37, s34, 0
    buffer_load_dwordx4 v8, s[12:15], s37 offen lds
    s_add_u32 m0, s36, 65536
    s_add_u32 s38, s35, 0
    buffer_load_dwordx4 v9, s[16:19], s38 offen lds
    s_add_u32 m0, s36, 4096
    s_add_u32 s37, s34, 40960
    buffer_load_dwordx4 v8, s[12:15], s37 offen lds
    s_add_u32 m0, s36, 69632
    s_add_u32 s38, s35, 61440
    buffer_load_dwordx4 v9, s[16:19], s38 offen lds
    s_add_u32 m0, s36, 8192
    s_add_u32 s37, s34, 81920
    buffer_load_dwordx4 v8, s[12:15], s37 offen lds
    s_add_u32 m0, s36, 73728
    s_add_u32 s38, s35, 122880
    buffer_load_dwordx4 v9, s[16:19], s38 offen lds
    s_add_u32 m0, s36, 12288
    s_add_u32 s37, s34, 122880
    buffer_load_dwordx4 v8, s[12:15], s37 offen lds
    s_add_u32 m0, s36, 77824
    s_add_u32 s38, s35, 184320
    buffer_load_dwordx4 v9, s[16:19], s38 offen lds
    s_add_u32 m0, s36, 16384
    s_add_u32 s37, s34, 128
    buffer_load_dwordx4 v8, s[12:15], s37 offen lds
    s_add_u32 m0, s36, 81920
    s_add_u32 s38, s35, 245760
    buffer_load_dwordx4 v9, s[16:19], s38 offen lds
    s_add_u32 m0, s36, 20480
    s_add_u32 s37, s34, 41088
    buffer_load_dwordx4 v8, s[12:15], s37 offen lds
    s_add_u32 m0, s36, 86016
    s_add_u32 s38, s35, 307200
    buffer_load_dwordx4 v9, s[16:19], s38 offen lds
    s_add_u32 m0, s36, 24576
    s_add_u32 s37, s34, 82048
    buffer_load_dwordx4 v8, s[12:15], s37 offen lds
    s_add_u32 m0, s36, 90112
    s_add_u32 s38, s35, 368640
    buffer_load_dwordx4 v9, s[16:19], s38 offen lds
    s_add_u32 m0, s36, 28672
    s_add_u32 s37, s34, 123008
    buffer_load_dwordx4 v8, s[12:15], s37 offen lds
    s_add_u32 m0, s36, 94208
    s_add_u32 s38, s35, 430080
    buffer_load_dwordx4 v9, s[16:19], s38 offen lds
    s_waitcnt vmcnt(8)
    s_barrier
    s_add_u32 m0, s36, 32768
    s_add_u32 s37, s34, 256
    buffer_load_dwordx4 v8, s[12:15], s37 offen lds
    s_add_u32 m0, s36, 98304
    s_add_u32 s38, s35, 491520
    buffer_load_dwordx4 v9, s[16:19], s38 offen lds
    s_add_u32 m0, s36, 36864
    s_add_u32 s37, s34, 41216
    buffer_load_dwordx4 v8, s[12:15], s37 offen lds
    s_add_u32 m0, s36, 102400
    s_add_u32 s38, s35, 552960
    buffer_load_dwordx4 v9, s[16:19], s38 offen lds
    s_add_u32 m0, s36, 40960
    s_add_u32 s37, s34, 82176
    buffer_load_dwordx4 v8, s[12:15], s37 offen lds
    s_add_u32 m0, s36, 106496
    s_add_u32 s38, s35, 614400
    buffer_load_dwordx4 v9, s[16:19], s38 offen lds
    s_add_u32 m0, s36, 45056
    s_add_u32 s37, s34, 123136
    buffer_load_dwordx4 v8, s[12:15], s37 offen lds
    s_add_u32 m0, s36, 110592
    s_add_u32 s38, s35, 675840
    buffer_load_dwordx4 v9, s[16:19], s38 offen lds
    s_waitcnt vmcnt(8)
    s_barrier
    s_add_u32 m0, s36, 49152
    s_add_u32 s37, s34, 384
    buffer_load_dwordx4 v8, s[12:15], s37 offen lds
    s_add_u32 m0, s36, 114688
    s_add_u32 s38, s35, 737280
    buffer_load_dwordx4 v9, s[16:19], s38 offen lds
    s_add_u32 m0, s36, 53248
    s_add_u32 s37, s34, 41344
    buffer_load_dwordx4 v8, s[12:15], s37 offen lds
    s_add_u32 m0, s36, 118784
    s_add_u32 s38, s35, 798720
    buffer_load_dwordx4 v9, s[16:19], s38 offen lds
    s_add_u32 m0, s36, 57344
    s_add_u32 s37, s34, 82304
    buffer_load_dwordx4 v8, s[12:15], s37 offen lds
    s_add_u32 m0, s36, 122880
    s_add_u32 s38, s35, 860160
    buffer_load_dwordx4 v9, s[16:19], s38 offen lds
    s_add_u32 m0, s36, 61440
    s_add_u32 s37, s34, 123264
    buffer_load_dwordx4 v8, s[12:15], s37 offen lds
    s_add_u32 m0, s36, 126976
    s_add_u32 s38, s35, 921600
    buffer_load_dwordx4 v9, s[16:19], s38 offen lds
    s_waitcnt vmcnt(8)
    s_barrier
    s_add_u32 m0, s36, 0
    s_add_u32 s37, s34, 512
    buffer_load_dwordx4 v8, s[12:15], s37 offen lds
    s_add_u32 m0, s36, 65536
    s_add_u32 s38, s35, 983040
    buffer_load_dwordx4 v9, s[16:19], s38 offen lds
    s_add_u32 m0, s36, 4096
    s_add_u32 s37, s34, 41472
    buffer_load_dwordx4 v8, s[12:15], s37 offen lds
    s_add_u32 m0, s36, 69632
    s_add_u32 s38, s35, 1044480
    buffer_load_dwordx4 v9, s[16:19], s38 offen lds
    s_add_u32 m0, s36, 8192
    s_add_u32 s37, s34, 82432
    buffer_load_dwordx4 v8, s[12:15], s37 offen lds
    s_add_u32 m0, s36, 73728
    s_add_u32 s38, s35, 1105920
    buffer_load_dwordx4 v9, s[16:19], s38 offen lds
    s_add_u32 m0, s36, 12288
    s_add_u32 s37, s34, 123392
    buffer_load_dwordx4 v8, s[12:15], s37 offen lds
    s_add_u32 m0, s36, 77824
    s_add_u32 s38, s35, 1167360
    buffer_load_dwordx4 v9, s[16:19], s38 offen lds
    s_waitcnt vmcnt(8)
    s_barrier
    s_add_u32 m0, s36, 16384
    s_add_u32 s37, s34, 640
    buffer_load_dwordx4 v8, s[12:15], s37 offen lds
    s_add_u32 m0, s36, 81920
    s_add_u32 s38, s35, 1228800
    buffer_load_dwordx4 v9, s[16:19], s38 offen lds
    s_add_u32 m0, s36, 20480
    s_add_u32 s37, s34, 41600
    buffer_load_dwordx4 v8, s[12:15], s37 offen lds
    s_add_u32 m0, s36, 86016
    s_add_u32 s38, s35, 1290240
    buffer_load_dwordx4 v9, s[16:19], s38 offen lds
    s_add_u32 m0, s36, 24576
    s_add_u32 s37, s34, 82560
    buffer_load_dwordx4 v8, s[12:15], s37 offen lds
    s_add_u32 m0, s36, 90112
    s_add_u32 s38, s35, 1351680
    buffer_load_dwordx4 v9, s[16:19], s38 offen lds
    s_add_u32 m0, s36, 28672
    s_add_u32 s37, s34, 123520
    buffer_load_dwordx4 v8, s[12:15], s37 offen lds
    s_add_u32 m0, s36, 94208
    s_add_u32 s38, s35, 1413120
    buffer_load_dwordx4 v9, s[16:19], s38 offen lds
    s_waitcnt vmcnt(8)
    s_barrier
    s_add_u32 m0, s36, 32768
    s_add_u32 s37, s34, 768
    buffer_load_dwordx4 v8, s[12:15], s37 offen lds
    s_add_u32 m0, s36, 98304
    s_add_u32 s38, s35, 1474560
    buffer_load_dwordx4 v9, s[16:19], s38 offen lds
    s_add_u32 m0, s36, 36864
    s_add_u32 s37, s34, 41728
    buffer_load_dwordx4 v8, s[12:15], s37 offen lds
    s_add_u32 m0, s36, 102400
    s_add_u32 s38, s35, 1536000
    buffer_load_dwordx4 v9, s[16:19], s38 offen lds
    s_add_u32 m0, s36, 40960
    s_add_u32 s37, s34, 82688
    buffer_load_dwordx4 v8, s[12:15], s37 offen lds
    s_add_u32 m0, s36, 106496
    s_add_u32 s38, s35, 1597440
    buffer_load_dwordx4 v9, s[16:19], s38 offen lds
    s_add_u32 m0, s36, 45056
    s_add_u32 s37, s34, 123648
    buffer_load_dwordx4 v8, s[12:15], s37 offen lds
    s_add_u32 m0, s36, 110592
    s_add_u32 s38, s35, 1658880
    buffer_load_dwordx4 v9, s[16:19], s38 offen lds
    s_waitcnt vmcnt(8)
    s_barrier
    s_add_u32 m0, s36, 49152
    s_add_u32 s37, s34, 896
    buffer_load_dwordx4 v8, s[12:15], s37 offen lds
    s_add_u32 m0, s36, 114688
    s_add_u32 s38, s35, 1720320
    buffer_load_dwordx4 v9, s[16:19], s38 offen lds
    s_add_u32 m0, s36, 53248
    s_add_u32 s37, s34, 41856
    buffer_load_dwordx4 v8, s[12:15], s37 offen lds
    s_add_u32 m0, s36, 118784
    s_add_u32 s38, s35, 1781760
    buffer_load_dwordx4 v9, s[16:19], s38 offen lds
    s_add_u32 m0, s36, 57344
    s_add_u32 s37, s34, 82816
    buffer_load_dwordx4 v8, s[12:15], s37 offen lds
    s_add_u32 m0, s36, 122880
    s_add_u32 s38, s35, 1843200
    buffer_load_dwordx4 v9, s[16:19], s38 offen lds
    s_add_u32 m0, s36, 61440
    s_add_u32 s37, s34, 123776
    buffer_load_dwordx4 v8, s[12:15], s37 offen lds
    s_add_u32 m0, s36, 126976
    s_add_u32 s38, s35, 1904640
    buffer_load_dwordx4 v9, s[16:19], s38 offen lds
    s_waitcnt vmcnt(8)
    s_barrier
    s_add_u32 m0, s36, 0
    s_add_u32 s37, s34, 1024
    buffer_load_dwordx4 v8, s[12:15], s37 offen lds
    s_add_u32 m0, s36, 65536
    s_add_u32 s38, s35, 1966080
    buffer_load_dwordx4 v9, s[16:19], s38 offen lds
    s_add_u32 m0, s36, 4096
    s_add_u32 s37, s34, 41984
    buffer_load_dwordx4 v8, s[12:15], s37 offen lds
    s_add_u32 m0, s36, 69632
    s_add_u32 s38, s35, 2027520
    buffer_load_dwordx4 v9, s[16:19], s38 offen lds
    s_add_u32 m0, s36, 8192
    s_add_u32 s37, s34, 82944
    buffer_load_dwordx4 v8, s[12:15], s37 offen lds
    s_add_u32 m0, s36, 73728
    s_add_u32 s38, s35, 2088960
    buffer_load_dwordx4 v9, s[16:19], s38 offen lds
    s_add_u32 m0, s36, 12288
    s_add_u32 s37, s34, 123904
    buffer_load_dwordx4 v8, s[12:15], s37 offen lds
    s_add_u32 m0, s36, 77824
    s_add_u32 s38, s35, 2150400
    buffer_load_dwordx4 v9, s[16:19], s38 offen lds
    s_waitcnt vmcnt(8)
    s_barrier
    s_add_u32 m0, s36, 16384
    s_add_u32 s37, s34, 1152
    buffer_load_dwordx4 v8, s[12:15], s37 offen lds
    s_add_u32 m0, s36, 81920
    s_add_u32 s38, s35, 2211840
    buffer_load_dwordx4 v9, s[16:19], s38 offen lds
    s_add_u32 m0, s36, 20480
    s_add_u32 s37, s34, 42112
    buffer_load_dwordx4 v8, s[12:15], s37 offen lds
    s_add_u32 m0, s36, 86016
    s_add_u32 s38, s35, 2273280
    buffer_load_dwordx4 v9, s[16:19], s38 offen lds
    s_add_u32 m0, s36, 24576
    s_add_u32 s37, s34, 83072
    buffer_load_dwordx4 v8, s[12:15], s37 offen lds
    s_add_u32 m0, s36, 90112
    s_add_u32 s38, s35, 2334720
    buffer_load_dwordx4 v9, s[16:19], s38 offen lds
    s_add_u32 m0, s36, 28672
    s_add_u32 s37, s34, 124032
    buffer_load_dwordx4 v8, s[12:15], s37 offen lds
    s_add_u32 m0, s36, 94208
    s_add_u32 s38, s35, 2396160
    buffer_load_dwordx4 v9, s[16:19], s38 offen lds
    s_lshr_b32 s40, s2, 2
    s_and_b32 s41, s2, 3
    s_lshl_b32 s41, s41, 2
    s_add_u32 s41, s41, s3
    v_lshrrev_b32 v41, 3, v0
    v_mul_u32_u24 v41, 3456, v41
    v_and_b32 v42, 7, v0
    v_lshl_add_u32 v41, v42, 4, v41
    s_mul_i32 s42, s41, 138240
    s_mul_i32 s43, s41, 14336
    s_cmp_ge_u32 s40, 27
    s_cselect_b32 s20, s26, s24
    s_cselect_b32 s21, s27, s25
    s_cselect_b32 s44, 27, 0
    s_cselect_b32 s45, 7168, 0
    s_add_u32 s43, s43, s45
    s_sub_u32 s44, s40, s44
    s_lshl_b32 s45, s44, 7
    s_add_u32 s42, s42, s45
    s_lshl_b32 s45, s44, 8
    s_add_u32 s43, s43, s45
    s_cmp_lt_u32 s40, 54
    s_cselect_b32 s22, 2211840, 0
    s_mov_b32 s23, 0x00020000
    buffer_load_dwordx4 v[44:47], v41, s[20:23], s42 offen
    s_add_u32 s42, s42, 27648
    buffer_load_dwordx4 v[48:51], v41, s[20:23], s42 offen
    s_add_u32 s42, s42, 27648
    buffer_load_dwordx4 v[52:55], v41, s[20:23], s42 offen
    s_add_u32 s42, s42, 27648
    buffer_load_dwordx4 v[56:59], v41, s[20:23], s42 offen
    s_add_u32 s42, s42, 27648
    buffer_load_dwordx4 v[60:63], v41, s[20:23], s42 offen
    s_waitcnt vmcnt(13)
    s_barrier
    s_waitcnt vmcnt(5)
    s_barrier
    s_barrier
    s_barrier
    s_cmp_lt_u32 s40, 54
    s_cbranch_scc1 k_qkv_kernel_hsum
    s_add_u32 s16, s8, 0x1580000
    s_addc_u32 s17, s9, 0
    s_mov_b32 s18, 0x18000
    s_mov_b32 s19, 0x00020000
    v_mov_b32 v16, 0
    v_mov_b32 v17, 0
    v_mov_b32 v18, 0
    v_mov_b32 v19, 0
    s_sub_u32 s40, s2, 216
    s_lshl_b32 s40, s40, 2
    s_add_u32 s40, s40, s3
    s_lshl_b32 s40, s40, 10
    v_lshlrev_b32 v41, 4, v0
    buffer_store_dwordx4 v[16:19], v41, s[16:19], s40 offen
    s_branch k_qkv_kernel_hend
k_qkv_kernel_hsum:
    s_add_u32 s16, s8, 0x1540000
    s_addc_u32 s17, s9, 0
    s_mov_b32 s18, 0x38000
    s_mov_b32 s19, 0x00020000
    v_mov_b32 v16, 0
    v_mov_b32 v17, 0
    v_mov_b32 v18, 0
    v_mov_b32 v19, 0
    v_mov_b32 v20, 0
    v_mov_b32 v21, 0
    v_mov_b32 v22, 0
    v_mov_b32 v23, 0
    s_mov_b32 s38, 0x00003f80
    s_mov_b32 s39, 0x3f800000
    s_waitcnt vmcnt(4)
    v_dot2c_f32_bf16 v16, s38, v44
    v_dot2c_f32_bf16 v17, s39, v44
    v_dot2c_f32_bf16 v18, s38, v45
    v_dot2c_f32_bf16 v19, s39, v45
    v_dot2c_f32_bf16 v20, s38, v46
    v_dot2c_f32_bf16 v21, s39, v46
    v_dot2c_f32_bf16 v22, s38, v47
    v_dot2c_f32_bf16 v23, s39, v47
    s_waitcnt vmcnt(3)
    v_dot2c_f32_bf16 v16, s38, v48
    v_dot2c_f32_bf16 v17, s39, v48
    v_dot2c_f32_bf16 v18, s38, v49
    v_dot2c_f32_bf16 v19, s39, v49
    v_dot2c_f32_bf16 v20, s38, v50
    v_dot2c_f32_bf16 v21, s39, v50
    v_dot2c_f32_bf16 v22, s38, v51
    v_dot2c_f32_bf16 v23, s39, v51
    s_waitcnt vmcnt(2)
    v_dot2c_f32_bf16 v16, s38, v52
    v_dot2c_f32_bf16 v17, s39, v52
    v_dot2c_f32_bf16 v18, s38, v53
    v_dot2c_f32_bf16 v19, s39, v53
    v_dot2c_f32_bf16 v20, s38, v54
    v_dot2c_f32_bf16 v21, s39, v54
    v_dot2c_f32_bf16 v22, s38, v55
    v_dot2c_f32_bf16 v23, s39, v55
    s_waitcnt vmcnt(1)
    v_dot2c_f32_bf16 v16, s38, v56
    v_dot2c_f32_bf16 v17, s39, v56
    v_dot2c_f32_bf16 v18, s38, v57
    v_dot2c_f32_bf16 v19, s39, v57
    v_dot2c_f32_bf16 v20, s38, v58
    v_dot2c_f32_bf16 v21, s39, v58
    v_dot2c_f32_bf16 v22, s38, v59
    v_dot2c_f32_bf16 v23, s39, v59
    s_waitcnt vmcnt(0)
    v_dot2c_f32_bf16 v16, s38, v60
    v_dot2c_f32_bf16 v17, s39, v60
    v_dot2c_f32_bf16 v18, s38, v61
    v_dot2c_f32_bf16 v19, s39, v61
    v_dot2c_f32_bf16 v20, s38, v62
    v_dot2c_f32_bf16 v21, s39, v62
    v_dot2c_f32_bf16 v22, s38, v63
    v_dot2c_f32_bf16 v23, s39, v63
    s_nop 4
    v_add_f32_dpp v16, v16, v16 row_ror:8 row_mask:0xf bank_mask:0xf
    v_add_f32_dpp v17, v17, v17 row_ror:8 row_mask:0xf bank_mask:0xf
    v_add_f32_dpp v18, v18, v18 row_ror:8 row_mask:0xf bank_mask:0xf
    v_add_f32_dpp v19, v19, v19 row_ror:8 row_mask:0xf bank_mask:0xf
    v_add_f32_dpp v20, v20, v20 row_ror:8 row_mask:0xf bank_mask:0xf
    v_add_f32_dpp v21, v21, v21 row_ror:8 row_mask:0xf bank_mask:0xf
    v_add_f32_dpp v22, v22, v22 row_ror:8 row_mask:0xf bank_mask:0xf
    v_add_f32_dpp v23, v23, v23 row_ror:8 row_mask:0xf bank_mask:0xf
    v_mov_b32 v24, v16
    s_nop 1
    v_permlane16_swap_b32 v16, v24
    v_add_f32 v16, v16, v24
    v_mov_b32 v25, v17
    s_nop 1
    v_permlane16_swap_b32 v17, v25
    v_add_f32 v17, v17, v25
    v_mov_b32 v26, v18
    s_nop 1
    v_permlane16_swap_b32 v18, v26
    v_add_f32 v18, v18, v26
    v_mov_b32 v27, v19
    s_nop 1
    v_permlane16_swap_b32 v19, v27
    v_add_f32 v19, v19, v27
    v_mov_b32 v28, v20
    s_nop 1
    v_permlane16_swap_b32 v20, v28
    v_add_f32 v20, v20, v28
    v_mov_b32 v29, v21
    s_nop 1
    v_permlane16_swap_b32 v21, v29
    v_add_f32 v21, v21, v29
    v_mov_b32 v30, v22
    s_nop 1
    v_permlane16_swap_b32 v22, v30
    v_add_f32 v22, v22, v30
    v_mov_b32 v31, v23
    s_nop 1
    v_permlane16_swap_b32 v23, v31
    v_add_f32 v23, v23, v31
    v_mov_b32 v24, v16
    s_nop 1
    v_permlane32_swap_b32 v16, v24
    v_add_f32 v16, v16, v24
    v_mov_b32 v25, v17
    s_nop 1
    v_permlane32_swap_b32 v17, v25
    v_add_f32 v17, v17, v25
    v_mov_b32 v26, v18
    s_nop 1
    v_permlane32_swap_b32 v18, v26
    v_add_f32 v18, v18, v26
    v_mov_b32 v27, v19
    s_nop 1
    v_permlane32_swap_b32 v19, v27
    v_add_f32 v19, v19, v27
    v_mov_b32 v28, v20
    s_nop 1
    v_permlane32_swap_b32 v20, v28
    v_add_f32 v20, v20, v28
    v_mov_b32 v29, v21
    s_nop 1
    v_permlane32_swap_b32 v21, v29
    v_add_f32 v21, v21, v29
    v_mov_b32 v30, v22
    s_nop 1
    v_permlane32_swap_b32 v22, v30
    v_add_f32 v22, v22, v30
    v_mov_b32 v31, v23
    s_nop 1
    v_permlane32_swap_b32 v23, v31
    v_add_f32 v23, v23, v31
    v_lshlrev_b32 v41, 5, v42
    s_mov_b64 exec, 0xff
    buffer_store_dwordx4 v[16:19], v41, s[16:19], s43 offen
    buffer_store_dwordx4 v[20:23], v41, s[16:19], s43 offen offset:16
k_qkv_kernel_hend:
k_qkv_kernel_end:
    s_endpgm
.globl k_attn_kernel
.p2align 8
.type k_attn_kernel,@function
k_attn_kernel:
    s_cmp_ge_u32 s2, 256
    s_cbranch_scc1 k_attn_kernel_end
    s_load_dwordx16 s[32:47], s[0:1], 16
    s_load_dwordx2 s[28:29], s[0:1], 0
    v_lshrrev_b32 v1, 6, v0
    v_and_b32 v0, 63, v0
    v_readfirstlane_b32 s3, v1
    v_readfirstlane_b32 s101, v1
    s_and_b32 s4, s2, 7
    s_lshl_b32 s4, s4, 2
    s_lshr_b32 s5, s2, 6
    s_add_u32 s4, s4, s5
    s_bfe_u32 s5, s2, 0x30003
    s_mul_i32 s6, s4, 163840
    s_add_u32 s6, s6, 0x300000
    s_lshl_b32 s7, s4, 3
    s_add_u32 s7, s7, s5
    s_lshl_b32 s7, s7, 3
    s_add_u32 s7, s7, s3
    s_mul_i32 s7, s7, 1280
    v_lshlrev_b32 v2, 4, v0
    v_and_b32 v5, 31, v0
    v_lshlrev_b32 v3, 3, v5
    v_add_u32 v3, 1024, v3
    v_mov_b32 v12, 0
    v_mov_b32 v13, 0
    s_lshl_b32 m0, s3, 10
    s_mov_b32 s14, 163840
    s_mov_b32 s15, 0x00020000
    s_mov_b32 s18, 0x280000
    s_mov_b32 s19, 0x00020000
    s_waitcnt lgkmcnt(0)
    s_add_u32 s12, s46, s6
    s_addc_u32 s13, s47, 0
    buffer_load_dwordx4 v2, s[12:15], m0 offen lds
    s_add_u32 m0, m0, 8192
    s_mov_b32 s16, s46
    s_mov_b32 s17, s47
    buffer_load_dwordx4 v[8:11], v2, s[16:19], s7 offen
    s_mov_b32 exec_hi, 0
    buffer_load_dwordx2 v[12:13], v3, s[16:19], s7 offen
    s_mov_b64 exec, -1
    buffer_load_dwordx4 v2, s[12:15], m0 offen lds
    s_add_u32 m0, m0, 8192
    s_nop 0
    buffer_load_dwordx4 v2, s[12:15], m0 offen lds
    s_add_u32 m0, m0, 8192
    s_nop 0
    buffer_load_dwordx4 v2, s[12:15], m0 offen lds
    s_add_u32 m0, m0, 8192
    s_mov_b32 s8, s46
    s_mov_b32 s9, s47
    s_add_u32 s20, s8, 0x800000
    s_addc_u32 s21, s9, 0
    s_mov_b32 s22, 0x280000
    s_mov_b32 s23, 0x00020000
    v_lshrrev_b32 v6, 5, v0
    v_mul_u32_u24 v7, 320, v6
    v_lshl_add_u32 v4, v5, 4, v7
    v_add_u32 v4, 1280, v4
    v_cmp_eq_u32 vcc, 20, v5
    v_mov_b32 v7, 0x3f803f80
    s_nop 0
    v_cndmask_b32 v100, 0, v7, vcc
    v_mov_b32 v101, v100
    v_mov_b32 v102, v100
    v_mov_b32 v103, v100
    v_mov_b32 v104, v100
    v_mov_b32 v105, v100
    v_mov_b32 v106, v100
    v_mov_b32 v107, v100
    v_mov_b32 v108, v100
    v_mov_b32 v109, v100
    v_mov_b32 v110, v100
    v_mov_b32 v111, v100
    v_mov_b32 v112, v100
    v_mov_b32 v113, v100
    v_mov_b32 v114, v100
    v_mov_b32 v115, v100
    s_mov_b32 s24, 0x000fffff
    s_mov_b32 s25, 0x000fffff
    s_lshl_b32 s10, s5, 4
    s_lshl_b32 s11, s3, 1
    s_add_u32 s10, s10, s11
    v_bfe_u32 v7, v0, 4, 1
    v_add_u32 v7, s10, v7
    v_mul_u32_u24 v7, 20480, v7
    v_and_b32 v1, 15, v0
    v_lshl_add_u32 v7, v1, 4, v7
    s_mul_i32 s10, s4, 5
    v_add_u32 v6, s10, v6
    v_lshrrev_b32 v1, 3, v6
    v_lshl_add_u32 v116, v1, 10, v7
    v_and_b32 v1, 3, v6
    v_lshl_add_u32 v116, v1, 8, v116
    v_bfe_u32 v1, v6, 2, 1
    v_lshl_add_u32 v116, v1, 3, v116
    v_add_u32 v6, 2, v6
    v_lshrrev_b32 v1, 3, v6
    v_lshl_add_u32 v117, v1, 10, v7
    v_and_b32 v1, 3, v6
    v_lshl_add_u32 v117, v1, 8, v117
    v_bfe_u32 v1, v6, 2, 1
    v_lshl_add_u32 v117, v1, 3, v117
    v_add_u32 v6, 2, v6
    v_lshrrev_b32 v1, 3, v6
    v_lshl_add_u32 v118, v1, 10, v7
    v_and_b32 v1, 3, v6
    v_lshl_add_u32 v118, v1, 8, v118
    v_bfe_u32 v1, v6, 2, 1
    v_lshl_add_u32 v118, v1, 3, v118
    v_mov_b32 v123, v2
    s_add_u32 s88, s8, 0x1600000
    s_addc_u32 s89, s9, 0
    s_mov_b32 s90, 0x744000
    s_mov_b32 s91, 0x00020000
    s_lshl_b32 s30, s2, 3
    s_add_u32 s30, s30, s3
    v_bfe_u32 v1, v0, 1, 2
    v_bfe_u32 v5, v0, 4, 1
    v_lshl_add_u32 v1, v5, 2, v1
    v_and_b32 v5, 8, v0
    v_add_u32 v1, v1, v5
    v_mul_u32_u24 v1, 3456, v1
    v_and_b32 v5, 32, v0
    v_add_u32 v1, v1, v5
    v_and_b32 v5, 1, v0
    v_lshl_add_u32 v127, v5, 4, v1
    v_mov_b32 v126, v127
    v_mov_b32 v125, v127
    s_mov_b32 s48, s40
    s_mov_b32 s49, s41
    s_mov_b32 s50, 0x21c000
    s_mov_b32 s4, 0
    s_mov_b32 s5, 270
    s_mov_b32 s6, 3884
    s_mov_b32 s51, 0x00020000
    s_add_u32 s4, s4, s30
    s_mul_i32 s6, s6, s4
    s_lshr_b32 s6, s6, 20
    s_mul_i32 s5, s5, s6
    s_sub_u32 s4, s4, s5
    s_lshl_b32 s4, s4, 6
    s_mul_i32 s92, s6, 160
    v_add_u32 v1, s4, v0
    v_mul_u32_u24 v5, 52429, v1
    v_lshrrev_b32 v5, 19, v5
    v_mul_u32_u24 v5, 1120, v5
    v_lshl_add_u32 v124, v1, 4, v5
    s_mov_b32 s52, s40
    s_mov_b32 s53, s41
    s_mov_b32 s54, 0x21c000
    s_mov_b32 s4, 2048
    s_mov_b32 s5, 270
    s_mov_b32 s6, 3884
    s_cmp_ge_u32 s30, 112
    s_cselect_b32 s52, s32, s52
    s_cselect_b32 s53, s33, s53
    s_cselect_b32 s54, 0xc8000, s54
    s_cselect_b32 s4, -112, s4
    s_cselect_b32 s5, 100, s5
    s_cselect_b32 s6, 10486, s6
    s_cmp_ge_u32 s30, 912
    s_cselect_b32 s52, s36, s52
    s_cselect_b32 s53, s37, s53
    s_cselect_b32 s54, 0x21c000, s54
    s_cselect_b32 s4, -912, s4
    s_cselect_b32 s5, 40, s5
    s_cselect_b32 s6, 26215, s6
    s_mov_b32 s55, 0x00020000
    s_add_u32 s4, s4, s30
    s_mul_i32 s6, s6, s4
    s_lshr_b32 s6, s6, 20
    s_mul_i32 s5, s5, s6
    s_sub_u32 s4, s4, s5
    s_cmp_ge_u32 s30, 912
    s_cbranch_scc1 k_attn_kernel_pk_2_b
    s_lshl_b32 s4, s4, 6
    s_mul_i32 s93, s6, 160
    v_add_u32 v1, s4, v0
    v_mul_u32_u24 v5, 52429, v1
    v_lshrrev_b32 v5, 19, v5
    v_mul_u32_u24 v5, 1120, v5
    v_lshl_add_u32 v125, v1, 4, v5
    s_branch k_attn_kernel_pk_2_e
k_attn_kernel_pk_2_b:
    s_cmp_ge_u32 s6, 28
    s_cselect_b32 s5, 28, 0
    s_cselect_b32 s7, 8, 0
    s_sub_u32 s6, s6, s5
    s_and_b32 s5, s6, 24
    s_add_u32 s5, s5, s6
    s_add_u32 s5, s5, s7
    s_lshr_b32 s7, s7, 1
    s_add_u32 s7, s7, s6
    s_add_u32 s7, s7, 24
    s_cmp_ge_u32 s6, 24
    s_cselect_b32 s5, s7, s5
    s_lshl_b32 s5, s5, 6
    s_mul_i32 s4, s4, 55296
    s_add_u32 s93, s4, s5
k_attn_kernel_pk_2_e:
    s_mov_b32 s56, s36
    s_mov_b32 s57, s37
    s_mov_b32 s58, 0x21c000
    s_mov_b32 s4, 1136
    s_mov_b32 s5, 40
    s_mov_b32 s6, 26215
    s_cmp_ge_u32 s30, 1104
    s_cselect_b32 s56, s38, s56
    s_cselect_b32 s57, s39, s57
    s_cselect_b32 s4, -1104, s4
    s_mov_b32 s59, 0x00020000
    s_add_u32 s4, s4, s30
    s_mul_i32 s6, s6, s4
    s_lshr_b32 s6, s6, 20
    s_mul_i32 s5, s5, s6
    s_sub_u32 s4, s4, s5
    s_cmp_ge_u32 s6, 28
    s_cselect_b32 s5, 28, 0
    s_cselect_b32 s7, 8, 0
    s_sub_u32 s6, s6, s5
    s_and_b32 s5, s6, 24
    s_add_u32 s5, s5, s6
    s_add_u32 s5, s5, s7
    s_lshr_b32 s7, s7, 1
    s_add_u32 s7, s7, s6
    s_add_u32 s7, s7, 24
    s_cmp_ge_u32 s6, 24
    s_cselect_b32 s5, s7, s5
    s_lshl_b32 s5, s5, 6
    s_mul_i32 s4, s4, 55296
    s_add_u32 s94, s4, s5
    s_mov_b32 s60, s38
    s_mov_b32 s61, s39
    s_mov_b32 s62, 0x21c000
    s_mov_b32 s4, 944
    s_mov_b32 s5, 40
    s_mov_b32 s6, 26215
    s_mov_b32 s63, 0x00020000
    s_add_u32 s4, s4, s30
    s_mul_i32 s6, s6, s4
    s_lshr_b32 s6, s6, 20
    s_mul_i32 s5, s5, s6
    s_sub_u32 s4, s4, s5
    s_cmp_ge_u32 s6, 28
    s_cselect_b32 s5, 28, 0
    s_cselect_b32 s7, 8, 0
    s_sub_u32 s6, s6, s5
    s_and_b32 s5, s6, 24
    s_add_u32 s5, s5, s6
    s_add_u32 s5, s5, s7
    s_lshr_b32 s7, s7, 1
    s_add_u32 s7, s7, s6
    s_add_u32 s7, s7, 24
    s_cmp_ge_u32 s6, 24
    s_cselect_b32 s5, s7, s5
    s_lshl_b32 s5, s5, 6
    s_mul_i32 s4, s4, 55296
    s_add_u32 s95, s4, s5
    s_lshl_b32 s30, s30, 10
    s_lshr_b32 s4, s2, 3
    s_lshl_b32 s4, s4, 3
    s_add_u32 s4, s4, s3
    s_and_b32 s5, s2, 1
    s_mul_i32 s5, s5, 1146880
    s_add_u32 s6, s5, 2211840
    s_add_u32 s7, s5, 3358720
    s_mov_b32 s31, 2211840
    s_cmp_ge_u32 s4, 100
    s_cselect_b32 s31, s6, s31
    s_cmp_ge_u32 s4, 240
    s_cselect_b32 s31, s7, s31
    s_lshl_b32 s10, s4, 13
    s_add_u32 s31, s31, s10
    s_add_u32 s7, s7, s10
    s_add_u32 s7, s7, 2097152
    s_cmp_lt_u32 s4, 124
    s_cselect_b32 s36, s7, 0x744000
    s_and_b32 s5, s2, 7
    s_mul_i32 s5, s5, 327680
    s_add_u32 s5, s5, s10
    s_sub_u32 s5, s5, 1769472
    s_cmp_ge_u32 s4, 216
    s_cselect_b32 s37, s5, 0x280000
    s_mov_b32 s32, s28
    s_mov_b32 s33, s29
    s_mov_b32 s34, 0x280000
    s_mov_b32 s35, 0x00020000
    v_lshlrev_b32 v119, 7, v0
    s_mov_b32 s26, 1
    s_mov_b32 s38, 12
    s_mov_b32 s27, 3
    s_mov_b32 s28, 6
    s_waitcnt vmcnt(0)
    s_barrier
k_attn_kernel_maxpass:
    v_mov_b32 v120, 0xff800000
    v_mov_b32 v121, v2
    v_mov_b32 v122, v3
    s_mov_b32 s29, s26
k_attn_kernel_maxloop:
    ds_read_b64 v[96:97], v122
    ds_read_b128 v[88:91], v121
    v_add_u32 v121, 2560, v121
    v_add_u32 v122, 2560, v122
    s_waitcnt lgkmcnt(0)
    v_mfma_f32_32x32x8bf16_1k v[32:47], v[96:97], v[12:13], 0
    v_mfma_f32_32x32x16_bf16 v[32:47], v[88:91], v[8:11], v[32:47]
    s_nop 11
    v_max3_f32 v120, v32, v33, v120
    v_max3_f32 v120, v34, v35, v120
    v_max3_f32 v120, v36, v37, v120
    v_max3_f32 v120, v38, v39, v120
    v_max3_f32 v120, v40, v41, v120
    v_max3_f32 v120, v42, v43, v120
    v_max3_f32 v120, v44, v45, v120
    v_max3_f32 v120, v46, v47, v120
    s_sub_u32 s29, s29, 1
    s_cmp_lg_u32 s29, 0
    s_cbranch_scc1 k_attn_kernel_maxloop
    ds_read_b64 v[96:97], v3
    ds_read_b128 v[88:91], v2
    ds_read_b64 v[98:99], v3 offset:2560
    ds_read_b128 v[92:95], v2 offset:2560
    s_mov_b64 exec, s[24:25]
    ds_read_b128 v[100:103], v4
    ds_read_b128 v[104:107], v4 offset:640
    s_mov_b64 exec, -1
    v_mov_b32 v121, v120
    s_nop 1
    v_permlane32_swap_b32 v120, v121
    v_max_f32 v120, v120, v121
    v_sub_f32 v16, 0, v120
    v_sub_f32 v17, 0, v120
    v_sub_f32 v18, 0, v120
    v_sub_f32 v19, 0, v120
    v_sub_f32 v20, 0, v120
    v_sub_f32 v21, 0, v120
    v_sub_f32 v22, 0, v120
    v_sub_f32 v23, 0, v120
    v_sub_f32 v24, 0, v120
    v_sub_f32 v25, 0, v120
    v_sub_f32 v26, 0, v120
    v_sub_f32 v27, 0, v120
    v_sub_f32 v28, 0, v120
    v_sub_f32 v29, 0, v120
    v_sub_f32 v30, 0, v120
    v_sub_f32 v31, 0, v120
    v_mov_b32 v72, 0
    v_mov_b32 v73, 0
    v_mov_b32 v74, 0
    v_mov_b32 v75, 0
    v_mov_b32 v76, 0
    v_mov_b32 v77, 0
    v_mov_b32 v78, 0
    v_mov_b32 v79, 0
    v_mov_b32 v80, 0
    v_mov_b32 v81, 0
    v_mov_b32 v82, 0
    v_mov_b32 v83, 0
    v_mov_b32 v84, 0
    v_mov_b32 v85, 0
    v_mov_b32 v86, 0
    v_mov_b32 v87, 0
    v_mov_b32 v68, 0
    v_mov_b32 v69, 0
    v_mov_b32 v70, 0
    v_mov_b32 v71, 0
    s_waitcnt lgkmcnt(0)
    v_mfma_f32_32x32x8bf16_1k v[32:47], v[96:97], v[12:13], v[16:31]
    v_mfma_f32_32x32x16_bf16 v[32:47], v[88:91], v[8:11], v[32:47]
    s_mov_b32 s29, 0
    s_cmp_ge_u32 s3, 4
    s_cselect_b64 vcc, -1, 0
    s_setprio 1
    s_nop 5
    s_cmp_lg_u32 s26, 1
    s_cbranch_scc1 k_attn_kernel_loop
.p2align 3
    s_cbranch_vccnz k_attn_kernel_p_5
    s_setprio 2
k_attn_kernel_p_5:
    v_exp_f32 v32, v32
    s_waitcnt lgkmcnt(0)
    v_mfma_f32_32x32x8bf16_1k v[48:63], v[98:99], v[12:13], v[16:31]
    ds_read_b64 v[96:97], v3 offset:5120
    ds_read_b128 v[88:91], v2 offset:5120
    v_exp_f32 v33, v33
    v_exp_f32 v34, v34
    v_mfma_f32_32x32x16_bf16 v[72:87], v[112:115], v[68:71], v[72:87]
    buffer_load_dwordx4 v2, s[12:15], m0 offen lds
    s_add_u32 m0, m0, 8192
    v_exp_f32 v35, v35
    s_mov_b64 exec, s[24:25]
    ds_read_b128 v[108:111], v4 offset:2560
    ds_read_b128 v[112:115], v4 offset:3200
    s_mov_b64 exec, -1
    v_exp_f32 v36, v36
    v_exp_f32 v37, v37
    v_exp_f32 v38, v38
    v_mfma_f32_32x32x16_bf16 v[48:63], v[92:95], v[8:11], v[48:63]
    buffer_load_dwordx4 v2, s[12:15], m0 offen lds
    s_add_u32 m0, m0, 8192
    v_exp_f32 v39, v39
    v_exp_f32 v40, v40
    v_cvt_pk_bf16_f32 v64, v32, v33
    v_cvt_pk_bf16_f32 v65, v34, v35
    v_cvt_pk_bf16_f32 v66, v36, v37
    v_cvt_pk_bf16_f32 v67, v38, v39
    v_exp_f32 v41, v41
    v_exp_f32 v42, v42
    v_mfma_f32_32x32x16_bf16 v[72:87], v[100:103], v[64:67], v[72:87]
    buffer_load_dwordx4 v2, s[12:15], m0 offen lds
    s_add_u32 m0, m0, 8192
    v_exp_f32 v43, v43
    v_exp_f32 v44, v44
    v_exp_f32 v45, v45
    v_exp_f32 v46, v46
    v_exp_f32_e64 v47, v47
    v_cvt_pk_bf16_f32 v68, v40, v41
    v_cvt_pk_bf16_f32 v69, v42, v43
    v_cvt_pk_bf16_f32 v70, v44, v45
    v_cvt_pk_bf16_f32 v71, v46, v47
    v_exp_f32 v48, v48
    s_waitcnt lgkmcnt(0)
    v_mfma_f32_32x32x8bf16_1k v[32:47], v[96:97], v[12:13], v[16:31]
    ds_read_b64 v[98:99], v3 offset:7680
    ds_read_b128 v[92:95], v2 offset:7680
    v_exp_f32 v49, v49
    v_exp_f32 v50, v50
    v_mfma_f32_32x32x16_bf16 v[72:87], v[104:107], v[68:71], v[72:87]
    buffer_load_dwordx4 v2, s[12:15], m0 offen lds
    s_add_u32 m0, m0, 8192
    v_exp_f32 v51, v51
    s_mov_b64 exec, s[24:25]
    ds_read_b128 v[100:103], v4 offset:5120
    ds_read_b128 v[104:107], v4 offset:5760
    s_mov_b64 exec, -1
    v_exp_f32 v52, v52
    v_exp_f32 v53, v53
    v_exp_f32 v54, v54
    v_mfma_f32_32x32x16_bf16 v[32:47], v[88:91], v[8:11], v[32:47]
    buffer_load_dwordx4 v2, s[12:15], m0 offen lds
    s_add_u32 m0, m0, 8192
    v_exp_f32 v55, v55
    v_exp_f32 v56, v56
    v_cvt_pk_bf16_f32 v64, v48, v49
    v_cvt_pk_bf16_f32 v65, v50, v51
    v_cvt_pk_bf16_f32 v66, v52, v53
    v_cvt_pk_bf16_f32 v67, v54, v55
    v_exp_f32 v57, v57
    v_exp_f32 v58, v58
    v_mfma_f32_32x32x16_bf16 v[72:87], v[108:111], v[64:67], v[72:87]
    buffer_load_dwordx4 v2, s[12:15], m0 offen lds
    s_add_u32 m0, m0, 8192
    v_exp_f32 v59, v59
    v_exp_f32 v60, v60
    v_exp_f32 v61, v61
    v_exp_f32 v62, v62
    v_exp_f32_e64 v63, v63
    v_cvt_pk_bf16_f32 v68, v56, v57
    v_cvt_pk_bf16_f32 v69, v58, v59
    v_cvt_pk_bf16_f32 v70, v60, v61
    v_cvt_pk_bf16_f32 v71, v62, v63
    v_exp_f32 v32, v32
    s_waitcnt lgkmcnt(0)
    v_mfma_f32_32x32x8bf16_1k v[48:63], v[98:99], v[12:13], v[16:31]
    ds_read_b64 v[96:97], v3 offset:10240
    ds_read_b128 v[88:91], v2 offset:10240
    v_exp_f32 v33, v33
    v_exp_f32 v34, v34
    v_mfma_f32_32x32x16_bf16 v[72:87], v[112:115], v[68:71], v[72:87]
    buffer_load_dwordx4 v2, s[12:15], m0 offen lds
    s_add_u32 m0, m0, 8192
    v_exp_f32 v35, v35
    s_mov_b64 exec, s[24:25]
    ds_read_b128 v[108:111], v4 offset:7680
    ds_read_b128 v[112:115], v4 offset:8320
    s_mov_b64 exec, -1
    v_exp_f32 v36, v36
    v_exp_f32 v37, v37
    v_exp_f32 v38, v38
    v_mfma_f32_32x32x16_bf16 v[48:63], v[92:95], v[8:11], v[48:63]
    buffer_load_dwordx4 v2, s[12:15], m0 offen lds
    s_add_u32 m0, m0, 8192
    v_exp_f32 v39, v39
    v_exp_f32 v40, v40
    v_cvt_pk_bf16_f32 v64, v32, v33
    v_cvt_pk_bf16_f32 v65, v34, v35
    v_cvt_pk_bf16_f32 v66, v36, v37
    v_cvt_pk_bf16_f32 v67, v38, v39
    v_exp_f32 v41, v41
    v_exp_f32 v42, v42
    v_mfma_f32_32x32x16_bf16 v[72:87], v[100:103], v[64:67], v[72:87]
    buffer_load_dwordx4 v2, s[12:15], m0 offen lds
    s_add_u32 m0, m0, 8192
    v_exp_f32 v43, v43
    v_exp_f32 v44, v44
    v_exp_f32 v45, v45
    v_exp_f32 v46, v46
    v_exp_f32_e64 v47, v47
    v_cvt_pk_bf16_f32 v68, v40, v41
    v_cvt_pk_bf16_f32 v69, v42, v43
    v_cvt_pk_bf16_f32 v70, v44, v45
    v_cvt_pk_bf16_f32 v71, v46, v47
    v_exp_f32 v48, v48
    s_waitcnt lgkmcnt(0)
    v_mfma_f32_32x32x8bf16_1k v[32:47], v[96:97], v[12:13], v[16:31]
    ds_read_b64 v[98:99], v3 offset:12800
    ds_read_b128 v[92:95], v2 offset:12800
    v_exp_f32 v49, v49
    v_exp_f32 v50, v50
    v_mfma_f32_32x32x16_bf16 v[72:87], v[104:107], v[68:71], v[72:87]
    s_cbranch_vccnz k_attn_kernel_p_6
    s_setprio 0
k_attn_kernel_p_6:
    buffer_load_dwordx4 v2, s[12:15], m0 offen lds
    s_add_u32 m0, m0, 8192
    v_exp_f32 v51, v51
    s_mov_b64 exec, s[24:25]
    ds_read_b128 v[100:103], v4 offset:10240
    ds_read_b128 v[104:107], v4 offset:10880
    s_mov_b64 exec, -1
    v_exp_f32 v52, v52
    v_exp_f32 v53, v53
    v_exp_f32 v54, v54
    v_mfma_f32_32x32x16_bf16 v[32:47], v[88:91], v[8:11], v[32:47]
    buffer_load_dwordx4 v2, s[12:15], m0 offen lds
    s_add_u32 m0, m0, 8192
    v_exp_f32 v55, v55
    v_exp_f32 v56, v56
    v_cvt_pk_bf16_f32 v64, v48, v49
    v_cvt_pk_bf16_f32 v65, v50, v51
    v_cvt_pk_bf16_f32 v66, v52, v53
    v_cvt_pk_bf16_f32 v67, v54, v55
    v_exp_f32 v57, v57
    v_exp_f32 v58, v58
    v_mfma_f32_32x32x16_bf16 v[72:87], v[108:111], v[64:67], v[72:87]
    buffer_load_dwordx4 v2, s[12:15], m0 offen lds
    s_add_u32 m0, m0, 8192
    v_exp_f32 v59, v59
    v_exp_f32 v60, v60
    v_exp_f32 v61, v61
    v_exp_f32 v62, v62
    v_exp_f32_e64 v63, v63
    v_cvt_pk_bf16_f32 v68, v56, v57
    v_cvt_pk_bf16_f32 v69, v58, v59
    v_cvt_pk_bf16_f32 v70, v60, v61
    v_cvt_pk_bf16_f32 v71, v62, v63
    s_cbranch_vccnz k_attn_kernel_p_7
    s_setprio 2
k_attn_kernel_p_7:
    v_exp_f32 v32, v32
    s_waitcnt lgkmcnt(0)
    v_mfma_f32_32x32x8bf16_1k v[48:63], v[98:99], v[12:13], v[16:31]
    ds_read_b64 v[96:97], v3 offset:15360
    ds_read_b128 v[88:91], v2 offset:15360
    v_exp_f32 v33, v33
    v_exp_f32 v34, v34
    v_mfma_f32_32x32x16_bf16 v[72:87], v[112:115], v[68:71], v[72:87]
    buffer_load_dwordx4 v2, s[12:15], m0 offen lds
    s_add_u32 m0, m0, 8192
    v_exp_f32 v35, v35
    s_mov_b64 exec, s[24:25]
    ds_read_b128 v[108:111], v4 offset:12800
    ds_read_b128 v[112:115], v4 offset:13440
    s_mov_b64 exec, -1
    v_exp_f32 v36, v36
    v_exp_f32 v37, v37
    v_exp_f32 v38, v38
    v_mfma_f32_32x32x16_bf16 v[48:63], v[92:95], v[8:11], v[48:63]
    buffer_load_dwordx4 v2, s[12:15], m0 offen lds
    s_add_u32 m0, m0, 8192
    v_exp_f32 v39, v39
    v_exp_f32 v40, v40
    v_cvt_pk_bf16_f32 v64, v32, v33
    v_cvt_pk_bf16_f32 v65, v34, v35
    v_cvt_pk_bf16_f32 v66, v36, v37
    v_cvt_pk_bf16_f32 v67, v38, v39
    v_exp_f32 v41, v41
    v_exp_f32 v42, v42
    v_mfma_f32_32x32x16_bf16 v[72:87], v[100:103], v[64:67], v[72:87]
    buffer_load_dwordx4 v2, s[12:15], m0 offen lds
    s_add_u32 m0, m0, 8192
    v_exp_f32 v43, v43
    v_exp_f32 v44, v44
    v_exp_f32 v45, v45
    v_exp_f32 v46, v46
    v_exp_f32_e64 v47, v47
    v_cvt_pk_bf16_f32 v68, v40, v41
    v_cvt_pk_bf16_f32 v69, v42, v43
    v_cvt_pk_bf16_f32 v70, v44, v45
    v_cvt_pk_bf16_f32 v71, v46, v47
    v_exp_f32 v48, v48
    s_waitcnt lgkmcnt(0)
    v_mfma_f32_32x32x8bf16_1k v[32:47], v[96:97], v[12:13], v[16:31]
    ds_read_b64 v[98:99], v3 offset:17920
    ds_read_b128 v[92:95], v2 offset:17920
    v_exp_f32 v49, v49
    v_exp_f32 v50, v50
    v_mfma_f32_32x32x16_bf16 v[72:87], v[104:107], v[68:71], v[72:87]
    buffer_load_dwordx4 v2, s[12:15], m0 offen lds
    s_add_u32 m0, m0, 8192
    v_exp_f32 v51, v51
    s_mov_b64 exec, s[24:25]
    ds_read_b128 v[100:103], v4 offset:15360
    ds_read_b128 v[104:107], v4 offset:16000
    s_mov_b64 exec, -1
    v_exp_f32 v52, v52
    v_exp_f32 v53, v53
    v_exp_f32 v54, v54
    v_mfma_f32_32x32x16_bf16 v[32:47], v[88:91], v[8:11], v[32:47]
    v_exp_f32 v55, v55
    v_exp_f32 v56, v56
    v_cvt_pk_bf16_f32 v64, v48, v49
    v_cvt_pk_bf16_f32 v65, v50, v51
    v_cvt_pk_bf16_f32 v66, v52, v53
    v_cvt_pk_bf16_f32 v67, v54, v55
    v_exp_f32 v57, v57
    v_exp_f32 v58, v58
    v_mfma_f32_32x32x16_bf16 v[72:87], v[108:111], v[64:67], v[72:87]
    v_exp_f32 v59, v59
    v_exp_f32 v60, v60
    v_exp_f32 v61, v61
    v_exp_f32 v62, v62
    v_exp_f32_e64 v63, v63
    v_cvt_pk_bf16_f32 v68, v56, v57
    v_cvt_pk_bf16_f32 v69, v58, v59
    v_cvt_pk_bf16_f32 v70, v60, v61
    v_cvt_pk_bf16_f32 v71, v62, v63
    v_exp_f32 v32, v32
    s_waitcnt lgkmcnt(0)
    v_mfma_f32_32x32x8bf16_1k v[48:63], v[98:99], v[12:13], v[16:31]
    ds_read_b64 v[96:97], v3 offset:20480
    ds_read_b128 v[88:91], v2 offset:20480
    v_exp_f32 v33, v33
    v_exp_f32 v34, v34
    v_mfma_f32_32x32x16_bf16 v[72:87], v[112:115], v[68:71], v[72:87]
    v_exp_f32 v35, v35
    s_mov_b64 exec, s[24:25]
    ds_read_b128 v[108:111], v4 offset:17920
    ds_read_b128 v[112:115], v4 offset:18560
    s_mov_b64 exec, -1
    v_exp_f32 v36, v36
    v_exp_f32 v37, v37
    v_exp_f32 v38, v38
    v_mfma_f32_32x32x16_bf16 v[48:63], v[92:95], v[8:11], v[48:63]
    v_exp_f32 v39, v39
    v_exp_f32 v40, v40
    v_cvt_pk_bf16_f32 v64, v32, v33
    v_cvt_pk_bf16_f32 v65, v34, v35
    v_cvt_pk_bf16_f32 v66, v36, v37
    v_cvt_pk_bf16_f32 v67, v38, v39
    v_exp_f32 v41, v41
    v_exp_f32 v42, v42
    v_mfma_f32_32x32x16_bf16 v[72:87], v[100:103], v[64:67], v[72:87]
    v_exp_f32 v43, v43
    v_exp_f32 v44, v44
    v_exp_f32 v45, v45
    v_exp_f32 v46, v46
    v_exp_f32_e64 v47, v47
    v_cvt_pk_bf16_f32 v68, v40, v41
    v_cvt_pk_bf16_f32 v69, v42, v43
    v_cvt_pk_bf16_f32 v70, v44, v45
    v_cvt_pk_bf16_f32 v71, v46, v47
    v_exp_f32 v48, v48
    s_waitcnt lgkmcnt(0)
    v_mfma_f32_32x32x8bf16_1k v[32:47], v[96:97], v[12:13], v[16:31]
    ds_read_b64 v[98:99], v3 offset:23040
    ds_read_b128 v[92:95], v2 offset:23040
    v_exp_f32 v49, v49
    v_exp_f32 v50, v50
    v_mfma_f32_32x32x16_bf16 v[72:87], v[104:107], v[68:71], v[72:87]
    s_cbranch_vccnz k_attn_kernel_p_8
    s_setprio 0
k_attn_kernel_p_8:
    v_exp_f32 v51, v51
    s_mov_b64 exec, s[24:25]
    ds_read_b128 v[100:103], v4 offset:20480
    ds_read_b128 v[104:107], v4 offset:21120
    s_mov_b64 exec, -1
    v_exp_f32 v52, v52
    v_exp_f32 v53, v53
    v_exp_f32 v54, v54
    v_mfma_f32_32x32x16_bf16 v[32:47], v[88:91], v[8:11], v[32:47]
    v_exp_f32 v55, v55
    v_exp_f32 v56, v56
    v_cvt_pk_bf16_f32 v64, v48, v49
    v_cvt_pk_bf16_f32 v65, v50, v51
    v_cvt_pk_bf16_f32 v66, v52, v53
    v_cvt_pk_bf16_f32 v67, v54, v55
    v_exp_f32 v57, v57
    v_exp_f32 v58, v58
    v_mfma_f32_32x32x16_bf16 v[72:87], v[108:111], v[64:67], v[72:87]
    v_exp_f32 v59, v59
    v_exp_f32 v60, v60
    v_exp_f32 v61, v61
    v_exp_f32 v62, v62
    v_exp_f32_e64 v63, v63
    v_cvt_pk_bf16_f32 v68, v56, v57
    v_cvt_pk_bf16_f32 v69, v58, v59
    v_cvt_pk_bf16_f32 v70, v60, v61
    v_cvt_pk_bf16_f32 v71, v62, v63
    v_add_u32 v2, 20480, v2
    v_add_u32 v3, 20480, v3
    v_add_u32 v4, 20480, v4
    s_mov_b32 s29, 2
    s_waitcnt vmcnt(0)
    s_barrier
.p2align 3
k_attn_kernel_loop:
    s_cbranch_vccnz k_attn_kernel_p_9
    s_setprio 2
k_attn_kernel_p_9:
    v_exp_f32 v32, v32
    s_waitcnt lgkmcnt(0)
    v_mfma_f32_32x32x8bf16_1k v[48:63], v[98:99], v[12:13], v[16:31]
    ds_read_b64 v[96:97], v3 offset:5120
    ds_read_b128 v[88:91], v2 offset:5120
    v_exp_f32 v33, v33
    v_exp_f32 v34, v34
    v_mfma_f32_32x32x16_bf16 v[72:87], v[112:115], v[68:71], v[72:87]
    v_exp_f32 v35, v35
    s_mov_b64 exec, s[24:25]
    ds_read_b128 v[108:111], v4 offset:2560
    ds_read_b128 v[112:115], v4 offset:3200
    s_mov_b64 exec, -1
    v_exp_f32 v36, v36
    v_exp_f32 v37, v37
    v_exp_f32 v38, v38
    v_mfma_f32_32x32x16_bf16 v[48:63], v[92:95], v[8:11], v[48:63]
    v_exp_f32 v39, v39
    v_exp_f32 v40, v40
    v_cvt_pk_bf16_f32 v64, v32, v33
    v_cvt_pk_bf16_f32 v65, v34, v35
    v_cvt_pk_bf16_f32 v66, v36, v37
    v_cvt_pk_bf16_f32 v67, v38, v39
    v_exp_f32 v41, v41
    v_exp_f32 v42, v42
    v_mfma_f32_32x32x16_bf16 v[72:87], v[100:103], v[64:67], v[72:87]
    v_exp_f32 v43, v43
    v_exp_f32 v44, v44
    v_exp_f32 v45, v45
    v_exp_f32 v46, v46
    v_exp_f32_e64 v47, v47
    v_cvt_pk_bf16_f32 v68, v40, v41
    v_cvt_pk_bf16_f32 v69, v42, v43
    v_cvt_pk_bf16_f32 v70, v44, v45
    v_cvt_pk_bf16_f32 v71, v46, v47
    v_exp_f32 v48, v48
    s_waitcnt lgkmcnt(0)
    v_mfma_f32_32x32x8bf16_1k v[32:47], v[96:97], v[12:13], v[16:31]
    ds_read_b64 v[98:99], v3 offset:7680
    ds_read_b128 v[92:95], v2 offset:7680
    v_exp_f32 v49, v49
    v_exp_f32 v50, v50
    v_mfma_f32_32x32x16_bf16 v[72:87], v[104:107], v[68:71], v[72:87]
    v_exp_f32 v51, v51
    s_mov_b64 exec, s[24:25]
    ds_read_b128 v[100:103], v4 offset:5120
    ds_read_b128 v[104:107], v4 offset:5760
    s_mov_b64 exec, -1
    v_exp_f32 v52, v52
    v_exp_f32 v53, v53
    v_exp_f32 v54, v54
    v_mfma_f32_32x32x16_bf16 v[32:47], v[88:91], v[8:11], v[32:47]
    v_exp_f32 v55, v55
    v_exp_f32 v56, v56
    v_cvt_pk_bf16_f32 v64, v48, v49
    v_cvt_pk_bf16_f32 v65, v50, v51
    v_cvt_pk_bf16_f32 v66, v52, v53
    v_cvt_pk_bf16_f32 v67, v54, v55
    v_exp_f32 v57, v57
    v_exp_f32 v58, v58
    v_mfma_f32_32x32x16_bf16 v[72:87], v[108:111], v[64:67], v[72:87]
    v_exp_f32 v59, v59
    v_exp_f32 v60, v60
    v_exp_f32 v61, v61
    v_exp_f32 v62, v62
    v_exp_f32_e64 v63, v63
    v_cvt_pk_bf16_f32 v68, v56, v57
    v_cvt_pk_bf16_f32 v69, v58, v59
    v_cvt_pk_bf16_f32 v70, v60, v61
    v_cvt_pk_bf16_f32 v71, v62, v63
    v_exp_f32 v32, v32
    s_waitcnt lgkmcnt(0)
    v_mfma_f32_32x32x8bf16_1k v[48:63], v[98:99], v[12:13], v[16:31]
    ds_read_b64 v[96:97], v3 offset:10240
    ds_read_b128 v[88:91], v2 offset:10240
    v_exp_f32 v33, v33
    v_exp_f32 v34, v34
    v_mfma_f32_32x32x16_bf16 v[72:87], v[112:115], v[68:71], v[72:87]
    v_exp_f32 v35, v35
    s_mov_b64 exec, s[24:25]
    ds_read_b128 v[108:111], v4 offset:7680
    ds_read_b128 v[112:115], v4 offset:8320
    s_mov_b64 exec, -1
    v_exp_f32 v36, v36
    v_exp_f32 v37, v37
    v_exp_f32 v38, v38
    v_mfma_f32_32x32x16_bf16 v[48:63], v[92:95], v[8:11], v[48:63]
    v_exp_f32 v39, v39
    v_exp_f32 v40, v40
    v_cvt_pk_bf16_f32 v64, v32, v33
    v_cvt_pk_bf16_f32 v65, v34, v35
    v_cvt_pk_bf16_f32 v66, v36, v37
    v_cvt_pk_bf16_f32 v67, v38, v39
    v_exp_f32 v41, v41
    v_exp_f32 v42, v42
    v_mfma_f32_32x32x16_bf16 v[72:87], v[100:103], v[64:67], v[72:87]
    v_exp_f32 v43, v43
    v_exp_f32 v44, v44
    v_exp_f32 v45, v45
    v_exp_f32 v46, v46
    v_exp_f32_e64 v47, v47
    v_cvt_pk_bf16_f32 v68, v40, v41
    v_cvt_pk_bf16_f32 v69, v42, v43
    v_cvt_pk_bf16_f32 v70, v44, v45
    v_cvt_pk_bf16_f32 v71, v46, v47
    v_exp_f32 v48, v48
    s_waitcnt lgkmcnt(0)
    v_mfma_f32_32x32x8bf16_1k v[32:47], v[96:97], v[12:13], v[16:31]
    ds_read_b64 v[98:99], v3 offset:12800
    ds_read_b128 v[92:95], v2 offset:12800
    v_exp_f32 v49, v49
    v_exp_f32 v50, v50
    v_mfma_f32_32x32x16_bf16 v[72:87], v[104:107], v[68:71], v[72:87]
    s_cbranch_vccnz k_attn_kernel_p_10
    s_setprio 0
k_attn_kernel_p_10:
    v_exp_f32 v51, v51
    s_mov_b64 exec, s[24:25]
    ds_read_b128 v[100:103], v4 offset:10240
    ds_read_b128 v[104:107], v4 offset:10880
    s_mov_b64 exec, -1
    v_exp_f32 v52, v52
    v_exp_f32 v53, v53
    v_exp_f32 v54, v54
    v_mfma_f32_32x32x16_bf16 v[32:47], v[88:91], v[8:11], v[32:47]
    v_exp_f32 v55, v55
    v_exp_f32 v56, v56
    v_cvt_pk_bf16_f32 v64, v48, v49
    v_cvt_pk_bf16_f32 v65, v50, v51
    v_cvt_pk_bf16_f32 v66, v52, v53
    v_cvt_pk_bf16_f32 v67, v54, v55
    v_exp_f32 v57, v57
    v_exp_f32 v58, v58
    v_mfma_f32_32x32x16_bf16 v[72:87], v[108:111], v[64:67], v[72:87]
    v_exp_f32 v59, v59
    v_exp_f32 v60, v60
    v_exp_f32 v61, v61
    v_exp_f32 v62, v62
    v_exp_f32_e64 v63, v63
    v_cvt_pk_bf16_f32 v68, v56, v57
    v_cvt_pk_bf16_f32 v69, v58, v59
    v_cvt_pk_bf16_f32 v70, v60, v61
    v_cvt_pk_bf16_f32 v71, v62, v63
    v_add_u32 v2, 10240, v2
    v_add_u32 v3, 10240, v3
    v_add_u32 v4, 10240, v4
    s_add_u32 s29, s29, 1
    s_cmp_eq_u32 s29, s27
    s_cbranch_scc1 k_attn_kernel_pld
    s_cmp_eq_u32 s29, s28
    s_cbranch_scc1 k_attn_kernel_pst
    s_cmp_eq_u32 s29, s38
    s_cbranch_scc1 k_attn_kernel_pf
    s_cmp_lt_u32 s29, 15
    s_cbranch_scc1 k_attn_kernel_loop
.p2align 3
    s_cbranch_vccnz k_attn_kernel_p_11
    s_setprio 2
k_attn_kernel_p_11:
    v_exp_f32 v32, v32
    s_waitcnt lgkmcnt(0)
    v_mfma_f32_32x32x8bf16_1k v[48:63], v[98:99], v[12:13], v[16:31]
    ds_read_b64 v[96:97], v3 offset:5120
    ds_read_b128 v[88:91], v2 offset:5120
    v_exp_f32 v33, v33
    v_exp_f32 v34, v34
    v_mfma_f32_32x32x16_bf16 v[72:87], v[112:115], v[68:71], v[72:87]
    v_exp_f32 v35, v35
    s_mov_b64 exec, s[24:25]
    ds_read_b128 v[108:111], v4 offset:2560
    ds_read_b128 v[112:115], v4 offset:3200
    s_mov_b64 exec, -1
    v_exp_f32 v36, v36
    v_exp_f32 v37, v37
    v_exp_f32 v38, v38
    v_mfma_f32_32x32x16_bf16 v[48:63], v[92:95], v[8:11], v[48:63]
    v_exp_f32 v39, v39
    v_exp_f32 v40, v40
    v_cvt_pk_bf16_f32 v64, v32, v33
    v_cvt_pk_bf16_f32 v65, v34, v35
    v_cvt_pk_bf16_f32 v66, v36, v37
    v_cvt_pk_bf16_f32 v67, v38, v39
    v_exp_f32 v41, v41
    v_exp_f32 v42, v42
    v_mfma_f32_32x32x16_bf16 v[72:87], v[100:103], v[64:67], v[72:87]
    v_exp_f32 v43, v43
    v_exp_f32 v44, v44
    v_exp_f32 v45, v45
    v_exp_f32 v46, v46
    v_exp_f32_e64 v47, v47
    v_cvt_pk_bf16_f32 v68, v40, v41
    v_cvt_pk_bf16_f32 v69, v42, v43
    v_cvt_pk_bf16_f32 v70, v44, v45
    v_cvt_pk_bf16_f32 v71, v46, v47
    v_exp_f32 v48, v48
    s_waitcnt lgkmcnt(0)
    v_mfma_f32_32x32x8bf16_1k v[32:47], v[96:97], v[12:13], v[16:31]
    ds_read_b64 v[98:99], v3 offset:7680
    ds_read_b128 v[92:95], v2 offset:7680
    v_exp_f32 v49, v49
    v_exp_f32 v50, v50
    v_mfma_f32_32x32x16_bf16 v[72:87], v[104:107], v[68:71], v[72:87]
    v_exp_f32 v51, v51
    s_mov_b64 exec, s[24:25]
    ds_read_b128 v[100:103], v4 offset:5120
    ds_read_b128 v[104:107], v4 offset:5760
    s_mov_b64 exec, -1
    v_exp_f32 v52, v52
    v_exp_f32 v53, v53
    v_exp_f32 v54, v54
    v_mfma_f32_32x32x16_bf16 v[32:47], v[88:91], v[8:11], v[32:47]
    v_exp_f32 v55, v55
    v_exp_f32 v56, v56
    v_cvt_pk_bf16_f32 v64, v48, v49
    v_cvt_pk_bf16_f32 v65, v50, v51
    v_cvt_pk_bf16_f32 v66, v52, v53
    v_cvt_pk_bf16_f32 v67, v54, v55
    v_exp_f32 v57, v57
    v_exp_f32 v58, v58
    v_mfma_f32_32x32x16_bf16 v[72:87], v[108:111], v[64:67], v[72:87]
    v_exp_f32 v59, v59
    v_exp_f32 v60, v60
    v_exp_f32 v61, v61
    v_exp_f32 v62, v62
    v_exp_f32_e64 v63, v63
    v_cvt_pk_bf16_f32 v68, v56, v57
    v_cvt_pk_bf16_f32 v69, v58, v59
    v_cvt_pk_bf16_f32 v70, v60, v61
    v_cvt_pk_bf16_f32 v71, v62, v63
    v_exp_f32 v32, v32
    s_waitcnt lgkmcnt(0)
    v_mfma_f32_32x32x8bf16_1k v[48:63], v[98:99], v[12:13], v[16:31]
    v_exp_f32 v33, v33
    v_exp_f32 v34, v34
    v_mfma_f32_32x32x16_bf16 v[72:87], v[112:115], v[68:71], v[72:87]
    v_exp_f32 v35, v35
    s_mov_b64 exec, s[24:25]
    ds_read_b128 v[108:111], v4 offset:7680
    ds_read_b128 v[112:115], v4 offset:8320
    s_mov_b64 exec, -1
    v_exp_f32 v36, v36
    v_exp_f32 v37, v37
    v_exp_f32 v38, v38
    v_mfma_f32_32x32x16_bf16 v[48:63], v[92:95], v[8:11], v[48:63]
    v_exp_f32 v39, v39
    v_exp_f32 v40, v40
    v_cvt_pk_bf16_f32 v64, v32, v33
    v_cvt_pk_bf16_f32 v65, v34, v35
    v_cvt_pk_bf16_f32 v66, v36, v37
    v_cvt_pk_bf16_f32 v67, v38, v39
    v_exp_f32 v41, v41
    v_exp_f32 v42, v42
    v_mfma_f32_32x32x16_bf16 v[72:87], v[100:103], v[64:67], v[72:87]
    v_exp_f32 v43, v43
    v_exp_f32 v44, v44
    v_exp_f32 v45, v45
    v_exp_f32 v46, v46
    v_exp_f32_e64 v47, v47
    v_cvt_pk_bf16_f32 v68, v40, v41
    v_cvt_pk_bf16_f32 v69, v42, v43
    v_cvt_pk_bf16_f32 v70, v44, v45
    v_cvt_pk_bf16_f32 v71, v46, v47
    v_exp_f32 v48, v48
    s_waitcnt lgkmcnt(0)
    v_exp_f32 v49, v49
    v_exp_f32 v50, v50
    v_mfma_f32_32x32x16_bf16 v[72:87], v[104:107], v[68:71], v[72:87]
    s_cbranch_vccnz k_attn_kernel_p_12
    s_setprio 0
k_attn_kernel_p_12:
    v_exp_f32 v51, v51
    v_exp_f32 v52, v52
    v_exp_f32 v53, v53
    v_exp_f32 v54, v54
    v_exp_f32 v55, v55
    v_exp_f32 v56, v56
    v_cvt_pk_bf16_f32 v64, v48, v49
    v_cvt_pk_bf16_f32 v65, v50, v51
    v_cvt_pk_bf16_f32 v66, v52, v53
    v_cvt_pk_bf16_f32 v67, v54, v55
    v_exp_f32 v57, v57
    v_exp_f32 v58, v58
    v_mfma_f32_32x32x16_bf16 v[72:87], v[108:111], v[64:67], v[72:87]
    v_exp_f32 v59, v59
    v_exp_f32 v60, v60
    v_exp_f32 v61, v61
    v_exp_f32 v62, v62
    v_exp_f32_e64 v63, v63
    v_cvt_pk_bf16_f32 v68, v56, v57
    v_cvt_pk_bf16_f32 v69, v58, v59
    v_cvt_pk_bf16_f32 v70, v60, v61
    v_cvt_pk_bf16_f32 v71, v62, v63
    s_nop 1
    v_mfma_f32_32x32x16_bf16 v[72:87], v[112:115], v[68:71], v[72:87]
    s_nop 11
    v_mov_b32 v120, v80
    v_mov_b32 v121, v80
    s_nop 1
    v_permlane32_swap_b32 v120, v121
    v_cmp_gt_f32 vcc, 0x4e800000, v121
    s_cmp_eq_u64 vcc, -1
    s_cbranch_scc1 k_attn_kernel_done
    s_cmp_eq_u32 s26, 64
    s_cbranch_scc1 k_attn_kernel_done
    s_mov_b32 s26, 64
    s_mov_b32 s27, -1
    s_mov_b32 s28, -1
    s_mov_b32 s38, -1
    v_subrev_u32 v2, 153600, v2
    v_subrev_u32 v3, 153600, v3
    v_subrev_u32 v4, 153600, v4
    s_branch k_attn_kernel_maxpass
k_attn_kernel_pld:
    buffer_load_dwordx4 v[128:131], v124, s[48:51], s92 offen
    buffer_load_dwordx4 v[132:135], v125, s[52:55], s93 offen
    buffer_load_dwordx4 v[136:139], v126, s[56:59], s94 offen
    buffer_load_dwordx4 v[140:143], v127, s[60:63], s95 offen
    s_branch k_attn_kernel_loop
k_attn_kernel_pst:
    s_waitcnt vmcnt(0)
    buffer_store_dwordx4 v[128:131], v123, s[88:91], s30 offen sc1
    s_add_u32 s30, s30, 2097152
    buffer_store_dwordx4 v[132:135], v123, s[88:91], s30 offen sc1
    s_add_u32 s30, s30, 2097152
    buffer_store_dwordx4 v[136:139], v123, s[88:91], s30 offen sc1
    s_add_u32 s30, s30, 2097152
    buffer_store_dwordx4 v[140:143], v123, s[88:91], s30 offen sc1
    s_branch k_attn_kernel_loop
k_attn_kernel_pf:
    buffer_load_dword v128, v119, s[88:91], s31 offen
    buffer_load_dword v129, v119, s[88:91], s36 offen
    buffer_load_dword v130, v119, s[32:35], s37 offen
    s_branch k_attn_kernel_loop
k_attn_kernel_done:
    v_rcp_f32 v120, v121
    s_nop 0
    v_mul_f32 v72, v72, v120
    v_mul_f32 v73, v73, v120
    v_mul_f32 v74, v74, v120
    v_mul_f32 v75, v75, v120
    v_cvt_pk_bf16_f32 v64, v72, v73
    v_cvt_pk_bf16_f32 v65, v74, v75
    buffer_store_dwordx2 v[64:65], v116, s[20:23], 0 offen
    v_mul_f32 v76, v76, v120
    v_mul_f32 v77, v77, v120
    v_mul_f32 v78, v78, v120
    v_mul_f32 v79, v79, v120
    v_cvt_pk_bf16_f32 v66, v76, v77
    v_cvt_pk_bf16_f32 v67, v78, v79
    buffer_store_dwordx2 v[66:67], v117, s[20:23], 0 offen
    v_mul_f32 v80, v80, v120
    v_mul_f32 v81, v81, v120
    v_mul_f32 v82, v82, v120
    v_mul_f32 v83, v83, v120
    v_cvt_pk_bf16_f32 v68, v80, v81
    v_cvt_pk_bf16_f32 v69, v82, v83
    s_mov_b32 exec_hi, 0
    buffer_store_dwordx2 v[68:69], v118, s[20:23], 0 offen
k_attn_kernel_end:
    s_endpgm
.globl k_ffn_kernel
.p2align 8
.type k_ffn_kernel,@function
k_ffn_kernel:
    s_cmp_ge_u32 s2, 256
    s_cbranch_scc1 k_ffn_kernel_end
    s_load_dwordx2 s[8:9], s[0:1], 72
    s_load_dwordx2 s[6:7], s[0:1], 0
    s_load_dwordx2 s[10:11], s[0:1], 56
    v_lshrrev_b32 v1, 6, v0
    v_and_b32 v0, 63, v0
    v_readfirstlane_b32 s3, v1
    v_readfirstlane_b32 s101, v1
    s_and_b32 s28, s2, 7
    s_lshl_b32 s28, s28, 2
    s_bfe_u32 s29, s2, 0x20003
    s_add_u32 s28, s28, s29
    s_bfe_u32 s40, s2, 0x20001
    s_lshl_b32 s40, s40, 2
    s_add_u32 s40, s40, s29
    s_lshr_b32 s29, s2, 5
    s_and_b32 s41, s2, 1
    s_lshl_b32 s41, s41, 3
    s_add_u32 s41, s41, s29
    s_cmp_ge_u32 s3, 4
    s_cbranch_scc1 k_ffn_kernel_helper
    s_setprio 2
    s_lshr_b32 s38, s3, 1
    s_and_b32 s30, s3, 1
    s_lshl_b32 s30, s30, 1
    s_lshl_b32 s31, s28, 2
    s_add_u32 s30, s30, s31
    s_mul_i32 s31, s30, 20
    s_add_u32 s31, s31, s38
    s_lshl_b32 s31, s31, 10
    s_add_u32 s30, s30, s38
    s_mul_i32 s32, s38, 20480
    v_mbcnt_lo_u32_b32 v5, -1, 0
    v_mbcnt_hi_u32_b32 v5, -1, v5
    v_lshlrev_b32 v5, 4, v5
    v_add_u32 v7, 20480, v5
    v_subrev_u32 v7, s32, v7
    v_add_u32 v5, s32, v5
    s_waitcnt lgkmcnt(0)
    s_add_u32 s12, s8, 0x800000
    s_addc_u32 s13, s9, 0
    s_mov_b32 s14, 0x280000
    s_mov_b32 s15, 0x00020000
    s_add_u32 s32, s31, 0
    buffer_load_dwordx4 v[104:107], v5, s[12:15], s32 offen offset:0
    buffer_load_dwordx4 v[108:111], v7, s[12:15], s32 offen offset:0
    buffer_load_dwordx4 v[112:115], v5, s[12:15], s32 offen offset:2048
    buffer_load_dwordx4 v[116:119], v7, s[12:15], s32 offen offset:2048
    s_add_u32 s32, s31, 4096
    buffer_load_dwordx4 v[120:123], v5, s[12:15], s32 offen offset:0
    buffer_load_dwordx4 v[124:127], v7, s[12:15], s32 offen offset:0
    v_mbcnt_lo_u32_b32 v0, -1, 0
    v_mbcnt_hi_u32_b32 v0, -1, v0
    v_lshrrev_b32 v2, 2, v0
    v_mul_u32_u24 v2, 160, v2
    v_and_b32 v3, 3, v0
    v_lshl_add_u32 v2, v3, 3, v2
    s_mul_i32 s38, s38, 5120
    v_add_u32 v2, s38, v2
    v_add_u32 v3, 61440, v2
    v_add_u32 v4, 122880, v2
    v_and_b32 v1, 15, v0
    v_lshrrev_b32 v100, 4, v0
    v_mul_u32_u24 v98, 1280, v1
    v_lshl_add_u32 v98, v100, 3, v98
    s_mul_i32 s33, s30, 20480
    s_mul_i32 s34, s29, 160
    s_add_u32 s33, s33, s34
    v_lshlrev_b32 v99, 4, v1
    v_lshrrev_b32 v1, 1, v100
    v_lshl_add_u32 v99, v1, 9, v99
    v_and_b32 v1, 1, v100
    v_lshl_add_u32 v99, v1, 3, v99
    s_lshr_b32 s34, s30, 1
    s_mul_i32 s34, s34, 40
    s_mul_i32 s35, s29, 5
    s_add_u32 s34, s34, s35
    s_lshl_b32 s34, s34, 10
    s_and_b32 s35, s30, 1
    s_lshl_b32 s35, s35, 8
    s_add_u32 s34, s34, s35
    s_add_u32 s35, s34, 4096
    s_mov_b32 s16, s6
    s_mov_b32 s17, s7
    s_mov_b32 s18, 0x280000
    s_mov_b32 s19, 0x00020000
    s_add_u32 s20, s8, 0xb00000
    s_addc_u32 s21, s9, 0
    s_mov_b32 s22, 0x280000
    s_mov_b32 s23, 0x00020000
    s_mul_i32 s36, s3, 5120
    s_add_u32 s36, s36, 83968
    v_lshlrev_b32 v1, 4, v0
    v_add_u32 v100, s36, v1
    s_xor_b32 s36, s3, 2
    s_mul_i32 s36, s36, 5120
    s_add_u32 s36, s36, 83968
    v_add_u32 v101, s36, v1
    s_mov_b32 s39, 0xffff0000
    s_add_u32 s24, s8, 0x1500000
    s_addc_u32 s25, s9, 0
    s_mov_b32 s26, 0x20000
    s_mov_b32 s27, 0x00020000
    s_barrier
    ds_read_b64_tr_b16 v[8:9], v2 offset:2048
    ds_read_b64_tr_b16 v[10:11], v2 offset:4608
    ds_read_b64_tr_b16 v[12:13], v2 offset:2080
    ds_read_b64_tr_b16 v[14:15], v2 offset:4640
    ds_read_b64_tr_b16 v[16:17], v2 offset:2112
    ds_read_b64_tr_b16 v[18:19], v2 offset:4672
    ds_read_b64_tr_b16 v[20:21], v2 offset:2144
    ds_read_b64_tr_b16 v[22:23], v2 offset:4704
    ds_read_b64_tr_b16 v[24:25], v2 offset:2176
    ds_read_b64_tr_b16 v[26:27], v2 offset:4736
    s_waitcnt vmcnt(5) lgkmcnt(8)
    v_mfma_f32_16x16x32_bf16 v[48:51], v[8:11], v[104:107], 0
    ds_read_b64_tr_b16 v[28:29], v2 offset:12288
    s_waitcnt vmcnt(4)
    v_mfma_f32_16x16x32_bf16 v[68:71], v[8:11], v[108:111], 0
    ds_read_b64_tr_b16 v[30:31], v2 offset:14848
    buffer_load_dwordx4 v[128:131], v5, s[12:15], s32 offen offset:2048
    s_waitcnt lgkmcnt(8)
    v_mfma_f32_16x16x32_bf16 v[52:55], v[12:15], v[104:107], 0
    ds_read_b64_tr_b16 v[32:33], v2 offset:12320
    v_mfma_f32_16x16x32_bf16 v[72:75], v[12:15], v[108:111], 0
    ds_read_b64_tr_b16 v[34:35], v2 offset:14880
    buffer_load_dwordx4 v[132:135], v7, s[12:15], s32 offen offset:2048
    s_waitcnt lgkmcnt(8)
    v_mfma_f32_16x16x32_bf16 v[56:59], v[16:19], v[104:107], 0
    ds_read_b64_tr_b16 v[36:37], v2 offset:12352
    v_mfma_f32_16x16x32_bf16 v[76:79], v[16:19], v[108:111], 0
    ds_read_b64_tr_b16 v[38:39], v2 offset:14912
    s_add_u32 s32, s31, 8192
    buffer_load_dwordx4 v[136:139], v5, s[12:15], s32 offen offset:0
    s_waitcnt lgkmcnt(8)
    v_mfma_f32_16x16x32_bf16 v[60:63], v[20:23], v[104:107], 0
    ds_read_b64_tr_b16 v[40:41], v2 offset:12384
    v_mfma_f32_16x16x32_bf16 v[80:83], v[20:23], v[108:111], 0
    ds_read_b64_tr_b16 v[42:43], v2 offset:14944
    s_waitcnt lgkmcnt(8)
    v_mfma_f32_16x16x32_bf16 v[64:67], v[24:27], v[104:107], 0
    ds_read_b64_tr_b16 v[44:45], v2 offset:12416
    v_mfma_f32_16x16x32_bf16 v[84:87], v[24:27], v[108:111], 0
    ds_read_b64_tr_b16 v[46:47], v2 offset:14976
    s_waitcnt vmcnt(6) lgkmcnt(8)
    v_mfma_f32_16x16x32_bf16 v[48:51], v[28:31], v[112:115], v[48:51]
    s_waitcnt vmcnt(5)
    v_mfma_f32_16x16x32_bf16 v[68:71], v[28:31], v[116:119], v[68:71]
    buffer_load_dwordx4 v[140:143], v7, s[12:15], s32 offen offset:0
    s_waitcnt lgkmcnt(6)
    v_mfma_f32_16x16x32_bf16 v[52:55], v[32:35], v[112:115], v[52:55]
    v_mfma_f32_16x16x32_bf16 v[72:75], v[32:35], v[116:119], v[72:75]
    buffer_load_dwordx4 v[144:147], v5, s[12:15], s32 offen offset:2048
    s_waitcnt lgkmcnt(0)
    s_barrier
    v_mfma_f32_16x16x32_bf16 v[56:59], v[36:39], v[112:115], v[56:59]
    ds_read_b64_tr_b16 v[8:9], v2 offset:22528
    ds_read_b64_tr_b16 v[10:11], v2 offset:25088
    v_mfma_f32_16x16x32_bf16 v[76:79], v[36:39], v[116:119], v[76:79]
    ds_read_b64_tr_b16 v[12:13], v2 offset:22560
    ds_read_b64_tr_b16 v[14:15], v2 offset:25120
    buffer_load_dwordx4 v[148:151], v7, s[12:15], s32 offen offset:2048
    v_mfma_f32_16x16x32_bf16 v[60:63], v[40:43], v[112:115], v[60:63]
    ds_read_b64_tr_b16 v[16:17], v2 offset:22592
    ds_read_b64_tr_b16 v[18:19], v2 offset:25152
    v_mfma_f32_16x16x32_bf16 v[80:83], v[40:43], v[116:119], v[80:83]
    ds_read_b64_tr_b16 v[20:21], v2 offset:22624
    ds_read_b64_tr_b16 v[22:23], v2 offset:25184
    v_mfma_f32_16x16x32_bf16 v[64:67], v[44:47], v[112:115], v[64:67]
    ds_read_b64_tr_b16 v[24:25], v2 offset:22656
    ds_read_b64_tr_b16 v[26:27], v2 offset:25216
    v_mfma_f32_16x16x32_bf16 v[84:87], v[44:47], v[116:119], v[84:87]
    s_waitcnt vmcnt(7) lgkmcnt(8)
    v_mfma_f32_16x16x32_bf16 v[48:51], v[8:11], v[120:123], v[48:51]
    ds_read_b64_tr_b16 v[28:29], v2 offset:32768
    s_waitcnt vmcnt(6)
    v_mfma_f32_16x16x32_bf16 v[68:71], v[8:11], v[124:127], v[68:71]
    ds_read_b64_tr_b16 v[30:31], v2 offset:35328
    s_add_u32 s32, s31, 12288
    buffer_load_dwordx4 v[152:155], v5, s[12:15], s32 offen offset:0
    s_waitcnt lgkmcnt(8)
    v_mfma_f32_16x16x32_bf16 v[52:55], v[12:15], v[120:123], v[52:55]
    ds_read_b64_tr_b16 v[32:33], v2 offset:32800
    v_mfma_f32_16x16x32_bf16 v[72:75], v[12:15], v[124:127], v[72:75]
    ds_read_b64_tr_b16 v[34:35], v2 offset:35360
    buffer_load_dwordx4 v[156:159], v7, s[12:15], s32 offen offset:0
    s_waitcnt lgkmcnt(8)
    v_mfma_f32_16x16x32_bf16 v[56:59], v[16:19], v[120:123], v[56:59]
    ds_read_b64_tr_b16 v[36:37], v2 offset:32832
    v_mfma_f32_16x16x32_bf16 v[76:79], v[16:19], v[124:127], v[76:79]
    ds_read_b64_tr_b16 v[38:39], v2 offset:35392
    buffer_load_dwordx4 v[160:163], v5, s[12:15], s32 offen offset:2048
    s_waitcnt lgkmcnt(8)
    v_mfma_f32_16x16x32_bf16 v[60:63], v[20:23], v[120:123], v[60:63]
    ds_read_b64_tr_b16 v[40:41], v2 offset:32864
    v_mfma_f32_16x16x32_bf16 v[80:83], v[20:23], v[124:127], v[80:83]
    ds_read_b64_tr_b16 v[42:43], v2 offset:35424
    s_waitcnt lgkmcnt(8)
    v_mfma_f32_16x16x32_bf16 v[64:67], v[24:27], v[120:123], v[64:67]
    ds_read_b64_tr_b16 v[44:45], v2 offset:32896
    v_mfma_f32_16x16x32_bf16 v[84:87], v[24:27], v[124:127], v[84:87]
    ds_read_b64_tr_b16 v[46:47], v2 offset:35456
    s_waitcnt vmcnt(8) lgkmcnt(8)
    v_mfma_f32_16x16x32_bf16 v[48:51], v[28:31], v[128:131], v[48:51]
    s_waitcnt vmcnt(7)
    v_mfma_f32_16x16x32_bf16 v[68:71], v[28:31], v[132:135], v[68:71]
    buffer_load_dwordx4 v[164:167], v7, s[12:15], s32 offen offset:2048
    s_waitcnt lgkmcnt(6)
    v_mfma_f32_16x16x32_bf16 v[52:55], v[32:35], v[128:131], v[52:55]
    v_mfma_f32_16x16x32_bf16 v[72:75], v[32:35], v[132:135], v[72:75]
    s_add_u32 s32, s31, 16384
    buffer_load_dwordx4 v[168:171], v5, s[12:15], s32 offen offset:0
    s_waitcnt lgkmcnt(0)
    s_barrier
    v_mfma_f32_16x16x32_bf16 v[56:59], v[36:39], v[128:131], v[56:59]
    ds_read_b64_tr_b16 v[8:9], v2 offset:43008
    ds_read_b64_tr_b16 v[10:11], v2 offset:45568
    v_mfma_f32_16x16x32_bf16 v[76:79], v[36:39], v[132:135], v[76:79]
    ds_read_b64_tr_b16 v[12:13], v2 offset:43040
    ds_read_b64_tr_b16 v[14:15], v2 offset:45600
    buffer_load_dwordx4 v[172:175], v7, s[12:15], s32 offen offset:0
    v_mfma_f32_16x16x32_bf16 v[60:63], v[40:43], v[128:131], v[60:63]
    ds_read_b64_tr_b16 v[16:17], v2 offset:43072
    ds_read_b64_tr_b16 v[18:19], v2 offset:45632
    v_mfma_f32_16x16x32_bf16 v[80:83], v[40:43], v[132:135], v[80:83]
    ds_read_b64_tr_b16 v[20:21], v2 offset:43104
    ds_read_b64_tr_b16 v[22:23], v2 offset:45664
    v_mfma_f32_16x16x32_bf16 v[64:67], v[44:47], v[128:131], v[64:67]
    ds_read_b64_tr_b16 v[24:25], v2 offset:43136
    ds_read_b64_tr_b16 v[26:27], v2 offset:45696
    v_mfma_f32_16x16x32_bf16 v[84:87], v[44:47], v[132:135], v[84:87]
    s_waitcnt vmcnt(9) lgkmcnt(8)
    v_mfma_f32_16x16x32_bf16 v[48:51], v[8:11], v[136:139], v[48:51]
    ds_read_b64_tr_b16 v[28:29], v2 offset:53248
    s_waitcnt vmcnt(8)
    v_mfma_f32_16x16x32_bf16 v[68:71], v[8:11], v[140:143], v[68:71]
    ds_read_b64_tr_b16 v[30:31], v2 offset:55808
    buffer_load_dwordx4 v[176:179], v5, s[12:15], s32 offen offset:2048
    s_waitcnt lgkmcnt(8)
    v_mfma_f32_16x16x32_bf16 v[52:55], v[12:15], v[136:139], v[52:55]
    ds_read_b64_tr_b16 v[32:33], v2 offset:53280
    v_mfma_f32_16x16x32_bf16 v[72:75], v[12:15], v[140:143], v[72:75]
    ds_read_b64_tr_b16 v[34:35], v2 offset:55840
    buffer_load_dwordx4 v[180:183], v7, s[12:15], s32 offen offset:2048
    s_waitcnt lgkmcnt(8)
    v_mfma_f32_16x16x32_bf16 v[56:59], v[16:19], v[136:139], v[56:59]
    ds_read_b64_tr_b16 v[36:37], v2 offset:53312
    v_mfma_f32_16x16x32_bf16 v[76:79], v[16:19], v[140:143], v[76:79]
    ds_read_b64_tr_b16 v[38:39], v2 offset:55872
    buffer_load_dwordx2 v[88:89], v98, s[16:19], s33 offen offset:0
    s_waitcnt lgkmcnt(8)
    v_mfma_f32_16x16x32_bf16 v[60:63], v[20:23], v[136:139], v[60:63]
    ds_read_b64_tr_b16 v[40:41], v2 offset:53344
    v_mfma_f32_16x16x32_bf16 v[80:83], v[20:23], v[140:143], v[80:83]
    ds_read_b64_tr_b16 v[42:43], v2 offset:55904
    s_waitcnt lgkmcnt(8)
    v_mfma_f32_16x16x32_bf16 v[64:67], v[24:27], v[136:139], v[64:67]
    ds_read_b64_tr_b16 v[44:45], v2 offset:53376
    v_mfma_f32_16x16x32_bf16 v[84:87], v[24:27], v[140:143], v[84:87]
    ds_read_b64_tr_b16 v[46:47], v2 offset:55936
    s_waitcnt vmcnt(10) lgkmcnt(8)
    v_mfma_f32_16x16x32_bf16 v[48:51], v[28:31], v[144:147], v[48:51]
    s_waitcnt vmcnt(9)
    v_mfma_f32_16x16x32_bf16 v[68:71], v[28:31], v[148:151], v[68:71]
    buffer_load_dwordx2 v[90:91], v98, s[16:19], s33 offen offset:32
    s_waitcnt lgkmcnt(6)
    v_mfma_f32_16x16x32_bf16 v[52:55], v[32:35], v[144:147], v[52:55]
    v_mfma_f32_16x16x32_bf16 v[72:75], v[32:35], v[148:151], v[72:75]
    buffer_load_dwordx2 v[92:93], v98, s[16:19], s33 offen offset:64
    s_waitcnt lgkmcnt(0)
    s_barrier
    v_mfma_f32_16x16x32_bf16 v[56:59], v[36:39], v[144:147], v[56:59]
    ds_read_b64_tr_b16 v[8:9], v3 offset:2048
    ds_read_b64_tr_b16 v[10:11], v3 offset:4608
    v_mfma_f32_16x16x32_bf16 v[76:79], v[36:39], v[148:151], v[76:79]
    ds_read_b64_tr_b16 v[12:13], v3 offset:2080
    ds_read_b64_tr_b16 v[14:15], v3 offset:4640
    buffer_load_dwordx2 v[94:95], v98, s[16:19], s33 offen offset:96
    v_mfma_f32_16x16x32_bf16 v[60:63], v[40:43], v[144:147], v[60:63]
    ds_read_b64_tr_b16 v[16:17], v3 offset:2112
    ds_read_b64_tr_b16 v[18:19], v3 offset:4672
    v_mfma_f32_16x16x32_bf16 v[80:83], v[40:43], v[148:151], v[80:83]
    ds_read_b64_tr_b16 v[20:21], v3 offset:2144
    ds_read_b64_tr_b16 v[22:23], v3 offset:4704
    v_mfma_f32_16x16x32_bf16 v[64:67], v[44:47], v[144:147], v[64:67]
    ds_read_b64_tr_b16 v[24:25], v3 offset:2176
    ds_read_b64_tr_b16 v[26:27], v3 offset:4736
    v_mfma_f32_16x16x32_bf16 v[84:87], v[44:47], v[148:151], v[84:87]
    s_waitcnt vmcnt(11) lgkmcnt(8)
    v_mfma_f32_16x16x32_bf16 v[48:51], v[8:11], v[152:155], v[48:51]
    ds_read_b64_tr_b16 v[28:29], v3 offset:12288
    s_waitcnt vmcnt(10)
    v_mfma_f32_16x16x32_bf16 v[68:71], v[8:11], v[156:159], v[68:71]
    ds_read_b64_tr_b16 v[30:31], v3 offset:14848
    buffer_load_dwordx2 v[96:97], v98, s[16:19], s33 offen offset:128
    s_waitcnt lgkmcnt(8)
    v_mfma_f32_16x16x32_bf16 v[52:55], v[12:15], v[152:155], v[52:55]
    ds_read_b64_tr_b16 v[32:33], v3 offset:12320
    v_mfma_f32_16x16x32_bf16 v[72:75], v[12:15], v[156:159], v[72:75]
    ds_read_b64_tr_b16 v[34:35], v3 offset:14880
    s_waitcnt lgkmcnt(8)
    v_mfma_f32_16x16x32_bf16 v[56:59], v[16:19], v[152:155], v[56:59]
    ds_read_b64_tr_b16 v[36:37], v3 offset:12352
    v_mfma_f32_16x16x32_bf16 v[76:79], v[16:19], v[156:159], v[76:79]
    ds_read_b64_tr_b16 v[38:39], v3 offset:14912
    s_waitcnt lgkmcnt(8)
    v_mfma_f32_16x16x32_bf16 v[60:63], v[20:23], v[152:155], v[60:63]
    ds_read_b64_tr_b16 v[40:41], v3 offset:12384
    v_mfma_f32_16x16x32_bf16 v[80:83], v[20:23], v[156:159], v[80:83]
    ds_read_b64_tr_b16 v[42:43], v3 offset:14944
    s_waitcnt lgkmcnt(8)
    v_mfma_f32_16x16x32_bf16 v[64:67], v[24:27], v[152:155], v[64:67]
    ds_read_b64_tr_b16 v[44:45], v3 offset:12416
    v_mfma_f32_16x16x32_bf16 v[84:87], v[24:27], v[156:159], v[84:87]
    ds_read_b64_tr_b16 v[46:47], v3 offset:14976
    s_waitcnt vmcnt(10) lgkmcnt(8)
    v_mfma_f32_16x16x32_bf16 v[48:51], v[28:31], v[160:163], v[48:51]
    s_waitcnt vmcnt(9)
    v_mfma_f32_16x16x32_bf16 v[68:71], v[28:31], v[164:167], v[68:71]
    s_waitcnt lgkmcnt(6)
    v_mfma_f32_16x16x32_bf16 v[52:55], v[32:35], v[160:163], v[52:55]
    v_mfma_f32_16x16x32_bf16 v[72:75], v[32:35], v[164:167], v[72:75]
    s_waitcnt lgkmcnt(0)
    s_barrier
    v_mfma_f32_16x16x32_bf16 v[56:59], v[36:39], v[160:163], v[56:59]
    ds_read_b64_tr_b16 v[8:9], v3 offset:22528
    ds_read_b64_tr_b16 v[10:11], v3 offset:25088
    v_mfma_f32_16x16x32_bf16 v[76:79], v[36:39], v[164:167], v[76:79]
    ds_read_b64_tr_b16 v[12:13], v3 offset:22560
    ds_read_b64_tr_b16 v[14:15], v3 offset:25120
    v_mfma_f32_16x16x32_bf16 v[60:63], v[40:43], v[160:163], v[60:63]
    ds_read_b64_tr_b16 v[16:17], v3 offset:22592
    ds_read_b64_tr_b16 v[18:19], v3 offset:25152
    v_mfma_f32_16x16x32_bf16 v[80:83], v[40:43], v[164:167], v[80:83]
    ds_read_b64_tr_b16 v[20:21], v3 offset:22624
    ds_read_b64_tr_b16 v[22:23], v3 offset:25184
    v_mfma_f32_16x16x32_bf16 v[64:67], v[44:47], v[160:163], v[64:67]
    ds_read_b64_tr_b16 v[24:25], v3 offset:22656
    ds_read_b64_tr_b16 v[26:27], v3 offset:25216
    v_mfma_f32_16x16x32_bf16 v[84:87], v[44:47], v[164:167], v[84:87]
    s_waitcnt vmcnt(8) lgkmcnt(8)
    v_mfma_f32_16x16x32_bf16 v[48:51], v[8:11], v[168:171], v[48:51]
    ds_read_b64_tr_b16 v[28:29], v3 offset:32768
    s_waitcnt vmcnt(7)
    v_mfma_f32_16x16x32_bf16 v[68:71], v[8:11], v[172:175], v[68:71]
    ds_read_b64_tr_b16 v[30:31], v3 offset:35328
    s_waitcnt lgkmcnt(8)
    v_mfma_f32_16x16x32_bf16 v[52:55], v[12:15], v[168:171], v[52:55]
    ds_read_b64_tr_b16 v[32:33], v3 offset:32800
    v_mfma_f32_16x16x32_bf16 v[72:75], v[12:15], v[172:175], v[72:75]
    ds_read_b64_tr_b16 v[34:35], v3 offset:35360
    s_waitcnt lgkmcnt(8)
    v_mfma_f32_16x16x32_bf16 v[56:59], v[16:19], v[168:171], v[56:59]
    ds_read_b64_tr_b16 v[36:37], v3 offset:32832
    v_mfma_f32_16x16x32_bf16 v[76:79], v[16:19], v[172:175], v[76:79]
    ds_read_b64_tr_b16 v[38:39], v3 offset:35392
    s_waitcnt lgkmcnt(8)
    v_mfma_f32_16x16x32_bf16 v[60:63], v[20:23], v[168:171], v[60:63]
    ds_read_b64_tr_b16 v[40:41], v3 offset:32864
    v_mfma_f32_16x16x32_bf16 v[80:83], v[20:23], v[172:175], v[80:83]
    ds_read_b64_tr_b16 v[42:43], v3 offset:35424
    s_waitcnt lgkmcnt(8)
    v_mfma_f32_16x16x32_bf16 v[64:67], v[24:27], v[168:171], v[64:67]
    ds_read_b64_tr_b16 v[44:45], v3 offset:32896
    v_mfma_f32_16x16x32_bf16 v[84:87], v[24:27], v[172:175], v[84:87]
    ds_read_b64_tr_b16 v[46:47], v3 offset:35456
    s_waitcnt vmcnt(6) lgkmcnt(8)
    v_mfma_f32_16x16x32_bf16 v[48:51], v[28:31], v[176:179], v[48:51]
    s_waitcnt vmcnt(5)
    v_mfma_f32_16x16x32_bf16 v[68:71], v[28:31], v[180:183], v[68:71]
    s_waitcnt lgkmcnt(6)
    v_mfma_f32_16x16x32_bf16 v[52:55], v[32:35], v[176:179], v[52:55]
    v_mfma_f32_16x16x32_bf16 v[72:75], v[32:35], v[180:183], v[72:75]
    s_waitcnt lgkmcnt(0)
    s_barrier
    v_mfma_f32_16x16x32_bf16 v[56:59], v[36:39], v[176:179], v[56:59]
    v_mfma_f32_16x16x32_bf16 v[76:79], v[36:39], v[180:183], v[76:79]
    v_mfma_f32_16x16x32_bf16 v[60:63], v[40:43], v[176:179], v[60:63]
    v_mfma_f32_16x16x32_bf16 v[80:83], v[40:43], v[180:183], v[80:83]
    v_mfma_f32_16x16x32_bf16 v[64:67], v[44:47], v[176:179], v[64:67]
    v_mfma_f32_16x16x32_bf16 v[84:87], v[44:47], v[180:183], v[84:87]
    ds_write_b128 v100, v[68:71] offset:0
    ds_write_b128 v100, v[72:75] offset:1024
    s_nop 1
    ds_write_b128 v100, v[76:79] offset:2048
    s_nop 0
    ds_write_b128 v100, v[80:83] offset:3072
    s_nop 0
    ds_write_b128 v100, v[84:87] offset:4096
    v_mov_b32 v8, 0
    v_mov_b32 v9, 0
    v_mov_b32 v10, 0
    v_mov_b32 v11, 0
    s_waitcnt lgkmcnt(0)
    s_barrier
    ds_read_b128 v[68:71], v101 offset:0
    ds_read_b128 v[72:75], v101 offset:1024
    ds_read_b128 v[76:79], v101 offset:2048
    ds_read_b128 v[80:83], v101 offset:3072
    ds_read_b128 v[84:87], v101 offset:4096
    s_waitcnt vmcnt(0)
    v_lshlrev_b32 v12, 16, v88
    v_and_b32 v13, s39, v88
    v_lshlrev_b32 v14, 16, v89
    v_and_b32 v15, s39, v89
    s_waitcnt lgkmcnt(4)
    v_pk_add_f32 v[48:49], v[48:49], v[68:69]
    v_pk_add_f32 v[50:51], v[50:51], v[70:71]
    v_pk_add_f32 v[48:49], v[48:49], v[12:13]
    v_pk_add_f32 v[50:51], v[50:51], v[14:15]
    v_cvt_pk_bf16_f32 v88, v48, v49
    v_cvt_pk_bf16_f32 v89, v50, v51
    buffer_store_dwordx2 v[88:89], v99, s[20:23], s34 offen offset:0 sc1
    v_lshlrev_b32 v16, 16, v90
    v_and_b32 v17, s39, v90
    v_lshlrev_b32 v18, 16, v91
    v_and_b32 v19, s39, v91
    s_waitcnt lgkmcnt(3)
    v_pk_add_f32 v[52:53], v[52:53], v[72:73]
    v_pk_add_f32 v[54:55], v[54:55], v[74:75]
    v_pk_add_f32 v[52:53], v[52:53], v[16:17]
    v_pk_add_f32 v[54:55], v[54:55], v[18:19]
    v_cvt_pk_bf16_f32 v90, v52, v53
    v_cvt_pk_bf16_f32 v91, v54, v55
    buffer_store_dwordx2 v[90:91], v99, s[20:23], s34 offen offset:1024 sc1
    v_lshlrev_b32 v12, 16, v92
    v_and_b32 v13, s39, v92
    v_lshlrev_b32 v14, 16, v93
    v_and_b32 v15, s39, v93
    s_waitcnt lgkmcnt(2)
    v_pk_add_f32 v[56:57], v[56:57], v[76:77]
    v_pk_add_f32 v[58:59], v[58:59], v[78:79]
    v_pk_add_f32 v[56:57], v[56:57], v[12:13]
    v_pk_add_f32 v[58:59], v[58:59], v[14:15]
    v_cvt_pk_bf16_f32 v92, v56, v57
    v_cvt_pk_bf16_f32 v93, v58, v59
    buffer_store_dwordx2 v[92:93], v99, s[20:23], s34 offen offset:2048 sc1
    v_lshlrev_b32 v16, 16, v94
    v_and_b32 v17, s39, v94
    v_lshlrev_b32 v18, 16, v95
    v_and_b32 v19, s39, v95
    s_waitcnt lgkmcnt(1)
    v_pk_add_f32 v[60:61], v[60:61], v[80:81]
    v_pk_add_f32 v[62:63], v[62:63], v[82:83]
    v_pk_add_f32 v[60:61], v[60:61], v[16:17]
    v_pk_add_f32 v[62:63], v[62:63], v[18:19]
    v_cvt_pk_bf16_f32 v94, v60, v61
    v_cvt_pk_bf16_f32 v95, v62, v63
    buffer_store_dwordx2 v[94:95], v99, s[20:23], s34 offen offset:3072 sc1
    v_lshlrev_b32 v12, 16, v96
    v_and_b32 v13, s39, v96
    v_lshlrev_b32 v14, 16, v97
    v_and_b32 v15, s39, v97
    s_waitcnt lgkmcnt(0)
    v_pk_add_f32 v[64:65], v[64:65], v[84:85]
    v_pk_add_f32 v[66:67], v[66:67], v[86:87]
    v_pk_add_f32 v[64:65], v[64:65], v[12:13]
    v_pk_add_f32 v[66:67], v[66:67], v[14:15]
    v_cvt_pk_bf16_f32 v96, v64, v65
    v_cvt_pk_bf16_f32 v97, v66, v67
    buffer_store_dwordx2 v[96:97], v99, s[20:23], s35 offen offset:0 sc1
    v_lshlrev_b32 v12, 16, v88
    v_and_b32 v13, s39, v88
    v_lshlrev_b32 v14, 16, v89
    v_and_b32 v15, s39, v89
    v_pk_add_f32 v[8:9], v[8:9], v[12:13]
    v_pk_fma_f32 v[10:11], v[12:13], v[12:13], v[10:11]
    v_pk_add_f32 v[8:9], v[8:9], v[14:15]
    v_pk_fma_f32 v[10:11], v[14:15], v[14:15], v[10:11]
    v_lshlrev_b32 v16, 16, v90
    v_and_b32 v17, s39, v90
    v_lshlrev_b32 v18, 16, v91
    v_and_b32 v19, s39, v91
    v_pk_add_f32 v[8:9], v[8:9], v[16:17]
    v_pk_fma_f32 v[10:11], v[16:17], v[16:17], v[10:11]
    v_pk_add_f32 v[8:9], v[8:9], v[18:19]
    v_pk_fma_f32 v[10:11], v[18:19], v[18:19], v[10:11]
    v_lshlrev_b32 v12, 16, v92
    v_and_b32 v13, s39, v92
    v_lshlrev_b32 v14, 16, v93
    v_and_b32 v15, s39, v93
    v_pk_add_f32 v[8:9], v[8:9], v[12:13]
    v_pk_fma_f32 v[10:11], v[12:13], v[12:13], v[10:11]
    v_pk_add_f32 v[8:9], v[8:9], v[14:15]
    v_pk_fma_f32 v[10:11], v[14:15], v[14:15], v[10:11]
    v_lshlrev_b32 v16, 16, v94
    v_and_b32 v17, s39, v94
    v_lshlrev_b32 v18, 16, v95
    v_and_b32 v19, s39, v95
    v_pk_add_f32 v[8:9], v[8:9], v[16:17]
    v_pk_fma_f32 v[10:11], v[16:17], v[16:17], v[10:11]
    v_pk_add_f32 v[8:9], v[8:9], v[18:19]
    v_pk_fma_f32 v[10:11], v[18:19], v[18:19], v[10:11]
    v_lshlrev_b32 v12, 16, v96
    v_and_b32 v13, s39, v96
    v_lshlrev_b32 v14, 16, v97
    v_and_b32 v15, s39, v97
    v_pk_add_f32 v[8:9], v[8:9], v[12:13]
    v_pk_fma_f32 v[10:11], v[12:13], v[12:13], v[10:11]
    v_pk_add_f32 v[8:9], v[8:9], v[14:15]
    v_pk_fma_f32 v[10:11], v[14:15], v[14:15], v[10:11]
    v_add_f32 v8, v8, v9
    v_add_f32 v9, v10, v11
    v_mov_b32 v10, v8
    v_mov_b32 v11, v9
    s_nop 0
    v_permlane16_swap_b32 v8, v10
    v_permlane16_swap_b32 v9, v11
    v_pk_add_f32 v[8:9], v[8:9], v[10:11]
    v_mov_b32 v10, v8
    v_mov_b32 v11, v9
    s_nop 0
    v_permlane32_swap_b32 v8, v10
    v_permlane32_swap_b32 v9, v11
    v_pk_add_f32 v[8:9], v[8:9], v[10:11]
    s_lshl_b32 s36, s29, 14
    s_lshl_b32 s37, s30, 7
    s_add_u32 s36, s36, s37
    v_lshlrev_b32 v1, 3, v0
    s_mov_b64 exec, 0xffff
    buffer_store_dwordx2 v[8:9], v1, s[24:27], s36 offen sc1
    s_mov_b64 exec, -1
    s_lshl_b32 s53, s40, 2
    s_add_u32 s53, s53, s3
    s_mul_i32 s54, s53, 40960
    s_lshl_b32 s33, s53, 8
    s_add_u32 s56, s8, 0xe00000
    s_addc_u32 s57, s9, 0
    s_mov_b32 s58, 0x700000
    s_mov_b32 s59, 0x00020000
    s_mul_i32 s55, s53, 112
    s_lshr_b32 s60, s41, 1
    s_add_u32 s60, s60, s55
    s_add_u32 s60, s60, 48
    s_lshl_b32 s60, s60, 1
    s_and_b32 s61, s41, 1
    s_add_u32 s60, s60, s61
    s_lshl_b32 s60, s60, 9
    s_add_u32 s55, s55, s41
    s_lshl_b32 s55, s55, 10
    v_lshlrev_b32 v72, 4, v0
    v_lshrrev_b32 v74, 5, v0
    v_and_b32 v75, 31, v0
    v_lshlrev_b32 v75, 3, v75
    v_lshl_add_u32 v73, v74, 16, v75
    v_bfe_u32 v76, v0, 4, 1
    v_and_b32 v77, 15, v0
    v_mul_u32_u24 v2, 8320, v76
    v_lshl_add_u32 v2, v74, 7, v2
    v_lshl_add_u32 v2, v77, 3, v2
    v_add_u32 v3, 56320, v2
    v_add_u32 v4, 112640, v2
    v_mul_u32_u24 v78, 57344, v76
    v_lshl_add_u32 v78, v74, 8, v78
    v_lshl_add_u32 v78, v77, 4, v78
    s_lshr_b32 s38, s3, 1
    s_and_b32 s30, s3, 1
    s_lshl_b32 s30, s30, 1
    s_lshl_b32 s31, s28, 2
    s_add_u32 s30, s30, s31
    s_mul_i32 s31, s30, 56
    s_add_u32 s31, s31, s38
    s_lshl_b32 s31, s31, 10
    s_add_u32 s30, s30, s38
    s_mul_i32 s32, s38, 57344
    v_mbcnt_lo_u32_b32 v5, -1, 0
    v_mbcnt_hi_u32_b32 v5, -1, v5
    v_lshlrev_b32 v5, 4, v5
    v_add_u32 v7, 57344, v5
    v_subrev_u32 v7, s32, v7
    v_add_u32 v5, s32, v5
    s_add_u32 s12, s8, 0xe00000
    s_addc_u32 s13, s9, 0
    s_mov_b32 s14, 0x700000
    s_mov_b32 s15, 0x00020000
    s_waitcnt vmcnt(0)
    s_barrier
    v_mov_b32 v0, v75
    v_mov_b32 v1, v78
    v_mov_b32 v10, 0
    v_mov_b32 v11, 0
    s_barrier
    s_add_u32 s37, s54, 0
    buffer_load_dwordx4 v[96:99], v72, s[20:23], s37 offen offset:0 sc1
    buffer_load_dwordx4 v[100:103], v72, s[20:23], s37 offen offset:1024 sc1
    buffer_load_dwordx4 v[104:107], v72, s[20:23], s37 offen offset:2048 sc1
    buffer_load_dwordx4 v[108:111], v72, s[20:23], s37 offen offset:3072 sc1
    s_add_u32 s37, s54, 4096
    buffer_load_dwordx4 v[112:115], v72, s[20:23], s37 offen offset:0 sc1
    buffer_load_dwordx4 v[116:119], v72, s[20:23], s37 offen offset:1024 sc1
    buffer_load_dwordx4 v[120:123], v72, s[20:23], s37 offen offset:2048 sc1
    buffer_load_dwordx4 v[124:127], v72, s[20:23], s37 offen offset:3072 sc1
    s_add_u32 s37, s54, 8192
    buffer_load_dwordx4 v[128:131], v72, s[20:23], s37 offen offset:0 sc1
    buffer_load_dwordx4 v[132:135], v72, s[20:23], s37 offen offset:1024 sc1
    buffer_load_dwordx4 v[136:139], v72, s[20:23], s37 offen offset:2048 sc1
    buffer_load_dwordx4 v[140:143], v72, s[20:23], s37 offen offset:3072 sc1
    ds_read_b64_tr_b16 v[12:13], v3 offset:48128
    ds_read_b64_tr_b16 v[14:15], v3 offset:48384
    ds_read_b64_tr_b16 v[16:17], v3 offset:48640
    ds_read_b64_tr_b16 v[18:19], v3 offset:48896
    ds_read_b64_tr_b16 v[20:21], v3 offset:49152
    ds_read_b64_tr_b16 v[22:23], v3 offset:49408
    ds_read_b64_tr_b16 v[24:25], v3 offset:49664
    ds_read_b64_tr_b16 v[26:27], v3 offset:49920
    ds_read_b64_tr_b16 v[28:29], v3 offset:50176
    ds_read_b64_tr_b16 v[30:31], v3 offset:50432
    s_waitcnt vmcnt(11) lgkmcnt(8)
    v_mfma_f32_32x32x16_bf16 v[32:47], v[12:15], v[96:99], 0
    ds_read_b64_tr_b16 v[12:13], v3 offset:50688
    ds_read_b64_tr_b16 v[14:15], v3 offset:50944
    s_add_u32 s37, s54, 12288
    buffer_load_dwordx4 v[144:147], v72, s[20:23], s37 offen offset:0 sc1
    s_waitcnt lgkmcnt(8)
    v_mfma_f32_32x32x16_bf16 v[48:63], v[16:19], v[96:99], 0
    ds_read_b64_tr_b16 v[16:17], v3 offset:51200
    ds_read_b64_tr_b16 v[18:19], v3 offset:51456
    buffer_load_dwordx4 v[148:151], v72, s[20:23], s37 offen offset:1024 sc1
    s_waitcnt vmcnt(12) lgkmcnt(8)
    v_mfma_f32_32x32x16_bf16 v[32:47], v[20:23], v[100:103], v[32:47]
    ds_read_b64_tr_b16 v[20:21], v3 offset:51712
    ds_read_b64_tr_b16 v[22:23], v3 offset:51968
    buffer_load_dwordx4 v[152:155], v72, s[20:23], s37 offen offset:2048 sc1
    s_waitcnt lgkmcnt(8)
    v_mfma_f32_32x32x16_bf16 v[48:63], v[24:27], v[100:103], v[48:63]
    ds_read_b64_tr_b16 v[24:25], v3 offset:52224
    ds_read_b64_tr_b16 v[26:27], v3 offset:52480
    buffer_load_dwordx4 v[156:159], v72, s[20:23], s37 offen offset:3072 sc1
    s_waitcnt vmcnt(13) lgkmcnt(8)
    v_mfma_f32_32x32x16_bf16 v[32:47], v[28:31], v[104:107], v[32:47]
    ds_read_b64_tr_b16 v[28:29], v3 offset:52736
    ds_read_b64_tr_b16 v[30:31], v3 offset:52992
    s_add_u32 s37, s54, 16384
    buffer_load_dwordx4 v[160:163], v72, s[20:23], s37 offen offset:0 sc1
    s_waitcnt lgkmcnt(8)
    v_mfma_f32_32x32x16_bf16 v[48:63], v[12:15], v[104:107], v[48:63]
    ds_read_b64_tr_b16 v[12:13], v3 offset:53248
    ds_read_b64_tr_b16 v[14:15], v3 offset:53504
    buffer_load_dwordx4 v[164:167], v72, s[20:23], s37 offen offset:1024 sc1
    s_waitcnt vmcnt(14) lgkmcnt(8)
    v_mfma_f32_32x32x16_bf16 v[32:47], v[16:19], v[108:111], v[32:47]
    ds_read_b64_tr_b16 v[16:17], v3 offset:53760
    ds_read_b64_tr_b16 v[18:19], v3 offset:54016
    buffer_load_dwordx4 v[168:171], v72, s[20:23], s37 offen offset:2048 sc1
    s_waitcnt lgkmcnt(8)
    v_mfma_f32_32x32x16_bf16 v[48:63], v[20:23], v[108:111], v[48:63]
    ds_read_b64_tr_b16 v[20:21], v3 offset:54272
    ds_read_b64_tr_b16 v[22:23], v3 offset:54528
    buffer_load_dwordx4 v[172:175], v72, s[20:23], s37 offen offset:3072 sc1
    s_waitcnt vmcnt(15) lgkmcnt(8)
    v_mfma_f32_32x32x16_bf16 v[32:47], v[24:27], v[112:115], v[32:47]
    ds_read_b64_tr_b16 v[24:25], v3 offset:54784
    ds_read_b64_tr_b16 v[26:27], v3 offset:55040
    s_add_u32 s37, s54, 20480
    buffer_load_dwordx4 v[176:179], v72, s[20:23], s37 offen offset:0 sc1
    buffer_load_dwordx2 v[64:65], v73, s[24:27], s33 offen sc1
    s_add_u32 s33, s33, 16384
    buffer_load_dwordx2 v[66:67], v73, s[24:27], s33 offen sc1
    s_add_u32 s33, s33, 16384
    buffer_load_dwordx2 v[68:69], v73, s[24:27], s33 offen sc1
    s_add_u32 s33, s33, 16384
    buffer_load_dwordx2 v[70:71], v73, s[24:27], s33 offen sc1
    s_waitcnt lgkmcnt(8)
    v_mfma_f32_32x32x16_bf16 v[48:63], v[28:31], v[112:115], v[48:63]
    ds_read_b64_tr_b16 v[28:29], v3 offset:55296
    ds_read_b64_tr_b16 v[30:31], v3 offset:55552
    buffer_load_dwordx4 v[180:183], v72, s[20:23], s37 offen offset:1024 sc1
    s_waitcnt vmcnt(20) lgkmcnt(8)
    v_mfma_f32_32x32x16_bf16 v[32:47], v[12:15], v[116:119], v[32:47]
    ds_read_b64_tr_b16 v[12:13], v3 offset:55808
    ds_read_b64_tr_b16 v[14:15], v3 offset:56064
    buffer_load_dwordx4 v[184:187], v72, s[20:23], s37 offen offset:2048 sc1
    s_waitcnt lgkmcnt(8)
    v_mfma_f32_32x32x16_bf16 v[48:63], v[16:19], v[116:119], v[48:63]
    ds_read_b64_tr_b16 v[16:17], v4 offset:8320
    ds_read_b64_tr_b16 v[18:19], v4 offset:8576
    buffer_load_dwordx4 v[188:191], v72, s[20:23], s37 offen offset:3072 sc1
    s_waitcnt vmcnt(21) lgkmcnt(8)
    v_mfma_f32_32x32x16_bf16 v[32:47], v[20:23], v[120:123], v[32:47]
    ds_read_b64_tr_b16 v[20:21], v4 offset:8832
    ds_read_b64_tr_b16 v[22:23], v4 offset:9088
    s_add_u32 s37, s54, 24576
    buffer_load_dwordx4 v[192:195], v72, s[20:23], s37 offen offset:0 sc1
    s_waitcnt lgkmcnt(8)
    v_mfma_f32_32x32x16_bf16 v[48:63], v[24:27], v[120:123], v[48:63]
    ds_read_b64_tr_b16 v[24:25], v4 offset:9344
    ds_read_b64_tr_b16 v[26:27], v4 offset:9600
    buffer_load_dwordx4 v[196:199], v72, s[20:23], s37 offen offset:1024 sc1
    s_waitcnt vmcnt(22) lgkmcnt(8)
    v_mfma_f32_32x32x16_bf16 v[32:47], v[28:31], v[124:127], v[32:47]
    ds_read_b64_tr_b16 v[28:29], v4 offset:9856
    ds_read_b64_tr_b16 v[30:31], v4 offset:10112
    buffer_load_dwordx4 v[200:203], v72, s[20:23], s37 offen offset:2048 sc1
    s_waitcnt lgkmcnt(8)
    v_mfma_f32_32x32x16_bf16 v[48:63], v[12:15], v[124:127], v[48:63]
    ds_read_b64_tr_b16 v[12:13], v4 offset:10368
    ds_read_b64_tr_b16 v[14:15], v4 offset:10624
    buffer_load_dwordx4 v[204:207], v72, s[20:23], s37 offen offset:3072 sc1
    s_barrier
    s_waitcnt vmcnt(23) lgkmcnt(8)
    v_mfma_f32_32x32x16_bf16 v[32:47], v[16:19], v[128:131], v[32:47]
    ds_read_b64_tr_b16 v[16:17], v4 offset:10880
    ds_read_b64_tr_b16 v[18:19], v4 offset:11136
    s_add_u32 s37, s54, 28672
    buffer_load_dwordx4 v[208:211], v72, s[20:23], s37 offen offset:0 sc1
    s_waitcnt lgkmcnt(8)
    v_mfma_f32_32x32x16_bf16 v[48:63], v[20:23], v[128:131], v[48:63]
    ds_read_b64_tr_b16 v[20:21], v4 offset:11392
    ds_read_b64_tr_b16 v[22:23], v4 offset:11648
    buffer_load_dwordx4 v[212:215], v72, s[20:23], s37 offen offset:1024 sc1
    s_waitcnt vmcnt(24) lgkmcnt(8)
    v_mfma_f32_32x32x16_bf16 v[32:47], v[24:27], v[132:135], v[32:47]
    ds_read_b64_tr_b16 v[24:25], v4 offset:11904
    ds_read_b64_tr_b16 v[26:27], v4 offset:12160
    buffer_load_dwordx4 v[216:219], v72, s[20:23], s37 offen offset:2048 sc1
    s_waitcnt lgkmcnt(8)
    v_mfma_f32_32x32x16_bf16 v[48:63], v[28:31], v[132:135], v[48:63]
    ds_read_b64_tr_b16 v[28:29], v4 offset:12416
    ds_read_b64_tr_b16 v[30:31], v4 offset:12672
    buffer_load_dwordx4 v[220:223], v72, s[20:23], s37 offen offset:3072 sc1
    s_waitcnt vmcnt(25) lgkmcnt(8)
    v_mfma_f32_32x32x16_bf16 v[32:47], v[12:15], v[136:139], v[32:47]
    ds_read_b64_tr_b16 v[12:13], v4 offset:12928
    ds_read_b64_tr_b16 v[14:15], v4 offset:13184
    s_add_u32 s37, s54, 32768
    buffer_load_dwordx4 v[224:227], v72, s[20:23], s37 offen offset:0 sc1
    s_waitcnt lgkmcnt(8)
    v_mfma_f32_32x32x16_bf16 v[48:63], v[16:19], v[136:139], v[48:63]
    ds_read_b64_tr_b16 v[16:17], v4 offset:13440
    ds_read_b64_tr_b16 v[18:19], v4 offset:13696
    buffer_load_dwordx4 v[228:231], v72, s[20:23], s37 offen offset:1024 sc1
    s_waitcnt vmcnt(26) lgkmcnt(8)
    v_mfma_f32_32x32x16_bf16 v[32:47], v[20:23], v[140:143], v[32:47]
    ds_read_b64_tr_b16 v[20:21], v4 offset:13952
    ds_read_b64_tr_b16 v[22:23], v4 offset:14208
    buffer_load_dwordx4 v[232:235], v72, s[20:23], s37 offen offset:2048 sc1
    s_waitcnt lgkmcnt(8)
    v_mfma_f32_32x32x16_bf16 v[48:63], v[24:27], v[140:143], v[48:63]
    ds_read_b64_tr_b16 v[24:25], v4 offset:14464
    ds_read_b64_tr_b16 v[26:27], v4 offset:14720
    buffer_load_dwordx4 v[236:239], v72, s[20:23], s37 offen offset:3072 sc1
    s_waitcnt vmcnt(27) lgkmcnt(8)
    v_mfma_f32_32x32x16_bf16 v[32:47], v[28:31], v[144:147], v[32:47]
    ds_read_b64_tr_b16 v[28:29], v4 offset:14976
    ds_read_b64_tr_b16 v[30:31], v4 offset:15232
    s_add_u32 s37, s54, 36864
    buffer_load_dwordx4 v[240:243], v72, s[20:23], s37 offen offset:0 sc1
    s_waitcnt lgkmcnt(8)
    v_mfma_f32_32x32x16_bf16 v[48:63], v[12:15], v[144:147], v[48:63]
    ds_read_b64_tr_b16 v[12:13], v4 offset:15488
    ds_read_b64_tr_b16 v[14:15], v4 offset:15744
    buffer_load_dwordx4 v[244:247], v72, s[20:23], s37 offen offset:1024 sc1
    s_waitcnt vmcnt(28) lgkmcnt(8)
    v_mfma_f32_32x32x16_bf16 v[32:47], v[16:19], v[148:151], v[32:47]
    ds_read_b64_tr_b16 v[16:17], v4 offset:16000
    ds_read_b64_tr_b16 v[18:19], v4 offset:16256
    buffer_load_dwordx4 v[248:251], v72, s[20:23], s37 offen offset:2048 sc1
    s_waitcnt lgkmcnt(8)
    v_mfma_f32_32x32x16_bf16 v[48:63], v[20:23], v[148:151], v[48:63]
    ds_read_b64_tr_b16 v[20:21], v4 offset:24832
    ds_read_b64_tr_b16 v[22:23], v4 offset:25088
    buffer_load_dwordx4 v[252:255], v72, s[20:23], s37 offen offset:3072 sc1
    s_waitcnt vmcnt(29) lgkmcnt(8)
    v_mfma_f32_32x32x16_bf16 v[32:47], v[24:27], v[152:155], v[32:47]
    ds_read_b64_tr_b16 v[24:25], v4 offset:25344
    ds_read_b64_tr_b16 v[26:27], v4 offset:25600
    s_waitcnt lgkmcnt(8)
    v_mfma_f32_32x32x16_bf16 v[48:63], v[28:31], v[152:155], v[48:63]
    ds_read_b64_tr_b16 v[28:29], v4 offset:25856
    ds_read_b64_tr_b16 v[30:31], v4 offset:26112
    s_waitcnt vmcnt(28) lgkmcnt(8)
    v_mfma_f32_32x32x16_bf16 v[32:47], v[12:15], v[156:159], v[32:47]
    ds_read_b64_tr_b16 v[12:13], v4 offset:26368
    ds_read_b64_tr_b16 v[14:15], v4 offset:26624
    s_waitcnt lgkmcnt(8)
    v_mfma_f32_32x32x16_bf16 v[48:63], v[16:19], v[156:159], v[48:63]
    ds_read_b64_tr_b16 v[16:17], v4 offset:26880
    ds_read_b64_tr_b16 v[18:19], v4 offset:27136
    s_barrier
    s_waitcnt vmcnt(27) lgkmcnt(8)
    v_mfma_f32_32x32x16_bf16 v[32:47], v[20:23], v[160:163], v[32:47]
    ds_read_b64_tr_b16 v[20:21], v4 offset:27392
    ds_read_b64_tr_b16 v[22:23], v4 offset:27648
    s_waitcnt lgkmcnt(8)
    v_mfma_f32_32x32x16_bf16 v[48:63], v[24:27], v[160:163], v[48:63]
    ds_read_b64_tr_b16 v[24:25], v4 offset:27904
    ds_read_b64_tr_b16 v[26:27], v4 offset:28160
    s_waitcnt vmcnt(26) lgkmcnt(8)
    v_mfma_f32_32x32x16_bf16 v[32:47], v[28:31], v[164:167], v[32:47]
    ds_read_b64_tr_b16 v[28:29], v4 offset:28416
    ds_read_b64_tr_b16 v[30:31], v4 offset:28672
    s_waitcnt lgkmcnt(8)
    v_mfma_f32_32x32x16_bf16 v[48:63], v[12:15], v[164:167], v[48:63]
    ds_read_b64_tr_b16 v[12:13], v4 offset:28928
    ds_read_b64_tr_b16 v[14:15], v4 offset:29184
    s_waitcnt vmcnt(25) lgkmcnt(8)
    v_mfma_f32_32x32x16_bf16 v[32:47], v[16:19], v[168:171], v[32:47]
    ds_read_b64_tr_b16 v[16:17], v4 offset:29440
    ds_read_b64_tr_b16 v[18:19], v4 offset:29696
    s_waitcnt lgkmcnt(8)
    v_mfma_f32_32x32x16_bf16 v[48:63], v[20:23], v[168:171], v[48:63]
    ds_read_b64_tr_b16 v[20:21], v4 offset:29952
    ds_read_b64_tr_b16 v[22:23], v4 offset:30208
    s_waitcnt vmcnt(24) lgkmcnt(8)
    v_mfma_f32_32x32x16_bf16 v[32:47], v[24:27], v[172:175], v[32:47]
    ds_read_b64_tr_b16 v[24:25], v4 offset:30464
    ds_read_b64_tr_b16 v[26:27], v4 offset:30720
    s_waitcnt lgkmcnt(8)
    v_mfma_f32_32x32x16_bf16 v[48:63], v[28:31], v[172:175], v[48:63]
    ds_read_b64_tr_b16 v[28:29], v4 offset:30976
    ds_read_b64_tr_b16 v[30:31], v4 offset:31232
    s_waitcnt vmcnt(23) lgkmcnt(8)
    v_mfma_f32_32x32x16_bf16 v[32:47], v[12:15], v[176:179], v[32:47]
    ds_read_b64_tr_b16 v[12:13], v4 offset:31488
    ds_read_b64_tr_b16 v[14:15], v4 offset:31744
    s_waitcnt lgkmcnt(8)
    v_mfma_f32_32x32x16_bf16 v[48:63], v[16:19], v[176:179], v[48:63]
    ds_read_b64_tr_b16 v[16:17], v4 offset:32000
    ds_read_b64_tr_b16 v[18:19], v4 offset:32256
    s_waitcnt vmcnt(18) lgkmcnt(8)
    v_mfma_f32_32x32x16_bf16 v[32:47], v[20:23], v[180:183], v[32:47]
    ds_read_b64_tr_b16 v[20:21], v4 offset:32512
    ds_read_b64_tr_b16 v[22:23], v4 offset:32768
    s_waitcnt lgkmcnt(8)
    v_mfma_f32_32x32x16_bf16 v[48:63], v[24:27], v[180:183], v[48:63]
    ds_read_b64_tr_b16 v[24:25], v2 offset:2048
    ds_read_b64_tr_b16 v[26:27], v2 offset:2304
    s_waitcnt vmcnt(17) lgkmcnt(8)
    v_mfma_f32_32x32x16_bf16 v[32:47], v[28:31], v[184:187], v[32:47]
    ds_read_b64_tr_b16 v[28:29], v2 offset:2560
    ds_read_b64_tr_b16 v[30:31], v2 offset:2816
    s_waitcnt lgkmcnt(8)
    v_mfma_f32_32x32x16_bf16 v[48:63], v[12:15], v[184:187], v[48:63]
    ds_read_b64_tr_b16 v[12:13], v2 offset:3072
    ds_read_b64_tr_b16 v[14:15], v2 offset:3328
    s_waitcnt vmcnt(16) lgkmcnt(8)
    v_mfma_f32_32x32x16_bf16 v[32:47], v[16:19], v[188:191], v[32:47]
    ds_read_b64_tr_b16 v[16:17], v2 offset:3584
    ds_read_b64_tr_b16 v[18:19], v2 offset:3840
    s_waitcnt lgkmcnt(8)
    v_mfma_f32_32x32x16_bf16 v[48:63], v[20:23], v[188:191], v[48:63]
    ds_read_b64_tr_b16 v[20:21], v2 offset:4096
    ds_read_b64_tr_b16 v[22:23], v2 offset:4352
    s_barrier
    s_waitcnt vmcnt(15) lgkmcnt(8)
    v_mfma_f32_32x32x16_bf16 v[32:47], v[24:27], v[192:195], v[32:47]
    ds_read_b64_tr_b16 v[24:25], v2 offset:4608
    ds_read_b64_tr_b16 v[26:27], v2 offset:4864
    s_waitcnt lgkmcnt(8)
    v_mfma_f32_32x32x16_bf16 v[48:63], v[28:31], v[192:195], v[48:63]
    ds_read_b64_tr_b16 v[28:29], v2 offset:5120
    ds_read_b64_tr_b16 v[30:31], v2 offset:5376
    s_waitcnt vmcnt(14) lgkmcnt(8)
    v_mfma_f32_32x32x16_bf16 v[32:47], v[12:15], v[196:199], v[32:47]
    ds_read_b64_tr_b16 v[12:13], v2 offset:5632
    ds_read_b64_tr_b16 v[14:15], v2 offset:5888
    s_waitcnt lgkmcnt(8)
    v_mfma_f32_32x32x16_bf16 v[48:63], v[16:19], v[196:199], v[48:63]
    ds_read_b64_tr_b16 v[16:17], v2 offset:6144
    ds_read_b64_tr_b16 v[18:19], v2 offset:6400
    s_waitcnt vmcnt(13) lgkmcnt(8)
    v_mfma_f32_32x32x16_bf16 v[32:47], v[20:23], v[200:203], v[32:47]
    ds_read_b64_tr_b16 v[20:21], v2 offset:6656
    ds_read_b64_tr_b16 v[22:23], v2 offset:6912
    s_waitcnt lgkmcnt(8)
    v_mfma_f32_32x32x16_bf16 v[48:63], v[24:27], v[200:203], v[48:63]
    ds_read_b64_tr_b16 v[24:25], v2 offset:7168
    ds_read_b64_tr_b16 v[26:27], v2 offset:7424
    s_waitcnt vmcnt(12) lgkmcnt(8)
    v_mfma_f32_32x32x16_bf16 v[32:47], v[28:31], v[204:207], v[32:47]
    ds_read_b64_tr_b16 v[28:29], v2 offset:7680
    ds_read_b64_tr_b16 v[30:31], v2 offset:7936
    s_waitcnt lgkmcnt(8)
    v_mfma_f32_32x32x16_bf16 v[48:63], v[12:15], v[204:207], v[48:63]
    ds_read_b64_tr_b16 v[12:13], v2 offset:8192
    ds_read_b64_tr_b16 v[14:15], v2 offset:8448
    s_waitcnt vmcnt(11) lgkmcnt(8)
    v_mfma_f32_32x32x16_bf16 v[32:47], v[16:19], v[208:211], v[32:47]
    ds_read_b64_tr_b16 v[16:17], v2 offset:8704
    ds_read_b64_tr_b16 v[18:19], v2 offset:8960
    s_waitcnt lgkmcnt(8)
    v_mfma_f32_32x32x16_bf16 v[48:63], v[20:23], v[208:211], v[48:63]
    ds_read_b64_tr_b16 v[20:21], v2 offset:9216
    ds_read_b64_tr_b16 v[22:23], v2 offset:9472
    s_waitcnt vmcnt(10) lgkmcnt(8)
    v_mfma_f32_32x32x16_bf16 v[32:47], v[24:27], v[212:215], v[32:47]
    ds_read_b64_tr_b16 v[24:25], v2 offset:9728
    ds_read_b64_tr_b16 v[26:27], v2 offset:9984
    s_waitcnt lgkmcnt(8)
    v_mfma_f32_32x32x16_bf16 v[48:63], v[28:31], v[212:215], v[48:63]
    ds_read_b64_tr_b16 v[28:29], v2 offset:18560
    ds_read_b64_tr_b16 v[30:31], v2 offset:18816
    s_waitcnt vmcnt(9) lgkmcnt(8)
    v_mfma_f32_32x32x16_bf16 v[32:47], v[12:15], v[216:219], v[32:47]
    ds_read_b64_tr_b16 v[12:13], v2 offset:19072
    ds_read_b64_tr_b16 v[14:15], v2 offset:19328
    s_waitcnt vmcnt(19)
    v_add_f32 v64, v64, v66
    v_add_f32 v65, v65, v67
    s_waitcnt lgkmcnt(8)
    v_mfma_f32_32x32x16_bf16 v[48:63], v[16:19], v[216:219], v[48:63]
    ds_read_b64_tr_b16 v[16:17], v2 offset:19584
    ds_read_b64_tr_b16 v[18:19], v2 offset:19840
    v_add_f32 v64, v64, v68
    v_add_f32 v65, v65, v69
    s_waitcnt vmcnt(8) lgkmcnt(8)
    v_mfma_f32_32x32x16_bf16 v[32:47], v[20:23], v[220:223], v[32:47]
    ds_read_b64_tr_b16 v[20:21], v2 offset:20096
    ds_read_b64_tr_b16 v[22:23], v2 offset:20352
    v_add_f32 v64, v64, v70
    v_add_f32 v65, v65, v71
    s_waitcnt lgkmcnt(8)
    v_mfma_f32_32x32x16_bf16 v[48:63], v[24:27], v[220:223], v[48:63]
    ds_read_b64_tr_b16 v[24:25], v2 offset:20608
    ds_read_b64_tr_b16 v[26:27], v2 offset:20864
    v_mov_b32 v66, v64
    s_nop 1
    v_permlane32_swap_b32 v64, v66
    s_barrier
    s_waitcnt vmcnt(7) lgkmcnt(8)
    v_mfma_f32_32x32x16_bf16 v[32:47], v[28:31], v[224:227], v[32:47]
    ds_read_b64_tr_b16 v[28:29], v2 offset:21120
    ds_read_b64_tr_b16 v[30:31], v2 offset:21376
    v_add_f32 v64, v64, v66
    v_mov_b32 v67, v65
    s_waitcnt lgkmcnt(8)
    v_mfma_f32_32x32x16_bf16 v[48:63], v[12:15], v[224:227], v[48:63]
    ds_read_b64_tr_b16 v[12:13], v2 offset:21632
    ds_read_b64_tr_b16 v[14:15], v2 offset:21888
    v_permlane32_swap_b32 v65, v67
    v_add_f32 v65, v65, v67
    s_waitcnt vmcnt(6) lgkmcnt(8)
    v_mfma_f32_32x32x16_bf16 v[32:47], v[16:19], v[228:231], v[32:47]
    ds_read_b64_tr_b16 v[16:17], v2 offset:22144
    ds_read_b64_tr_b16 v[18:19], v2 offset:22400
    v_mul_f32 v64, 0x3acccccd, v64
    v_mul_f32 v65, 0x3acccccd, v65
    s_waitcnt lgkmcnt(8)
    v_mfma_f32_32x32x16_bf16 v[48:63], v[20:23], v[228:231], v[48:63]
    ds_read_b64_tr_b16 v[20:21], v2 offset:22656
    ds_read_b64_tr_b16 v[22:23], v2 offset:22912
    v_fma_f32 v65, -v64, v64, v65
    v_max_f32 v65, 0, v65
    s_waitcnt vmcnt(5) lgkmcnt(8)
    v_mfma_f32_32x32x16_bf16 v[32:47], v[24:27], v[232:235], v[32:47]
    ds_read_b64_tr_b16 v[24:25], v2 offset:23168
    ds_read_b64_tr_b16 v[26:27], v2 offset:23424
    v_cvt_pk_bf16_f32 v65, v65, v65
    v_and_b32 v65, 0xffff0000, v65
    s_waitcnt lgkmcnt(8)
    v_mfma_f32_32x32x16_bf16 v[48:63], v[28:31], v[232:235], v[48:63]
    ds_read_b64_tr_b16 v[28:29], v2 offset:23680
    ds_read_b64_tr_b16 v[30:31], v2 offset:23936
    v_add_f32 v65, 0x3727c5ac, v65
    v_cvt_pk_bf16_f32 v65, v65, v65
    s_waitcnt vmcnt(4) lgkmcnt(8)
    v_mfma_f32_32x32x16_bf16 v[32:47], v[12:15], v[236:239], v[32:47]
    ds_read_b64_tr_b16 v[12:13], v2 offset:24192
    ds_read_b64_tr_b16 v[14:15], v2 offset:24448
    v_and_b32 v65, 0xffff0000, v65
    v_sqrt_f32 v65, v65
    s_waitcnt lgkmcnt(8)
    v_mfma_f32_32x32x16_bf16 v[48:63], v[16:19], v[236:239], v[48:63]
    ds_read_b64_tr_b16 v[16:17], v2 offset:24704
    ds_read_b64_tr_b16 v[18:19], v2 offset:24960
    v_cvt_pk_bf16_f32 v65, v65, v65
    v_and_b32 v65, 0xffff0000, v65
    s_waitcnt vmcnt(3) lgkmcnt(8)
    v_mfma_f32_32x32x16_bf16 v[32:47], v[20:23], v[240:243], v[32:47]
    ds_read_b64_tr_b16 v[20:21], v2 offset:25216
    ds_read_b64_tr_b16 v[22:23], v2 offset:25472
    v_rcp_f32 v65, v65
    v_cvt_pk_bf16_f32 v64, v64, v64
    s_waitcnt lgkmcnt(8)
    v_mfma_f32_32x32x16_bf16 v[48:63], v[24:27], v[240:243], v[48:63]
    ds_read_b64_tr_b16 v[24:25], v2 offset:25728
    ds_read_b64_tr_b16 v[26:27], v2 offset:25984
    v_and_b32 v64, 0xffff0000, v64
    v_sub_f32 v64, 0, v64
    s_waitcnt vmcnt(2) lgkmcnt(8)
    v_mfma_f32_32x32x16_bf16 v[32:47], v[28:31], v[244:247], v[32:47]
    ds_read_b64_tr_b16 v[28:29], v2 offset:26240
    ds_read_b64_tr_b16 v[30:31], v2 offset:26496
    v_mul_f32 v6, v65, v65
    v_lshrrev_b32 v9, 16, v64
    s_waitcnt lgkmcnt(8)
    v_mfma_f32_32x32x16_bf16 v[48:63], v[12:15], v[244:247], v[48:63]
    ds_read_b64 v[12:13], v0 offset:0
    v_or_b32 v8, v64, v9
    s_mov_b64 vcc, 0xffffffff
    v_cndmask_b32 v8, 0, v8, vcc
    s_waitcnt vmcnt(1) lgkmcnt(7)
    v_mfma_f32_32x32x16_bf16 v[32:47], v[16:19], v[248:251], v[32:47]
    ds_read_b64 v[16:17], v0 offset:256
    v_cndmask_b32 v9, 0, v9, vcc
    s_waitcnt lgkmcnt(6)
    v_mfma_f32_32x32x16_bf16 v[48:63], v[20:23], v[248:251], v[48:63]
    ds_read_b64_tr_b16 v[20:21], v2 offset:35072
    ds_read_b64_tr_b16 v[22:23], v2 offset:35328
    s_waitcnt vmcnt(0) lgkmcnt(6)
    v_mfma_f32_32x32x16_bf16 v[32:47], v[24:27], v[252:255], v[32:47]
    ds_read_b64_tr_b16 v[24:25], v2 offset:35584
    ds_read_b64_tr_b16 v[26:27], v2 offset:35840
    s_waitcnt lgkmcnt(6)
    v_mfma_f32_32x32x16_bf16 v[48:63], v[28:31], v[252:255], v[48:63]
    ds_read_b64_tr_b16 v[28:29], v2 offset:36096
    ds_read_b64_tr_b16 v[30:31], v2 offset:36352
    s_waitcnt lgkmcnt(7)
    v_mfma_f32_32x32x16_bf16 v[32:47], v[12:15], v[8:11], v[32:47]
    ds_read_b64_tr_b16 v[12:13], v2 offset:36608
    ds_read_b64_tr_b16 v[14:15], v2 offset:36864
    s_waitcnt lgkmcnt(8)
    v_mfma_f32_32x32x16_bf16 v[48:63], v[16:19], v[8:11], v[48:63]
    ds_read_b64_tr_b16 v[16:17], v2 offset:37120
    ds_read_b64_tr_b16 v[18:19], v2 offset:37376
    s_barrier
    s_waitcnt lgkmcnt(8)
    v_mfma_f32_32x32x16_bf16 v[64:79], v[20:23], v[96:99], 0
    ds_read_b64_tr_b16 v[20:21], v2 offset:37632
    ds_read_b64_tr_b16 v[22:23], v2 offset:37888
    s_waitcnt lgkmcnt(8)
    v_mfma_f32_32x32x16_bf16 v[80:95], v[24:27], v[96:99], 0
    ds_read_b64_tr_b16 v[24:25], v2 offset:38144
    ds_read_b64_tr_b16 v[26:27], v2 offset:38400
    s_waitcnt lgkmcnt(8)
    v_mfma_f32_32x32x16_bf16 v[64:79], v[28:31], v[100:103], v[64:79]
    ds_read_b64_tr_b16 v[28:29], v2 offset:38656
    ds_read_b64_tr_b16 v[30:31], v2 offset:38912
    v_max_f32 v32, 0, v32
    v_max_f32 v33, 0, v33
    s_waitcnt lgkmcnt(8)
    v_mfma_f32_32x32x16_bf16 v[80:95], v[12:15], v[100:103], v[80:95]
    ds_read_b64_tr_b16 v[12:13], v2 offset:39168
    ds_read_b64_tr_b16 v[14:15], v2 offset:39424
    v_max_f32 v34, 0, v34
    v_max_f32 v35, 0, v35
    s_waitcnt lgkmcnt(8)
    v_mfma_f32_32x32x16_bf16 v[64:79], v[16:19], v[104:107], v[64:79]
    ds_read_b64_tr_b16 v[16:17], v2 offset:39680
    ds_read_b64_tr_b16 v[18:19], v2 offset:39936
    v_max_f32 v36, 0, v36
    v_max_f32 v37, 0, v37
    s_waitcnt lgkmcnt(8)
    v_mfma_f32_32x32x16_bf16 v[80:95], v[20:23], v[104:107], v[80:95]
    ds_read_b64_tr_b16 v[20:21], v2 offset:40192
    ds_read_b64_tr_b16 v[22:23], v2 offset:40448
    v_max_f32 v38, 0, v38
    v_max_f32 v39, 0, v39
    s_waitcnt lgkmcnt(8)
    v_mfma_f32_32x32x16_bf16 v[64:79], v[24:27], v[108:111], v[64:79]
    ds_read_b64_tr_b16 v[24:25], v2 offset:40704
    ds_read_b64_tr_b16 v[26:27], v2 offset:40960
    v_mul_f32 v40, v6, v40
    v_mul_f32 v41, v6, v41
    s_waitcnt lgkmcnt(8)
    v_mfma_f32_32x32x16_bf16 v[80:95], v[28:31], v[108:111], v[80:95]
    ds_read_b64_tr_b16 v[28:29], v2 offset:41216
    ds_read_b64_tr_b16 v[30:31], v2 offset:41472
    v_mul_f32 v42, v6, v42
    v_mul_f32 v43, v6, v43
    s_waitcnt lgkmcnt(8)
    v_mfma_f32_32x32x16_bf16 v[64:79], v[12:15], v[112:115], v[64:79]
    ds_read_b64_tr_b16 v[12:13], v2 offset:41728
    ds_read_b64_tr_b16 v[14:15], v2 offset:41984
    v_mul_f32 v44, v6, v44
    v_mul_f32 v45, v6, v45
    s_waitcnt lgkmcnt(8)
    v_mfma_f32_32x32x16_bf16 v[80:95], v[16:19], v[112:115], v[80:95]
    ds_read_b64_tr_b16 v[16:17], v2 offset:42240
    ds_read_b64_tr_b16 v[18:19], v2 offset:42496
    v_mul_f32 v46, v6, v46
    v_mul_f32 v47, v6, v47
    s_waitcnt lgkmcnt(8)
    v_mfma_f32_32x32x16_bf16 v[64:79], v[20:23], v[116:119], v[64:79]
    ds_read_b64_tr_b16 v[20:21], v2 offset:42752
    ds_read_b64_tr_b16 v[22:23], v2 offset:43008
    v_mul_f32 v32, v32, v40
    v_mul_f32 v33, v33, v41
    s_waitcnt lgkmcnt(8)
    v_mfma_f32_32x32x16_bf16 v[80:95], v[24:27], v[116:119], v[80:95]
    ds_read_b64_tr_b16 v[24:25], v2 offset:51584
    ds_read_b64_tr_b16 v[26:27], v2 offset:51840
    v_mul_f32 v34, v34, v42
    v_mul_f32 v35, v35, v43
    s_waitcnt lgkmcnt(8)
    v_mfma_f32_32x32x16_bf16 v[64:79], v[28:31], v[120:123], v[64:79]
    ds_read_b64_tr_b16 v[28:29], v2 offset:52096
    ds_read_b64_tr_b16 v[30:31], v2 offset:52352
    v_mul_f32 v36, v36, v44
    v_mul_f32 v37, v37, v45
    s_waitcnt lgkmcnt(8)
    v_mfma_f32_32x32x16_bf16 v[80:95], v[12:15], v[120:123], v[80:95]
    ds_read_b64_tr_b16 v[12:13], v2 offset:52608
    ds_read_b64_tr_b16 v[14:15], v2 offset:52864
    v_mul_f32 v38, v38, v46
    v_mul_f32 v39, v39, v47
    s_waitcnt lgkmcnt(8)
    v_mfma_f32_32x32x16_bf16 v[64:79], v[16:19], v[124:127], v[64:79]
    ds_read_b64_tr_b16 v[16:17], v2 offset:53120
    ds_read_b64_tr_b16 v[18:19], v2 offset:53376
    v_cvt_pk_bf16_f32 v40, v32, v33
    v_cvt_pk_bf16_f32 v41, v34, v35
    s_waitcnt lgkmcnt(8)
    v_mfma_f32_32x32x16_bf16 v[80:95], v[20:23], v[124:127], v[80:95]
    ds_read_b64_tr_b16 v[20:21], v2 offset:53632
    ds_read_b64_tr_b16 v[22:23], v2 offset:53888
    v_cvt_pk_bf16_f32 v42, v36, v37
    v_cvt_pk_bf16_f32 v43, v38, v39
    s_barrier
    s_waitcnt lgkmcnt(8)
    v_mfma_f32_32x32x16_bf16 v[64:79], v[24:27], v[128:131], v[64:79]
    ds_read_b64_tr_b16 v[24:25], v2 offset:54144
    ds_read_b64_tr_b16 v[26:27], v2 offset:54400
    s_add_u32 s61, s55, 0
    buffer_store_dwordx4 v[40:43], v1, s[56:59], s61 offen offset:0 sc1
    v_max_f32 v48, 0, v48
    s_waitcnt lgkmcnt(8)
    v_mfma_f32_32x32x16_bf16 v[80:95], v[28:31], v[128:131], v[80:95]
    ds_read_b64_tr_b16 v[28:29], v2 offset:54656
    ds_read_b64_tr_b16 v[30:31], v2 offset:54912
    v_max_f32 v49, 0, v49
    v_max_f32 v50, 0, v50
    s_waitcnt lgkmcnt(8)
    v_mfma_f32_32x32x16_bf16 v[64:79], v[12:15], v[132:135], v[64:79]
    ds_read_b64_tr_b16 v[12:13], v2 offset:55168
    ds_read_b64_tr_b16 v[14:15], v2 offset:55424
    v_max_f32 v51, 0, v51
    v_max_f32 v52, 0, v52
    s_waitcnt lgkmcnt(8)
    v_mfma_f32_32x32x16_bf16 v[80:95], v[16:19], v[132:135], v[80:95]
    ds_read_b64_tr_b16 v[16:17], v2 offset:55680
    ds_read_b64_tr_b16 v[18:19], v2 offset:55936
    v_max_f32 v53, 0, v53
    v_max_f32 v54, 0, v54
    s_waitcnt lgkmcnt(8)
    v_mfma_f32_32x32x16_bf16 v[64:79], v[20:23], v[136:139], v[64:79]
    ds_read_b64_tr_b16 v[20:21], v2 offset:56192
    ds_read_b64_tr_b16 v[22:23], v3 offset:128
    v_max_f32 v55, 0, v55
    v_mul_f32 v56, v6, v56
    s_waitcnt lgkmcnt(8)
    v_mfma_f32_32x32x16_bf16 v[80:95], v[24:27], v[136:139], v[80:95]
    ds_read_b64_tr_b16 v[24:25], v3 offset:384
    ds_read_b64_tr_b16 v[26:27], v3 offset:640
    v_mul_f32 v57, v6, v57
    v_mul_f32 v58, v6, v58
    s_waitcnt lgkmcnt(8)
    v_mfma_f32_32x32x16_bf16 v[64:79], v[28:31], v[140:143], v[64:79]
    ds_read_b64_tr_b16 v[28:29], v3 offset:896
    ds_read_b64_tr_b16 v[30:31], v3 offset:1152
    v_mul_f32 v59, v6, v59
    v_mul_f32 v60, v6, v60
    s_waitcnt lgkmcnt(8)
    v_mfma_f32_32x32x16_bf16 v[80:95], v[12:15], v[140:143], v[80:95]
    ds_read_b64_tr_b16 v[12:13], v3 offset:1408
    ds_read_b64_tr_b16 v[14:15], v3 offset:1664
    v_mul_f32 v61, v6, v61
    v_mul_f32 v62, v6, v62
    s_waitcnt lgkmcnt(8)
    v_mfma_f32_32x32x16_bf16 v[64:79], v[16:19], v[144:147], v[64:79]
    ds_read_b64_tr_b16 v[16:17], v3 offset:1920
    ds_read_b64_tr_b16 v[18:19], v3 offset:2176
    v_mul_f32 v63, v6, v63
    v_mul_f32 v48, v48, v56
    s_waitcnt lgkmcnt(8)
    v_mfma_f32_32x32x16_bf16 v[80:95], v[20:23], v[144:147], v[80:95]
    ds_read_b64_tr_b16 v[20:21], v3 offset:2432
    ds_read_b64_tr_b16 v[22:23], v3 offset:2688
    v_mul_f32 v49, v49, v57
    v_mul_f32 v50, v50, v58
    s_waitcnt lgkmcnt(8)
    v_mfma_f32_32x32x16_bf16 v[64:79], v[24:27], v[148:151], v[64:79]
    ds_read_b64_tr_b16 v[24:25], v3 offset:2944
    ds_read_b64_tr_b16 v[26:27], v3 offset:3200
    v_mul_f32 v51, v51, v59
    v_mul_f32 v52, v52, v60
    s_waitcnt lgkmcnt(8)
    v_mfma_f32_32x32x16_bf16 v[80:95], v[28:31], v[148:151], v[80:95]
    ds_read_b64_tr_b16 v[28:29], v3 offset:11776
    ds_read_b64_tr_b16 v[30:31], v3 offset:12032
    v_mul_f32 v53, v53, v61
    v_mul_f32 v54, v54, v62
    s_waitcnt lgkmcnt(8)
    v_mfma_f32_32x32x16_bf16 v[64:79], v[12:15], v[152:155], v[64:79]
    ds_read_b64_tr_b16 v[12:13], v3 offset:12288
    ds_read_b64_tr_b16 v[14:15], v3 offset:12544
    v_mul_f32 v55, v55, v63
    v_cvt_pk_bf16_f32 v56, v48, v49
    s_waitcnt lgkmcnt(8)
    v_mfma_f32_32x32x16_bf16 v[80:95], v[16:19], v[152:155], v[80:95]
    ds_read_b64_tr_b16 v[16:17], v3 offset:12800
    ds_read_b64_tr_b16 v[18:19], v3 offset:13056
    v_cvt_pk_bf16_f32 v57, v50, v51
    v_cvt_pk_bf16_f32 v58, v52, v53
    s_waitcnt lgkmcnt(8)
    v_mfma_f32_32x32x16_bf16 v[64:79], v[20:23], v[156:159], v[64:79]
    ds_read_b64_tr_b16 v[20:21], v3 offset:13312
    ds_read_b64_tr_b16 v[22:23], v3 offset:13568
    v_cvt_pk_bf16_f32 v59, v54, v55
    buffer_store_dwordx4 v[56:59], v1, s[56:59], s61 offen offset:512 sc1
    s_waitcnt lgkmcnt(8)
    v_mfma_f32_32x32x16_bf16 v[80:95], v[24:27], v[156:159], v[80:95]
    ds_read_b64_tr_b16 v[24:25], v3 offset:13824
    ds_read_b64_tr_b16 v[26:27], v3 offset:14080
    s_barrier
    s_waitcnt lgkmcnt(8)
    v_mfma_f32_32x32x16_bf16 v[64:79], v[28:31], v[160:163], v[64:79]
    ds_read_b64_tr_b16 v[28:29], v3 offset:14336
    ds_read_b64_tr_b16 v[30:31], v3 offset:14592
    s_waitcnt lgkmcnt(8)
    v_mfma_f32_32x32x16_bf16 v[80:95], v[12:15], v[160:163], v[80:95]
    ds_read_b64_tr_b16 v[12:13], v3 offset:14848
    ds_read_b64_tr_b16 v[14:15], v3 offset:15104
    s_waitcnt lgkmcnt(8)
    v_mfma_f32_32x32x16_bf16 v[64:79], v[16:19], v[164:167], v[64:79]
    ds_read_b64_tr_b16 v[16:17], v3 offset:15360
    ds_read_b64_tr_b16 v[18:19], v3 offset:15616
    s_waitcnt lgkmcnt(8)
    v_mfma_f32_32x32x16_bf16 v[80:95], v[20:23], v[164:167], v[80:95]
    ds_read_b64_tr_b16 v[20:21], v3 offset:15872
    ds_read_b64_tr_b16 v[22:23], v3 offset:16128
    s_waitcnt lgkmcnt(8)
    v_mfma_f32_32x32x16_bf16 v[64:79], v[24:27], v[168:171], v[64:79]
    ds_read_b64_tr_b16 v[24:25], v3 offset:16384
    ds_read_b64_tr_b16 v[26:27], v3 offset:16640
    s_waitcnt lgkmcnt(8)
    v_mfma_f32_32x32x16_bf16 v[80:95], v[28:31], v[168:171], v[80:95]
    ds_read_b64_tr_b16 v[28:29], v3 offset:16896
    ds_read_b64_tr_b16 v[30:31], v3 offset:17152
    s_waitcnt lgkmcnt(8)
    v_mfma_f32_32x32x16_bf16 v[64:79], v[12:15], v[172:175], v[64:79]
    ds_read_b64_tr_b16 v[12:13], v3 offset:17408
    ds_read_b64_tr_b16 v[14:15], v3 offset:17664
    s_waitcnt lgkmcnt(8)
    v_mfma_f32_32x32x16_bf16 v[80:95], v[16:19], v[172:175], v[80:95]
    ds_read_b64_tr_b16 v[16:17], v3 offset:17920
    ds_read_b64_tr_b16 v[18:19], v3 offset:18176
    s_waitcnt lgkmcnt(8)
    v_mfma_f32_32x32x16_bf16 v[64:79], v[20:23], v[176:179], v[64:79]
    ds_read_b64_tr_b16 v[20:21], v3 offset:18432
    ds_read_b64_tr_b16 v[22:23], v3 offset:18688
    s_waitcnt lgkmcnt(8)
    v_mfma_f32_32x32x16_bf16 v[80:95], v[24:27], v[176:179], v[80:95]
    ds_read_b64_tr_b16 v[24:25], v3 offset:18944
    ds_read_b64_tr_b16 v[26:27], v3 offset:19200
    s_waitcnt lgkmcnt(8)
    v_mfma_f32_32x32x16_bf16 v[64:79], v[28:31], v[180:183], v[64:79]
    ds_read_b64_tr_b16 v[28:29], v3 offset:19456
    ds_read_b64_tr_b16 v[30:31], v3 offset:19712
    s_waitcnt lgkmcnt(8)
    v_mfma_f32_32x32x16_bf16 v[80:95], v[12:15], v[180:183], v[80:95]
    ds_read_b64_tr_b16 v[12:13], v3 offset:28288
    ds_read_b64_tr_b16 v[14:15], v3 offset:28544
    s_waitcnt lgkmcnt(8)
    v_mfma_f32_32x32x16_bf16 v[64:79], v[16:19], v[184:187], v[64:79]
    ds_read_b64_tr_b16 v[16:17], v3 offset:28800
    ds_read_b64_tr_b16 v[18:19], v3 offset:29056
    s_waitcnt lgkmcnt(8)
    v_mfma_f32_32x32x16_bf16 v[80:95], v[20:23], v[184:187], v[80:95]
    ds_read_b64_tr_b16 v[20:21], v3 offset:29312
    ds_read_b64_tr_b16 v[22:23], v3 offset:29568
    s_waitcnt lgkmcnt(8)
    v_mfma_f32_32x32x16_bf16 v[64:79], v[24:27], v[188:191], v[64:79]
    ds_read_b64_tr_b16 v[24:25], v3 offset:29824
    ds_read_b64_tr_b16 v[26:27], v3 offset:30080
    s_waitcnt lgkmcnt(8)
    v_mfma_f32_32x32x16_bf16 v[80:95], v[28:31], v[188:191], v[80:95]
    ds_read_b64_tr_b16 v[28:29], v3 offset:30336
    ds_read_b64_tr_b16 v[30:31], v3 offset:30592
    s_waitcnt vmcnt(0)
    s_barrier
    s_waitcnt lgkmcnt(8)
    v_mfma_f32_32x32x16_bf16 v[64:79], v[12:15], v[192:195], v[64:79]
    ds_read_b64_tr_b16 v[12:13], v3 offset:30848
    ds_read_b64_tr_b16 v[14:15], v3 offset:31104
    s_waitcnt lgkmcnt(8)
    v_mfma_f32_32x32x16_bf16 v[80:95], v[16:19], v[192:195], v[80:95]
    ds_read_b64_tr_b16 v[16:17], v3 offset:31360
    ds_read_b64_tr_b16 v[18:19], v3 offset:31616
    s_waitcnt lgkmcnt(8)
    v_mfma_f32_32x32x16_bf16 v[64:79], v[20:23], v[196:199], v[64:79]
    ds_read_b64_tr_b16 v[20:21], v3 offset:31872
    ds_read_b64_tr_b16 v[22:23], v3 offset:32128
    s_waitcnt lgkmcnt(8)
    v_mfma_f32_32x32x16_bf16 v[80:95], v[24:27], v[196:199], v[80:95]
    ds_read_b64_tr_b16 v[24:25], v3 offset:32384
    ds_read_b64_tr_b16 v[26:27], v3 offset:32640
    s_waitcnt lgkmcnt(8)
    v_mfma_f32_32x32x16_bf16 v[64:79], v[28:31], v[200:203], v[64:79]
    ds_read_b64_tr_b16 v[28:29], v3 offset:32896
    ds_read_b64_tr_b16 v[30:31], v3 offset:33152
    s_waitcnt lgkmcnt(8)
    v_mfma_f32_32x32x16_bf16 v[80:95], v[12:15], v[200:203], v[80:95]
    ds_read_b64_tr_b16 v[12:13], v3 offset:33408
    ds_read_b64_tr_b16 v[14:15], v3 offset:33664
    s_waitcnt lgkmcnt(8)
    v_mfma_f32_32x32x16_bf16 v[64:79], v[16:19], v[204:207], v[64:79]
    ds_read_b64_tr_b16 v[16:17], v3 offset:33920
    ds_read_b64_tr_b16 v[18:19], v3 offset:34176
    s_waitcnt lgkmcnt(8)
    v_mfma_f32_32x32x16_bf16 v[80:95], v[20:23], v[204:207], v[80:95]
    ds_read_b64_tr_b16 v[20:21], v3 offset:34432
    ds_read_b64_tr_b16 v[22:23], v3 offset:34688
    s_waitcnt lgkmcnt(8)
    v_mfma_f32_32x32x16_bf16 v[64:79], v[24:27], v[208:211], v[64:79]
    ds_read_b64_tr_b16 v[24:25], v3 offset:34944
    ds_read_b64_tr_b16 v[26:27], v3 offset:35200
    s_waitcnt lgkmcnt(8)
    v_mfma_f32_32x32x16_bf16 v[80:95], v[28:31], v[208:211], v[80:95]
    ds_read_b64_tr_b16 v[28:29], v3 offset:35456
    ds_read_b64_tr_b16 v[30:31], v3 offset:35712
    s_waitcnt lgkmcnt(8)
    v_mfma_f32_32x32x16_bf16 v[64:79], v[12:15], v[212:215], v[64:79]
    ds_read_b64_tr_b16 v[12:13], v3 offset:35968
    ds_read_b64_tr_b16 v[14:15], v3 offset:36224
    s_waitcnt lgkmcnt(8)
    v_mfma_f32_32x32x16_bf16 v[80:95], v[16:19], v[212:215], v[80:95]
    ds_read_b64_tr_b16 v[16:17], v3 offset:44800
    ds_read_b64_tr_b16 v[18:19], v3 offset:45056
    s_waitcnt lgkmcnt(8)
    v_mfma_f32_32x32x16_bf16 v[64:79], v[20:23], v[216:219], v[64:79]
    ds_read_b64_tr_b16 v[20:21], v3 offset:45312
    ds_read_b64_tr_b16 v[22:23], v3 offset:45568
    s_waitcnt lgkmcnt(8)
    v_mfma_f32_32x32x16_bf16 v[80:95], v[24:27], v[216:219], v[80:95]
    ds_read_b64_tr_b16 v[24:25], v3 offset:45824
    ds_read_b64_tr_b16 v[26:27], v3 offset:46080
    s_waitcnt lgkmcnt(8)
    v_mfma_f32_32x32x16_bf16 v[64:79], v[28:31], v[220:223], v[64:79]
    ds_read_b64_tr_b16 v[28:29], v3 offset:46336
    ds_read_b64_tr_b16 v[30:31], v3 offset:46592
    s_waitcnt lgkmcnt(8)
    v_mfma_f32_32x32x16_bf16 v[80:95], v[12:15], v[220:223], v[80:95]
    ds_read_b64_tr_b16 v[12:13], v3 offset:46848
    ds_read_b64_tr_b16 v[14:15], v3 offset:47104
    s_barrier
    s_waitcnt lgkmcnt(8)
    v_mfma_f32_32x32x16_bf16 v[64:79], v[16:19], v[224:227], v[64:79]
    ds_read_b64_tr_b16 v[16:17], v3 offset:47360
    ds_read_b64_tr_b16 v[18:19], v3 offset:47616
    s_waitcnt lgkmcnt(8)
    v_mfma_f32_32x32x16_bf16 v[80:95], v[20:23], v[224:227], v[80:95]
    ds_read_b64_tr_b16 v[20:21], v3 offset:47872
    ds_read_b64_tr_b16 v[22:23], v3 offset:48128
    s_waitcnt lgkmcnt(8)
    v_mfma_f32_32x32x16_bf16 v[64:79], v[24:27], v[228:231], v[64:79]
    ds_read_b64_tr_b16 v[24:25], v3 offset:48384
    ds_read_b64_tr_b16 v[26:27], v3 offset:48640
    s_waitcnt lgkmcnt(8)
    v_mfma_f32_32x32x16_bf16 v[80:95], v[28:31], v[228:231], v[80:95]
    ds_read_b64_tr_b16 v[28:29], v3 offset:48896
    ds_read_b64_tr_b16 v[30:31], v3 offset:49152
    s_waitcnt lgkmcnt(8)
    v_mfma_f32_32x32x16_bf16 v[64:79], v[12:15], v[232:235], v[64:79]
    ds_read_b64_tr_b16 v[12:13], v3 offset:49408
    ds_read_b64_tr_b16 v[14:15], v3 offset:49664
    s_waitcnt lgkmcnt(8)
    v_mfma_f32_32x32x16_bf16 v[80:95], v[16:19], v[232:235], v[80:95]
    ds_read_b64_tr_b16 v[16:17], v3 offset:49920
    ds_read_b64_tr_b16 v[18:19], v3 offset:50176
    s_waitcnt lgkmcnt(8)
    v_mfma_f32_32x32x16_bf16 v[64:79], v[20:23], v[236:239], v[64:79]
    ds_read_b64_tr_b16 v[20:21], v3 offset:50432
    ds_read_b64_tr_b16 v[22:23], v3 offset:50688
    s_waitcnt lgkmcnt(8)
    v_mfma_f32_32x32x16_bf16 v[80:95], v[24:27], v[236:239], v[80:95]
    ds_read_b64_tr_b16 v[24:25], v3 offset:50944
    ds_read_b64_tr_b16 v[26:27], v3 offset:51200
    s_waitcnt lgkmcnt(8)
    v_mfma_f32_32x32x16_bf16 v[64:79], v[28:31], v[240:243], v[64:79]
    ds_read_b64_tr_b16 v[28:29], v3 offset:51456
    ds_read_b64_tr_b16 v[30:31], v3 offset:51712
    s_waitcnt lgkmcnt(8)
    v_mfma_f32_32x32x16_bf16 v[80:95], v[12:15], v[240:243], v[80:95]
    ds_read_b64_tr_b16 v[12:13], v3 offset:51968
    ds_read_b64_tr_b16 v[14:15], v3 offset:52224
    s_waitcnt lgkmcnt(8)
    v_mfma_f32_32x32x16_bf16 v[64:79], v[16:19], v[244:247], v[64:79]
    ds_read_b64_tr_b16 v[16:17], v3 offset:52480
    ds_read_b64_tr_b16 v[18:19], v3 offset:52736
    s_waitcnt lgkmcnt(8)
    v_mfma_f32_32x32x16_bf16 v[80:95], v[20:23], v[244:247], v[80:95]
    ds_read_b64 v[20:21], v0 offset:512
    s_waitcnt lgkmcnt(7)
    v_mfma_f32_32x32x16_bf16 v[64:79], v[24:27], v[248:251], v[64:79]
    ds_read_b64 v[24:25], v0 offset:768
    s_waitcnt lgkmcnt(6)
    v_mfma_f32_32x32x16_bf16 v[80:95], v[28:31], v[248:251], v[80:95]
    ds_read_b64_tr_b16 v[28:29], v4 offset:4992
    ds_read_b64_tr_b16 v[30:31], v4 offset:5248
    s_waitcnt lgkmcnt(6)
    v_mfma_f32_32x32x16_bf16 v[64:79], v[12:15], v[252:255], v[64:79]
    ds_read_b64_tr_b16 v[12:13], v4 offset:5504
    ds_read_b64_tr_b16 v[14:15], v4 offset:5760
    s_waitcnt lgkmcnt(6)
    v_mfma_f32_32x32x16_bf16 v[80:95], v[16:19], v[252:255], v[80:95]
    ds_read_b64_tr_b16 v[16:17], v4 offset:6016
    ds_read_b64_tr_b16 v[18:19], v4 offset:6272
    s_waitcnt lgkmcnt(7)
    v_mfma_f32_32x32x16_bf16 v[64:79], v[20:23], v[8:11], v[64:79]
    ds_read_b64_tr_b16 v[20:21], v4 offset:6528
    ds_read_b64_tr_b16 v[22:23], v4 offset:6784
    s_waitcnt lgkmcnt(8)
    v_mfma_f32_32x32x16_bf16 v[80:95], v[24:27], v[8:11], v[80:95]
    ds_read_b64_tr_b16 v[24:25], v4 offset:7040
    ds_read_b64_tr_b16 v[26:27], v4 offset:7296
    s_barrier
    s_waitcnt lgkmcnt(8)
    v_mfma_f32_32x32x16_bf16 v[32:47], v[28:31], v[96:99], 0
    ds_read_b64_tr_b16 v[28:29], v4 offset:7552
    ds_read_b64_tr_b16 v[30:31], v4 offset:7808
    s_waitcnt lgkmcnt(8)
    v_mfma_f32_32x32x16_bf16 v[48:63], v[12:15], v[96:99], 0
    ds_read_b64_tr_b16 v[12:13], v4 offset:8064
    ds_read_b64_tr_b16 v[14:15], v4 offset:8320
    s_waitcnt lgkmcnt(8)
    v_mfma_f32_32x32x16_bf16 v[32:47], v[16:19], v[100:103], v[32:47]
    ds_read_b64_tr_b16 v[16:17], v4 offset:8576
    ds_read_b64_tr_b16 v[18:19], v4 offset:8832
    v_max_f32 v64, 0, v64
    v_max_f32 v65, 0, v65
    s_waitcnt lgkmcnt(8)
    v_mfma_f32_32x32x16_bf16 v[48:63], v[20:23], v[100:103], v[48:63]
    ds_read_b64_tr_b16 v[20:21], v4 offset:9088
    ds_read_b64_tr_b16 v[22:23], v4 offset:9344
    v_max_f32 v66, 0, v66
    v_max_f32 v67, 0, v67
    s_waitcnt lgkmcnt(8)
    v_mfma_f32_32x32x16_bf16 v[32:47], v[24:27], v[104:107], v[32:47]
    ds_read_b64_tr_b16 v[24:25], v4 offset:9600
    ds_read_b64_tr_b16 v[26:27], v4 offset:9856
    v_max_f32 v68, 0, v68
    v_max_f32 v69, 0, v69
    s_waitcnt lgkmcnt(8)
    v_mfma_f32_32x32x16_bf16 v[48:63], v[28:31], v[104:107], v[48:63]
    ds_read_b64_tr_b16 v[28:29], v4 offset:10112
    ds_read_b64_tr_b16 v[30:31], v4 offset:10368
    v_max_f32 v70, 0, v70
    v_max_f32 v71, 0, v71
    s_waitcnt lgkmcnt(8)
    v_mfma_f32_32x32x16_bf16 v[32:47], v[12:15], v[108:111], v[32:47]
    ds_read_b64_tr_b16 v[12:13], v4 offset:10624
    ds_read_b64_tr_b16 v[14:15], v4 offset:10880
    v_mul_f32 v72, v6, v72
    v_mul_f32 v73, v6, v73
    s_waitcnt lgkmcnt(8)
    v_mfma_f32_32x32x16_bf16 v[48:63], v[16:19], v[108:111], v[48:63]
    ds_read_b64_tr_b16 v[16:17], v4 offset:11136
    ds_read_b64_tr_b16 v[18:19], v4 offset:11392
    v_mul_f32 v74, v6, v74
    v_mul_f32 v75, v6, v75
    s_waitcnt lgkmcnt(8)
    v_mfma_f32_32x32x16_bf16 v[32:47], v[20:23], v[112:115], v[32:47]
    ds_read_b64_tr_b16 v[20:21], v4 offset:11648
    ds_read_b64_tr_b16 v[22:23], v4 offset:11904
    v_mul_f32 v76, v6, v76
    v_mul_f32 v77, v6, v77
    s_waitcnt lgkmcnt(8)
    v_mfma_f32_32x32x16_bf16 v[48:63], v[24:27], v[112:115], v[48:63]
    ds_read_b64_tr_b16 v[24:25], v4 offset:12160
    ds_read_b64_tr_b16 v[26:27], v4 offset:12416
    v_mul_f32 v78, v6, v78
    v_mul_f32 v79, v6, v79
    s_waitcnt lgkmcnt(8)
    v_mfma_f32_32x32x16_bf16 v[32:47], v[28:31], v[116:119], v[32:47]
    ds_read_b64_tr_b16 v[28:29], v4 offset:12672
    ds_read_b64_tr_b16 v[30:31], v4 offset:12928
    v_mul_f32 v64, v64, v72
    v_mul_f32 v65, v65, v73
    s_waitcnt lgkmcnt(8)
    v_mfma_f32_32x32x16_bf16 v[48:63], v[12:15], v[116:119], v[48:63]
    ds_read_b64_tr_b16 v[12:13], v4 offset:21504
    ds_read_b64_tr_b16 v[14:15], v4 offset:21760
    v_mul_f32 v66, v66, v74
    v_mul_f32 v67, v67, v75
    s_waitcnt lgkmcnt(8)
    v_mfma_f32_32x32x16_bf16 v[32:47], v[16:19], v[120:123], v[32:47]
    ds_read_b64_tr_b16 v[16:17], v4 offset:22016
    ds_read_b64_tr_b16 v[18:19], v4 offset:22272
    v_mul_f32 v68, v68, v76
    v_mul_f32 v69, v69, v77
    s_waitcnt lgkmcnt(8)
    v_mfma_f32_32x32x16_bf16 v[48:63], v[20:23], v[120:123], v[48:63]
    ds_read_b64_tr_b16 v[20:21], v4 offset:22528
    ds_read_b64_tr_b16 v[22:23], v4 offset:22784
    v_mul_f32 v70, v70, v78
    v_mul_f32 v71, v71, v79
    s_waitcnt lgkmcnt(8)
    v_mfma_f32_32x32x16_bf16 v[32:47], v[24:27], v[124:127], v[32:47]
    ds_read_b64_tr_b16 v[24:25], v4 offset:23040
    ds_read_b64_tr_b16 v[26:27], v4 offset:23296
    v_cvt_pk_bf16_f32 v72, v64, v65
    v_cvt_pk_bf16_f32 v73, v66, v67
    s_waitcnt lgkmcnt(8)
    v_mfma_f32_32x32x16_bf16 v[48:63], v[28:31], v[124:127], v[48:63]
    ds_read_b64_tr_b16 v[28:29], v4 offset:23552
    ds_read_b64_tr_b16 v[30:31], v4 offset:23808
    v_cvt_pk_bf16_f32 v74, v68, v69
    v_cvt_pk_bf16_f32 v75, v70, v71
    s_barrier
    s_waitcnt lgkmcnt(8)
    v_mfma_f32_32x32x16_bf16 v[32:47], v[12:15], v[128:131], v[32:47]
    ds_read_b64_tr_b16 v[12:13], v4 offset:24064
    ds_read_b64_tr_b16 v[14:15], v4 offset:24320
    s_add_u32 s61, s55, 16384
    buffer_store_dwordx4 v[72:75], v1, s[56:59], s61 offen offset:0 sc1
    v_max_f32 v80, 0, v80
    s_waitcnt lgkmcnt(8)
    v_mfma_f32_32x32x16_bf16 v[48:63], v[16:19], v[128:131], v[48:63]
    ds_read_b64_tr_b16 v[16:17], v4 offset:24576
    ds_read_b64_tr_b16 v[18:19], v4 offset:24832
    v_max_f32 v81, 0, v81
    v_max_f32 v82, 0, v82
    s_waitcnt lgkmcnt(8)
    v_mfma_f32_32x32x16_bf16 v[32:47], v[20:23], v[132:135], v[32:47]
    ds_read_b64_tr_b16 v[20:21], v4 offset:25088
    ds_read_b64_tr_b16 v[22:23], v4 offset:25344
    v_max_f32 v83, 0, v83
    v_max_f32 v84, 0, v84
    s_waitcnt lgkmcnt(8)
    v_mfma_f32_32x32x16_bf16 v[48:63], v[24:27], v[132:135], v[48:63]
    ds_read_b64_tr_b16 v[24:25], v4 offset:25600
    ds_read_b64_tr_b16 v[26:27], v4 offset:25856
    v_max_f32 v85, 0, v85
    v_max_f32 v86, 0, v86
    s_waitcnt lgkmcnt(8)
    v_mfma_f32_32x32x16_bf16 v[32:47], v[28:31], v[136:139], v[32:47]
    ds_read_b64_tr_b16 v[28:29], v4 offset:26112
    ds_read_b64_tr_b16 v[30:31], v4 offset:26368
    v_max_f32 v87, 0, v87
    v_mul_f32 v88, v6, v88
    s_waitcnt lgkmcnt(8)
    v_mfma_f32_32x32x16_bf16 v[48:63], v[12:15], v[136:139], v[48:63]
    ds_read_b64_tr_b16 v[12:13], v4 offset:26624
    ds_read_b64_tr_b16 v[14:15], v4 offset:26880
    v_mul_f32 v89, v6, v89
    v_mul_f32 v90, v6, v90
    s_waitcnt lgkmcnt(8)
    v_mfma_f32_32x32x16_bf16 v[32:47], v[16:19], v[140:143], v[32:47]
    ds_read_b64_tr_b16 v[16:17], v4 offset:27136
    ds_read_b64_tr_b16 v[18:19], v4 offset:27392
    v_mul_f32 v91, v6, v91
    v_mul_f32 v92, v6, v92
    s_waitcnt lgkmcnt(8)
    v_mfma_f32_32x32x16_bf16 v[48:63], v[20:23], v[140:143], v[48:63]
    ds_read_b64_tr_b16 v[20:21], v4 offset:27648
    ds_read_b64_tr_b16 v[22:23], v4 offset:27904
    v_mul_f32 v93, v6, v93
    v_mul_f32 v94, v6, v94
    s_waitcnt lgkmcnt(8)
    v_mfma_f32_32x32x16_bf16 v[32:47], v[24:27], v[144:147], v[32:47]
    ds_read_b64_tr_b16 v[24:25], v4 offset:28160
    ds_read_b64_tr_b16 v[26:27], v4 offset:28416
    v_mul_f32 v95, v6, v95
    v_mul_f32 v80, v80, v88
    s_waitcnt lgkmcnt(8)
    v_mfma_f32_32x32x16_bf16 v[48:63], v[28:31], v[144:147], v[48:63]
    ds_read_b64_tr_b16 v[28:29], v4 offset:28672
    ds_read_b64_tr_b16 v[30:31], v4 offset:28928
    v_mul_f32 v81, v81, v89
    v_mul_f32 v82, v82, v90
    s_waitcnt lgkmcnt(8)
    v_mfma_f32_32x32x16_bf16 v[32:47], v[12:15], v[148:151], v[32:47]
    ds_read_b64_tr_b16 v[12:13], v4 offset:29184
    ds_read_b64_tr_b16 v[14:15], v4 offset:29440
    v_mul_f32 v83, v83, v91
    v_mul_f32 v84, v84, v92
    s_waitcnt lgkmcnt(8)
    v_mfma_f32_32x32x16_bf16 v[48:63], v[16:19], v[148:151], v[48:63]
    ds_read_b64_tr_b16 v[16:17], v2 offset:2048
    ds_read_b64_tr_b16 v[18:19], v2 offset:2304
    v_mul_f32 v85, v85, v93
    v_mul_f32 v86, v86, v94
    s_waitcnt lgkmcnt(8)
    v_mfma_f32_32x32x16_bf16 v[32:47], v[20:23], v[152:155], v[32:47]
    ds_read_b64_tr_b16 v[20:21], v2 offset:2560
    ds_read_b64_tr_b16 v[22:23], v2 offset:2816
    v_mul_f32 v87, v87, v95
    v_cvt_pk_bf16_f32 v88, v80, v81
    s_waitcnt lgkmcnt(8)
    v_mfma_f32_32x32x16_bf16 v[48:63], v[24:27], v[152:155], v[48:63]
    ds_read_b64_tr_b16 v[24:25], v2 offset:3072
    ds_read_b64_tr_b16 v[26:27], v2 offset:3328
    v_cvt_pk_bf16_f32 v89, v82, v83
    v_cvt_pk_bf16_f32 v90, v84, v85
    s_waitcnt lgkmcnt(8)
    v_mfma_f32_32x32x16_bf16 v[32:47], v[28:31], v[156:159], v[32:47]
    ds_read_b64_tr_b16 v[28:29], v2 offset:3584
    ds_read_b64_tr_b16 v[30:31], v2 offset:3840
    v_cvt_pk_bf16_f32 v91, v86, v87
    buffer_store_dwordx4 v[88:91], v1, s[56:59], s61 offen offset:512 sc1
    s_waitcnt lgkmcnt(8)
    v_mfma_f32_32x32x16_bf16 v[48:63], v[12:15], v[156:159], v[48:63]
    ds_read_b64_tr_b16 v[12:13], v2 offset:4096
    ds_read_b64_tr_b16 v[14:15], v2 offset:4352
    s_waitcnt vmcnt(0)
    s_barrier
    s_waitcnt lgkmcnt(8)
    v_mfma_f32_32x32x16_bf16 v[32:47], v[16:19], v[160:163], v[32:47]
    ds_read_b64_tr_b16 v[16:17], v2 offset:4608
    ds_read_b64_tr_b16 v[18:19], v2 offset:4864
    s_waitcnt lgkmcnt(8)
    v_mfma_f32_32x32x16_bf16 v[48:63], v[20:23], v[160:163], v[48:63]
    ds_read_b64_tr_b16 v[20:21], v2 offset:5120
    ds_read_b64_tr_b16 v[22:23], v2 offset:5376
    s_waitcnt lgkmcnt(8)
    v_mfma_f32_32x32x16_bf16 v[32:47], v[24:27], v[164:167], v[32:47]
    ds_read_b64_tr_b16 v[24:25], v2 offset:5632
    ds_read_b64_tr_b16 v[26:27], v2 offset:5888
    s_waitcnt lgkmcnt(8)
    v_mfma_f32_32x32x16_bf16 v[48:63], v[28:31], v[164:167], v[48:63]
    ds_read_b64_tr_b16 v[28:29], v2 offset:6144
    ds_read_b64_tr_b16 v[30:31], v2 offset:6400
    s_waitcnt lgkmcnt(8)
    v_mfma_f32_32x32x16_bf16 v[32:47], v[12:15], v[168:171], v[32:47]
    ds_read_b64_tr_b16 v[12:13], v2 offset:6656
    ds_read_b64_tr_b16 v[14:15], v2 offset:6912
    s_waitcnt lgkmcnt(8)
    v_mfma_f32_32x32x16_bf16 v[48:63], v[16:19], v[168:171], v[48:63]
    ds_read_b64_tr_b16 v[16:17], v2 offset:7168
    ds_read_b64_tr_b16 v[18:19], v2 offset:7424
    s_waitcnt lgkmcnt(8)
    v_mfma_f32_32x32x16_bf16 v[32:47], v[20:23], v[172:175], v[32:47]
    ds_read_b64_tr_b16 v[20:21], v2 offset:7680
    ds_read_b64_tr_b16 v[22:23], v2 offset:7936
    s_waitcnt lgkmcnt(8)
    v_mfma_f32_32x32x16_bf16 v[48:63], v[24:27], v[172:175], v[48:63]
    ds_read_b64_tr_b16 v[24:25], v2 offset:8192
    ds_read_b64_tr_b16 v[26:27], v2 offset:8448
    s_waitcnt lgkmcnt(8)
    v_mfma_f32_32x32x16_bf16 v[32:47], v[28:31], v[176:179], v[32:47]
    ds_read_b64_tr_b16 v[28:29], v2 offset:8704
    ds_read_b64_tr_b16 v[30:31], v2 offset:8960
    s_waitcnt lgkmcnt(8)
    v_mfma_f32_32x32x16_bf16 v[48:63], v[12:15], v[176:179], v[48:63]
    ds_read_b64_tr_b16 v[12:13], v2 offset:9216
    ds_read_b64_tr_b16 v[14:15], v2 offset:9472
    s_waitcnt lgkmcnt(8)
    v_mfma_f32_32x32x16_bf16 v[32:47], v[16:19], v[180:183], v[32:47]
    ds_read_b64_tr_b16 v[16:17], v2 offset:9728
    ds_read_b64_tr_b16 v[18:19], v2 offset:9984
    s_waitcnt lgkmcnt(8)
    v_mfma_f32_32x32x16_bf16 v[48:63], v[20:23], v[180:183], v[48:63]
    ds_read_b64_tr_b16 v[20:21], v2 offset:18560
    ds_read_b64_tr_b16 v[22:23], v2 offset:18816
    s_waitcnt lgkmcnt(8)
    v_mfma_f32_32x32x16_bf16 v[32:47], v[24:27], v[184:187], v[32:47]
    ds_read_b64_tr_b16 v[24:25], v2 offset:19072
    ds_read_b64_tr_b16 v[26:27], v2 offset:19328
    s_waitcnt lgkmcnt(8)
    v_mfma_f32_32x32x16_bf16 v[48:63], v[28:31], v[184:187], v[48:63]
    ds_read_b64_tr_b16 v[28:29], v2 offset:19584
    ds_read_b64_tr_b16 v[30:31], v2 offset:19840
    s_waitcnt lgkmcnt(8)
    v_mfma_f32_32x32x16_bf16 v[32:47], v[12:15], v[188:191], v[32:47]
    ds_read_b64_tr_b16 v[12:13], v2 offset:20096
    ds_read_b64_tr_b16 v[14:15], v2 offset:20352
    s_waitcnt lgkmcnt(8)
    v_mfma_f32_32x32x16_bf16 v[48:63], v[16:19], v[188:191], v[48:63]
    ds_read_b64_tr_b16 v[16:17], v2 offset:20608
    ds_read_b64_tr_b16 v[18:19], v2 offset:20864
    s_barrier
    s_waitcnt lgkmcnt(8)
    v_mfma_f32_32x32x16_bf16 v[32:47], v[20:23], v[192:195], v[32:47]
    ds_read_b64_tr_b16 v[20:21], v2 offset:21120
    ds_read_b64_tr_b16 v[22:23], v2 offset:21376
    s_waitcnt lgkmcnt(8)
    v_mfma_f32_32x32x16_bf16 v[48:63], v[24:27], v[192:195], v[48:63]
    ds_read_b64_tr_b16 v[24:25], v2 offset:21632
    ds_read_b64_tr_b16 v[26:27], v2 offset:21888
    s_waitcnt lgkmcnt(8)
    v_mfma_f32_32x32x16_bf16 v[32:47], v[28:31], v[196:199], v[32:47]
    ds_read_b64_tr_b16 v[28:29], v2 offset:22144
    ds_read_b64_tr_b16 v[30:31], v2 offset:22400
    s_waitcnt lgkmcnt(8)
    v_mfma_f32_32x32x16_bf16 v[48:63], v[12:15], v[196:199], v[48:63]
    ds_read_b64_tr_b16 v[12:13], v2 offset:22656
    ds_read_b64_tr_b16 v[14:15], v2 offset:22912
    s_waitcnt lgkmcnt(8)
    v_mfma_f32_32x32x16_bf16 v[32:47], v[16:19], v[200:203], v[32:47]
    ds_read_b64_tr_b16 v[16:17], v2 offset:23168
    ds_read_b64_tr_b16 v[18:19], v2 offset:23424
    s_waitcnt lgkmcnt(8)
    v_mfma_f32_32x32x16_bf16 v[48:63], v[20:23], v[200:203], v[48:63]
    ds_read_b64_tr_b16 v[20:21], v2 offset:23680
    ds_read_b64_tr_b16 v[22:23], v2 offset:23936
    s_waitcnt lgkmcnt(8)
    v_mfma_f32_32x32x16_bf16 v[32:47], v[24:27], v[204:207], v[32:47]
    ds_read_b64_tr_b16 v[24:25], v2 offset:24192
    ds_read_b64_tr_b16 v[26:27], v2 offset:24448
    s_waitcnt lgkmcnt(8)
    v_mfma_f32_32x32x16_bf16 v[48:63], v[28:31], v[204:207], v[48:63]
    ds_read_b64_tr_b16 v[28:29], v2 offset:24704
    ds_read_b64_tr_b16 v[30:31], v2 offset:24960
    s_waitcnt lgkmcnt(8)
    v_mfma_f32_32x32x16_bf16 v[32:47], v[12:15], v[208:211], v[32:47]
    ds_read_b64_tr_b16 v[12:13], v2 offset:25216
    ds_read_b64_tr_b16 v[14:15], v2 offset:25472
    s_waitcnt lgkmcnt(8)
    v_mfma_f32_32x32x16_bf16 v[48:63], v[16:19], v[208:211], v[48:63]
    ds_read_b64_tr_b16 v[16:17], v2 offset:25728
    ds_read_b64_tr_b16 v[18:19], v2 offset:25984
    s_waitcnt lgkmcnt(8)
    v_mfma_f32_32x32x16_bf16 v[32:47], v[20:23], v[212:215], v[32:47]
    ds_read_b64_tr_b16 v[20:21], v2 offset:26240
    ds_read_b64_tr_b16 v[22:23], v2 offset:26496
    s_waitcnt lgkmcnt(8)
    v_mfma_f32_32x32x16_bf16 v[48:63], v[24:27], v[212:215], v[48:63]
    ds_read_b64_tr_b16 v[24:25], v2 offset:35072
    ds_read_b64_tr_b16 v[26:27], v2 offset:35328
    s_waitcnt lgkmcnt(8)
    v_mfma_f32_32x32x16_bf16 v[32:47], v[28:31], v[216:219], v[32:47]
    ds_read_b64_tr_b16 v[28:29], v2 offset:35584
    ds_read_b64_tr_b16 v[30:31], v2 offset:35840
    s_waitcnt lgkmcnt(8)
    v_mfma_f32_32x32x16_bf16 v[48:63], v[12:15], v[216:219], v[48:63]
    ds_read_b64_tr_b16 v[12:13], v2 offset:36096
    ds_read_b64_tr_b16 v[14:15], v2 offset:36352
    s_waitcnt lgkmcnt(8)
    v_mfma_f32_32x32x16_bf16 v[32:47], v[16:19], v[220:223], v[32:47]
    ds_read_b64_tr_b16 v[16:17], v2 offset:36608
    ds_read_b64_tr_b16 v[18:19], v2 offset:36864
    s_waitcnt lgkmcnt(8)
    v_mfma_f32_32x32x16_bf16 v[48:63], v[20:23], v[220:223], v[48:63]
    ds_read_b64_tr_b16 v[20:21], v2 offset:37120
    ds_read_b64_tr_b16 v[22:23], v2 offset:37376
    s_barrier
    s_waitcnt lgkmcnt(8)
    v_mfma_f32_32x32x16_bf16 v[32:47], v[24:27], v[224:227], v[32:47]
    ds_read_b64_tr_b16 v[24:25], v2 offset:37632
    ds_read_b64_tr_b16 v[26:27], v2 offset:37888
    s_waitcnt lgkmcnt(8)
    v_mfma_f32_32x32x16_bf16 v[48:63], v[28:31], v[224:227], v[48:63]
    ds_read_b64_tr_b16 v[28:29], v2 offset:38144
    ds_read_b64_tr_b16 v[30:31], v2 offset:38400
    s_waitcnt lgkmcnt(8)
    v_mfma_f32_32x32x16_bf16 v[32:47], v[12:15], v[228:231], v[32:47]
    ds_read_b64_tr_b16 v[12:13], v2 offset:38656
    ds_read_b64_tr_b16 v[14:15], v2 offset:38912
    s_waitcnt lgkmcnt(8)
    v_mfma_f32_32x32x16_bf16 v[48:63], v[16:19], v[228:231], v[48:63]
    ds_read_b64_tr_b16 v[16:17], v2 offset:39168
    ds_read_b64_tr_b16 v[18:19], v2 offset:39424
    s_waitcnt lgkmcnt(8)
    v_mfma_f32_32x32x16_bf16 v[32:47], v[20:23], v[232:235], v[32:47]
    ds_read_b64_tr_b16 v[20:21], v2 offset:39680
    ds_read_b64_tr_b16 v[22:23], v2 offset:39936
    s_waitcnt lgkmcnt(8)
    v_mfma_f32_32x32x16_bf16 v[48:63], v[24:27], v[232:235], v[48:63]
    ds_read_b64_tr_b16 v[24:25], v2 offset:40192
    ds_read_b64_tr_b16 v[26:27], v2 offset:40448
    s_waitcnt lgkmcnt(8)
    v_mfma_f32_32x32x16_bf16 v[32:47], v[28:31], v[236:239], v[32:47]
    ds_read_b64_tr_b16 v[28:29], v2 offset:40704
    ds_read_b64_tr_b16 v[30:31], v2 offset:40960
    s_waitcnt lgkmcnt(8)
    v_mfma_f32_32x32x16_bf16 v[48:63], v[12:15], v[236:239], v[48:63]
    ds_read_b64_tr_b16 v[12:13], v2 offset:41216
    ds_read_b64_tr_b16 v[14:15], v2 offset:41472
    s_waitcnt lgkmcnt(8)
    v_mfma_f32_32x32x16_bf16 v[32:47], v[16:19], v[240:243], v[32:47]
    ds_read_b64_tr_b16 v[16:17], v2 offset:41728
    ds_read_b64_tr_b16 v[18:19], v2 offset:41984
    s_waitcnt lgkmcnt(8)
    v_mfma_f32_32x32x16_bf16 v[48:63], v[20:23], v[240:243], v[48:63]
    ds_read_b64_tr_b16 v[20:21], v2 offset:42240
    ds_read_b64_tr_b16 v[22:23], v2 offset:42496
    s_waitcnt lgkmcnt(8)
    v_mfma_f32_32x32x16_bf16 v[32:47], v[24:27], v[244:247], v[32:47]
    ds_read_b64_tr_b16 v[24:25], v2 offset:42752
    ds_read_b64_tr_b16 v[26:27], v2 offset:43008
    s_waitcnt lgkmcnt(8)
    v_mfma_f32_32x32x16_bf16 v[48:63], v[28:31], v[244:247], v[48:63]
    ds_read_b64 v[28:29], v0 offset:1024
    s_waitcnt lgkmcnt(7)
    v_mfma_f32_32x32x16_bf16 v[32:47], v[12:15], v[248:251], v[32:47]
    ds_read_b64 v[12:13], v0 offset:1280
    s_waitcnt lgkmcnt(6)
    v_mfma_f32_32x32x16_bf16 v[48:63], v[16:19], v[248:251], v[48:63]
    ds_read_b64_tr_b16 v[16:17], v2 offset:51584
    ds_read_b64_tr_b16 v[18:19], v2 offset:51840
    s_waitcnt lgkmcnt(6)
    v_mfma_f32_32x32x16_bf16 v[32:47], v[20:23], v[252:255], v[32:47]
    ds_read_b64_tr_b16 v[20:21], v2 offset:52096
    ds_read_b64_tr_b16 v[22:23], v2 offset:52352
    s_waitcnt lgkmcnt(6)
    v_mfma_f32_32x32x16_bf16 v[48:63], v[24:27], v[252:255], v[48:63]
    ds_read_b64_tr_b16 v[24:25], v2 offset:52608
    ds_read_b64_tr_b16 v[26:27], v2 offset:52864
    s_waitcnt lgkmcnt(7)
    v_mfma_f32_32x32x16_bf16 v[32:47], v[28:31], v[8:11], v[32:47]
    ds_read_b64_tr_b16 v[28:29], v2 offset:53120
    ds_read_b64_tr_b16 v[30:31], v2 offset:53376
    s_waitcnt lgkmcnt(8)
    v_mfma_f32_32x32x16_bf16 v[48:63], v[12:15], v[8:11], v[48:63]
    ds_read_b64_tr_b16 v[12:13], v2 offset:53632
    ds_read_b64_tr_b16 v[14:15], v2 offset:53888
    s_barrier
    s_waitcnt lgkmcnt(8)
    v_mfma_f32_32x32x16_bf16 v[64:79], v[16:19], v[96:99], 0
    ds_read_b64_tr_b16 v[16:17], v2 offset:54144
    ds_read_b64_tr_b16 v[18:19], v2 offset:54400
    s_waitcnt lgkmcnt(8)
    v_mfma_f32_32x32x16_bf16 v[80:95], v[20:23], v[100:103], 0
    ds_read_b64_tr_b16 v[20:21], v2 offset:54656
    ds_read_b64_tr_b16 v[22:23], v2 offset:54912
    s_waitcnt lgkmcnt(8)
    v_mfma_f32_32x32x16_bf16 v[64:79], v[24:27], v[104:107], v[64:79]
    ds_read_b64_tr_b16 v[24:25], v2 offset:55168
    ds_read_b64_tr_b16 v[26:27], v2 offset:55424
    v_max_f32 v32, 0, v32
    v_max_f32 v33, 0, v33
    s_waitcnt lgkmcnt(8)
    v_mfma_f32_32x32x16_bf16 v[80:95], v[28:31], v[108:111], v[80:95]
    ds_read_b64_tr_b16 v[28:29], v2 offset:55680
    ds_read_b64_tr_b16 v[30:31], v2 offset:55936
    v_max_f32 v34, 0, v34
    v_max_f32 v35, 0, v35
    s_add_u32 s32, s31, 0
    buffer_load_dwordx4 v[104:107], v5, s[12:15], s32 offen offset:0 sc1
    s_waitcnt lgkmcnt(8)
    v_mfma_f32_32x32x16_bf16 v[64:79], v[12:15], v[112:115], v[64:79]
    ds_read_b64_tr_b16 v[12:13], v2 offset:56192
    ds_read_b64_tr_b16 v[14:15], v3 offset:128
    v_max_f32 v36, 0, v36
    v_max_f32 v37, 0, v37
    buffer_load_dwordx4 v[108:111], v7, s[12:15], s32 offen offset:0 sc1
    s_waitcnt lgkmcnt(8)
    v_mfma_f32_32x32x16_bf16 v[80:95], v[16:19], v[116:119], v[80:95]
    ds_read_b64_tr_b16 v[16:17], v3 offset:384
    ds_read_b64_tr_b16 v[18:19], v3 offset:640
    v_max_f32 v38, 0, v38
    v_max_f32 v39, 0, v39
    buffer_load_dwordx4 v[112:115], v5, s[12:15], s32 offen offset:2048 sc1
    s_waitcnt lgkmcnt(8)
    v_mfma_f32_32x32x16_bf16 v[64:79], v[20:23], v[120:123], v[64:79]
    ds_read_b64_tr_b16 v[20:21], v3 offset:896
    ds_read_b64_tr_b16 v[22:23], v3 offset:1152
    v_mul_f32 v40, v6, v40
    v_mul_f32 v41, v6, v41
    buffer_load_dwordx4 v[116:119], v7, s[12:15], s32 offen offset:2048 sc1
    s_waitcnt lgkmcnt(8)
    v_mfma_f32_32x32x16_bf16 v[80:95], v[24:27], v[124:127], v[80:95]
    ds_read_b64_tr_b16 v[24:25], v3 offset:1408
    ds_read_b64_tr_b16 v[26:27], v3 offset:1664
    v_mul_f32 v42, v6, v42
    v_mul_f32 v43, v6, v43
    s_add_u32 s32, s31, 4096
    buffer_load_dwordx4 v[120:123], v5, s[12:15], s32 offen offset:0 sc1
    s_waitcnt lgkmcnt(8)
    v_mfma_f32_32x32x16_bf16 v[64:79], v[28:31], v[128:131], v[64:79]
    ds_read_b64_tr_b16 v[28:29], v3 offset:1920
    ds_read_b64_tr_b16 v[30:31], v3 offset:2176
    v_mul_f32 v44, v6, v44
    v_mul_f32 v45, v6, v45
    buffer_load_dwordx4 v[124:127], v7, s[12:15], s32 offen offset:0 sc1
    s_waitcnt lgkmcnt(8)
    v_mfma_f32_32x32x16_bf16 v[80:95], v[12:15], v[132:135], v[80:95]
    ds_read_b64_tr_b16 v[12:13], v3 offset:2432
    ds_read_b64_tr_b16 v[14:15], v3 offset:2688
    v_mul_f32 v46, v6, v46
    v_mul_f32 v47, v6, v47
    buffer_load_dwordx4 v[128:131], v5, s[12:15], s32 offen offset:2048 sc1
    s_waitcnt lgkmcnt(8)
    v_mfma_f32_32x32x16_bf16 v[64:79], v[16:19], v[136:139], v[64:79]
    ds_read_b64_tr_b16 v[16:17], v3 offset:2944
    ds_read_b64_tr_b16 v[18:19], v3 offset:3200
    v_mul_f32 v32, v32, v40
    v_mul_f32 v33, v33, v41
    buffer_load_dwordx4 v[132:135], v7, s[12:15], s32 offen offset:2048 sc1
    s_waitcnt lgkmcnt(8)
    v_mfma_f32_32x32x16_bf16 v[80:95], v[20:23], v[140:143], v[80:95]
    ds_read_b64_tr_b16 v[20:21], v3 offset:11776
    ds_read_b64_tr_b16 v[22:23], v3 offset:12032
    v_mul_f32 v34, v34, v42
    v_mul_f32 v35, v35, v43
    s_add_u32 s32, s31, 8192
    buffer_load_dwordx4 v[136:139], v5, s[12:15], s32 offen offset:0 sc1
    s_waitcnt lgkmcnt(8)
    v_mfma_f32_32x32x16_bf16 v[64:79], v[24:27], v[144:147], v[64:79]
    ds_read_b64_tr_b16 v[24:25], v3 offset:12288
    ds_read_b64_tr_b16 v[26:27], v3 offset:12544
    v_mul_f32 v36, v36, v44
    v_mul_f32 v37, v37, v45
    buffer_load_dwordx4 v[140:143], v7, s[12:15], s32 offen offset:0 sc1
    s_waitcnt lgkmcnt(8)
    v_mfma_f32_32x32x16_bf16 v[80:95], v[28:31], v[148:151], v[80:95]
    ds_read_b64_tr_b16 v[28:29], v3 offset:12800
    ds_read_b64_tr_b16 v[30:31], v3 offset:13056
    v_mul_f32 v38, v38, v46
    v_mul_f32 v39, v39, v47
    buffer_load_dwordx4 v[144:147], v5, s[12:15], s32 offen offset:2048 sc1
    s_waitcnt lgkmcnt(8)
    v_mfma_f32_32x32x16_bf16 v[64:79], v[12:15], v[152:155], v[64:79]
    ds_read_b64_tr_b16 v[12:13], v3 offset:13312
    ds_read_b64_tr_b16 v[14:15], v3 offset:13568
    v_cvt_pk_bf16_f32 v40, v32, v33
    v_cvt_pk_bf16_f32 v41, v34, v35
    buffer_load_dwordx4 v[148:151], v7, s[12:15], s32 offen offset:2048 sc1
    s_waitcnt lgkmcnt(8)
    v_mfma_f32_32x32x16_bf16 v[80:95], v[16:19], v[156:159], v[80:95]
    ds_read_b64_tr_b16 v[16:17], v3 offset:13824
    ds_read_b64_tr_b16 v[18:19], v3 offset:14080
    v_cvt_pk_bf16_f32 v42, v36, v37
    v_cvt_pk_bf16_f32 v43, v38, v39
    s_add_u32 s32, s31, 12288
    buffer_load_dwordx4 v[152:155], v5, s[12:15], s32 offen offset:0 sc1
    s_barrier
    s_waitcnt lgkmcnt(8)
    v_mfma_f32_32x32x16_bf16 v[64:79], v[20:23], v[160:163], v[64:79]
    ds_read_b64_tr_b16 v[20:21], v3 offset:14336
    ds_read_b64_tr_b16 v[22:23], v3 offset:14592
    s_add_u32 s61, s55, 32768
    buffer_store_dwordx4 v[40:43], v1, s[56:59], s61 offen offset:0 sc1
    v_max_f32 v48, 0, v48
    buffer_load_dwordx4 v[156:159], v7, s[12:15], s32 offen offset:0 sc1
    s_waitcnt lgkmcnt(8)
    v_mfma_f32_32x32x16_bf16 v[80:95], v[24:27], v[164:167], v[80:95]
    ds_read_b64_tr_b16 v[24:25], v3 offset:14848
    ds_read_b64_tr_b16 v[26:27], v3 offset:15104
    v_max_f32 v49, 0, v49
    v_max_f32 v50, 0, v50
    buffer_load_dwordx4 v[160:163], v5, s[12:15], s32 offen offset:2048 sc1
    s_waitcnt lgkmcnt(8)
    v_mfma_f32_32x32x16_bf16 v[64:79], v[28:31], v[168:171], v[64:79]
    ds_read_b64_tr_b16 v[28:29], v3 offset:15360
    ds_read_b64_tr_b16 v[30:31], v3 offset:15616
    v_max_f32 v51, 0, v51
    v_max_f32 v52, 0, v52
    buffer_load_dwordx4 v[164:167], v7, s[12:15], s32 offen offset:2048 sc1
    s_waitcnt lgkmcnt(8)
    v_mfma_f32_32x32x16_bf16 v[80:95], v[12:15], v[172:175], v[80:95]
    ds_read_b64_tr_b16 v[12:13], v3 offset:15872
    ds_read_b64_tr_b16 v[14:15], v3 offset:16128
    v_max_f32 v53, 0, v53
    v_max_f32 v54, 0, v54
    s_waitcnt lgkmcnt(8)
    v_mfma_f32_32x32x16_bf16 v[64:79], v[16:19], v[176:179], v[64:79]
    ds_read_b64_tr_b16 v[16:17], v3 offset:16384
    ds_read_b64_tr_b16 v[18:19], v3 offset:16640
    v_max_f32 v55, 0, v55
    v_mul_f32 v56, v6, v56
    s_waitcnt lgkmcnt(8)
    v_mfma_f32_32x32x16_bf16 v[80:95], v[20:23], v[180:183], v[80:95]
    ds_read_b64_tr_b16 v[20:21], v3 offset:16896
    ds_read_b64_tr_b16 v[22:23], v3 offset:17152
    v_mul_f32 v57, v6, v57
    v_mul_f32 v58, v6, v58
    s_waitcnt lgkmcnt(8)
    v_mfma_f32_32x32x16_bf16 v[64:79], v[24:27], v[184:187], v[64:79]
    ds_read_b64_tr_b16 v[24:25], v3 offset:17408
    ds_read_b64_tr_b16 v[26:27], v3 offset:17664
    v_mul_f32 v59, v6, v59
    v_mul_f32 v60, v6, v60
    s_waitcnt lgkmcnt(8)
    v_mfma_f32_32x32x16_bf16 v[80:95], v[28:31], v[188:191], v[80:95]
    ds_read_b64_tr_b16 v[28:29], v3 offset:17920
    ds_read_b64_tr_b16 v[30:31], v3 offset:18176
    v_mul_f32 v61, v6, v61
    v_mul_f32 v62, v6, v62
    s_waitcnt lgkmcnt(8)
    v_mfma_f32_32x32x16_bf16 v[64:79], v[12:15], v[192:195], v[64:79]
    ds_read_b64_tr_b16 v[12:13], v3 offset:18432
    ds_read_b64_tr_b16 v[14:15], v3 offset:18688
    v_mul_f32 v63, v6, v63
    v_mul_f32 v48, v48, v56
    s_waitcnt lgkmcnt(8)
    v_mfma_f32_32x32x16_bf16 v[80:95], v[16:19], v[196:199], v[80:95]
    ds_read_b64_tr_b16 v[16:17], v3 offset:18944
    ds_read_b64_tr_b16 v[18:19], v3 offset:19200
    v_mul_f32 v49, v49, v57
    v_mul_f32 v50, v50, v58
    s_waitcnt lgkmcnt(8)
    v_mfma_f32_32x32x16_bf16 v[64:79], v[20:23], v[200:203], v[64:79]
    ds_read_b64_tr_b16 v[20:21], v3 offset:19456
    ds_read_b64_tr_b16 v[22:23], v3 offset:19712
    v_mul_f32 v51, v51, v59
    v_mul_f32 v52, v52, v60
    s_waitcnt lgkmcnt(8)
    v_mfma_f32_32x32x16_bf16 v[80:95], v[24:27], v[204:207], v[80:95]
    ds_read_b64_tr_b16 v[24:25], v3 offset:28288
    ds_read_b64_tr_b16 v[26:27], v3 offset:28544
    v_mul_f32 v53, v53, v61
    v_mul_f32 v54, v54, v62
    s_waitcnt lgkmcnt(8)
    v_mfma_f32_32x32x16_bf16 v[64:79], v[28:31], v[208:211], v[64:79]
    ds_read_b64_tr_b16 v[28:29], v3 offset:28800
    ds_read_b64_tr_b16 v[30:31], v3 offset:29056
    v_mul_f32 v55, v55, v63
    v_cvt_pk_bf16_f32 v56, v48, v49
    s_waitcnt lgkmcnt(8)
    v_mfma_f32_32x32x16_bf16 v[80:95], v[12:15], v[212:215], v[80:95]
    ds_read_b64_tr_b16 v[12:13], v3 offset:29312
    ds_read_b64_tr_b16 v[14:15], v3 offset:29568
    v_cvt_pk_bf16_f32 v57, v50, v51
    v_cvt_pk_bf16_f32 v58, v52, v53
    s_waitcnt lgkmcnt(8)
    v_mfma_f32_32x32x16_bf16 v[64:79], v[16:19], v[216:219], v[64:79]
    ds_read_b64_tr_b16 v[16:17], v3 offset:29824
    ds_read_b64_tr_b16 v[18:19], v3 offset:30080
    v_cvt_pk_bf16_f32 v59, v54, v55
    buffer_store_dwordx4 v[56:59], v1, s[56:59], s61 offen offset:512 sc1
    s_waitcnt lgkmcnt(8)
    v_mfma_f32_32x32x16_bf16 v[80:95], v[20:23], v[220:223], v[80:95]
    ds_read_b64_tr_b16 v[20:21], v3 offset:30336
    ds_read_b64_tr_b16 v[22:23], v3 offset:30592
    s_barrier
    s_waitcnt lgkmcnt(8)
    v_mfma_f32_32x32x16_bf16 v[64:79], v[24:27], v[224:227], v[64:79]
    ds_read_b64_tr_b16 v[24:25], v3 offset:30848
    ds_read_b64_tr_b16 v[26:27], v3 offset:31104
    s_add_u32 s32, s31, 16384
    buffer_load_dwordx4 v[168:171], v5, s[12:15], s32 offen offset:0 sc1
    s_waitcnt lgkmcnt(8)
    v_mfma_f32_32x32x16_bf16 v[80:95], v[28:31], v[228:231], v[80:95]
    ds_read_b64_tr_b16 v[28:29], v3 offset:31360
    ds_read_b64_tr_b16 v[30:31], v3 offset:31616
    buffer_load_dwordx4 v[172:175], v7, s[12:15], s32 offen offset:0 sc1
    s_waitcnt lgkmcnt(8)
    v_mfma_f32_32x32x16_bf16 v[64:79], v[12:15], v[232:235], v[64:79]
    ds_read_b64_tr_b16 v[12:13], v3 offset:31872
    ds_read_b64_tr_b16 v[14:15], v3 offset:32128
    buffer_load_dwordx4 v[176:179], v5, s[12:15], s32 offen offset:2048 sc1
    s_waitcnt lgkmcnt(8)
    v_mfma_f32_32x32x16_bf16 v[80:95], v[16:19], v[236:239], v[80:95]
    ds_read_b64 v[16:17], v0 offset:1536
    buffer_load_dwordx4 v[180:183], v7, s[12:15], s32 offen offset:2048 sc1
    s_waitcnt lgkmcnt(7)
    v_mfma_f32_32x32x16_bf16 v[64:79], v[20:23], v[240:243], v[64:79]
    s_add_u32 s32, s31, 20480
    buffer_load_dwordx4 v[184:187], v5, s[12:15], s32 offen offset:0 sc1
    s_waitcnt lgkmcnt(5)
    v_mfma_f32_32x32x16_bf16 v[80:95], v[24:27], v[244:247], v[80:95]
    buffer_load_dwordx4 v[188:191], v7, s[12:15], s32 offen offset:0 sc1
    s_waitcnt lgkmcnt(3)
    v_mfma_f32_32x32x16_bf16 v[64:79], v[28:31], v[248:251], v[64:79]
    buffer_load_dwordx4 v[192:195], v5, s[12:15], s32 offen offset:2048 sc1
    s_waitcnt lgkmcnt(1)
    v_mfma_f32_32x32x16_bf16 v[80:95], v[12:15], v[252:255], v[80:95]
    buffer_load_dwordx4 v[196:199], v7, s[12:15], s32 offen offset:2048 sc1
    s_waitcnt lgkmcnt(0)
    v_mfma_f32_32x32x16_bf16 v[64:79], v[16:19], v[8:11], v[64:79]
    s_add_u32 s32, s31, 24576
    buffer_load_dwordx4 v[200:203], v5, s[12:15], s32 offen offset:0 sc1
    v_mbcnt_lo_u32_b32 v0, -1, 0
    v_mbcnt_hi_u32_b32 v0, -1, v0
    v_bfe_u32 v2, v0, 2, 3
    v_lshrrev_b32 v3, 5, v0
    v_lshl_add_u32 v2, v3, 4, v2
    v_mul_u32_u24 v2, 160, v2
    v_and_b32 v3, 3, v0
    v_lshl_add_u32 v2, v3, 3, v2
    s_mul_i32 s38, s38, 5120
    v_add_u32 v2, s38, v2
    v_add_u32 v3, 61440, v2
    v_add_u32 v4, 122880, v2
    ds_read_b64_tr_b16 v[8:9], v3 offset:35584
    ds_read_b64_tr_b16 v[10:11], v3 offset:36864
    v_add_f32 v64, v64, v80
    v_add_f32 v65, v65, v81
    v_add_f32 v66, v66, v82
    v_add_f32 v67, v67, v83
    ds_read_b64_tr_b16 v[12:13], v3 offset:35616
    ds_read_b64_tr_b16 v[14:15], v3 offset:36896
    v_add_f32 v68, v68, v84
    v_add_f32 v69, v69, v85
    v_add_f32 v70, v70, v86
    v_add_f32 v71, v71, v87
    ds_read_b64_tr_b16 v[16:17], v3 offset:35648
    ds_read_b64_tr_b16 v[18:19], v3 offset:36928
    v_add_f32 v72, v72, v88
    v_add_f32 v73, v73, v89
    v_add_f32 v74, v74, v90
    v_add_f32 v75, v75, v91
    ds_read_b64_tr_b16 v[20:21], v3 offset:35680
    ds_read_b64_tr_b16 v[22:23], v3 offset:36960
    v_add_f32 v76, v76, v92
    v_add_f32 v77, v77, v93
    v_add_f32 v78, v78, v94
    v_add_f32 v79, v79, v95
    ds_read_b64_tr_b16 v[24:25], v3 offset:35712
    ds_read_b64_tr_b16 v[26:27], v3 offset:36992
    v_max_f32 v64, 0, v64
    v_max_f32 v65, 0, v65
    v_max_f32 v66, 0, v66
    v_max_f32 v67, 0, v67
    v_max_f32 v68, 0, v68
    v_max_f32 v69, 0, v69
    v_max_f32 v70, 0, v70
    v_max_f32 v71, 0, v71
    v_mul_f32 v72, v6, v72
    v_mul_f32 v73, v6, v73
    v_mul_f32 v74, v6, v74
    v_mul_f32 v75, v6, v75
    v_mul_f32 v76, v6, v76
    v_mul_f32 v77, v6, v77
    v_mul_f32 v78, v6, v78
    v_mul_f32 v79, v6, v79
    v_mul_f32 v64, v64, v72
    v_mul_f32 v65, v65, v73
    v_mul_f32 v66, v66, v74
    v_mul_f32 v67, v67, v75
    v_mul_f32 v68, v68, v76
    v_mul_f32 v69, v69, v77
    v_mul_f32 v70, v70, v78
    v_mul_f32 v71, v71, v79
    v_cvt_pk_bf16_f32 v72, v64, v65
    v_cvt_pk_bf16_f32 v73, v66, v67
    v_cvt_pk_bf16_f32 v74, v68, v69
    v_cvt_pk_bf16_f32 v75, v70, v71
    buffer_store_dwordx4 v[72:75], v1, s[56:59], s60 offen offset:0 sc1
    v_and_b32 v1, 15, v0
    v_lshrrev_b32 v100, 4, v0
    v_mul_u32_u24 v98, 1280, v1
    v_lshl_add_u32 v98, v100, 3, v98
    s_mul_i32 s33, s30, 20480
    s_mul_i32 s34, s29, 160
    s_add_u32 s33, s33, s34
    v_lshlrev_b32 v99, 4, v1
    v_lshrrev_b32 v1, 1, v100
    v_lshl_add_u32 v99, v1, 9, v99
    v_and_b32 v1, 1, v100
    v_lshl_add_u32 v99, v1, 3, v99
    s_lshr_b32 s34, s30, 1
    s_mul_i32 s34, s34, 40
    s_mul_i32 s35, s29, 5
    s_add_u32 s34, s34, s35
    s_lshl_b32 s34, s34, 10
    s_and_b32 s35, s30, 1
    s_lshl_b32 s35, s35, 8
    s_add_u32 s34, s34, s35
    s_add_u32 s35, s34, 4096
    s_mov_b32 s16, s10
    s_mov_b32 s17, s11
    s_mov_b32 s18, 0x280000
    s_mov_b32 s19, 0x00020000
    s_add_u32 s20, s8, 0xb00000
    s_addc_u32 s21, s9, 0
    s_mov_b32 s22, 0x280000
    s_mov_b32 s23, 0x00020000
    s_mul_i32 s36, s3, 5120
    s_add_u32 s36, s36, 104448
    v_lshlrev_b32 v1, 4, v0
    v_add_u32 v100, s36, v1
    s_xor_b32 s36, s3, 2
    s_mul_i32 s36, s36, 5120
    s_add_u32 s36, s36, 104448
    v_add_u32 v101, s36, v1
    s_mov_b32 s39, 0xffff0000
    s_waitcnt vmcnt(10)
    s_barrier
    s_waitcnt vmcnt(27) lgkmcnt(8)
    v_mfma_f32_16x16x32_bf16 v[48:51], v[8:11], v[104:107], 0
    ds_read_b64_tr_b16 v[28:29], v3 offset:45824
    s_waitcnt vmcnt(26)
    v_mfma_f32_16x16x32_bf16 v[68:71], v[8:11], v[108:111], 0
    ds_read_b64_tr_b16 v[30:31], v3 offset:47104
    buffer_load_dwordx4 v[204:207], v7, s[12:15], s32 offen offset:0 sc1
    s_waitcnt lgkmcnt(8)
    v_mfma_f32_16x16x32_bf16 v[52:55], v[12:15], v[104:107], 0
    ds_read_b64_tr_b16 v[32:33], v3 offset:45856
    v_mfma_f32_16x16x32_bf16 v[72:75], v[12:15], v[108:111], 0
    ds_read_b64_tr_b16 v[34:35], v3 offset:47136
    buffer_load_dwordx4 v[208:211], v5, s[12:15], s32 offen offset:2048 sc1
    s_waitcnt lgkmcnt(8)
    v_mfma_f32_16x16x32_bf16 v[56:59], v[16:19], v[104:107], 0
    ds_read_b64_tr_b16 v[36:37], v3 offset:45888
    v_mfma_f32_16x16x32_bf16 v[76:79], v[16:19], v[108:111], 0
    ds_read_b64_tr_b16 v[38:39], v3 offset:47168
    buffer_load_dwordx4 v[212:215], v7, s[12:15], s32 offen offset:2048 sc1
    s_waitcnt lgkmcnt(8)
    v_mfma_f32_16x16x32_bf16 v[60:63], v[20:23], v[104:107], 0
    ds_read_b64_tr_b16 v[40:41], v3 offset:45920
    v_mfma_f32_16x16x32_bf16 v[80:83], v[20:23], v[108:111], 0
    ds_read_b64_tr_b16 v[42:43], v3 offset:47200
    s_waitcnt lgkmcnt(8)
    v_mfma_f32_16x16x32_bf16 v[64:67], v[24:27], v[104:107], 0
    ds_read_b64_tr_b16 v[44:45], v3 offset:45952
    v_mfma_f32_16x16x32_bf16 v[84:87], v[24:27], v[108:111], 0
    ds_read_b64_tr_b16 v[46:47], v3 offset:47232
    s_waitcnt vmcnt(28) lgkmcnt(8)
    v_mfma_f32_16x16x32_bf16 v[48:51], v[28:31], v[112:115], v[48:51]
    ds_read_b64_tr_b16 v[8:9], v3 offset:56064
    s_waitcnt vmcnt(27)
    v_mfma_f32_16x16x32_bf16 v[68:71], v[28:31], v[116:119], v[68:71]
    ds_read_b64_tr_b16 v[10:11], v3 offset:57344
    s_add_u32 s32, s31, 28672
    buffer_load_dwordx4 v[216:219], v5, s[12:15], s32 offen offset:0 sc1
    s_waitcnt lgkmcnt(8)
    v_mfma_f32_16x16x32_bf16 v[52:55], v[32:35], v[112:115], v[52:55]
    ds_read_b64_tr_b16 v[12:13], v3 offset:56096
    v_mfma_f32_16x16x32_bf16 v[72:75], v[32:35], v[116:119], v[72:75]
    ds_read_b64_tr_b16 v[14:15], v3 offset:57376
    buffer_load_dwordx4 v[220:223], v7, s[12:15], s32 offen offset:0 sc1
    s_waitcnt lgkmcnt(8)
    v_mfma_f32_16x16x32_bf16 v[56:59], v[36:39], v[112:115], v[56:59]
    ds_read_b64_tr_b16 v[16:17], v3 offset:56128
    v_mfma_f32_16x16x32_bf16 v[76:79], v[36:39], v[116:119], v[76:79]
    ds_read_b64_tr_b16 v[18:19], v3 offset:57408
    buffer_load_dwordx4 v[224:227], v5, s[12:15], s32 offen offset:2048 sc1
    s_waitcnt lgkmcnt(8)
    v_mfma_f32_16x16x32_bf16 v[60:63], v[40:43], v[112:115], v[60:63]
    ds_read_b64_tr_b16 v[20:21], v3 offset:56160
    v_mfma_f32_16x16x32_bf16 v[80:83], v[40:43], v[116:119], v[80:83]
    ds_read_b64_tr_b16 v[22:23], v3 offset:57440
    s_waitcnt lgkmcnt(8)
    v_mfma_f32_16x16x32_bf16 v[64:67], v[44:47], v[112:115], v[64:67]
    ds_read_b64_tr_b16 v[24:25], v3 offset:56192
    v_mfma_f32_16x16x32_bf16 v[84:87], v[44:47], v[116:119], v[84:87]
    ds_read_b64_tr_b16 v[26:27], v3 offset:57472
    s_barrier
    s_waitcnt vmcnt(29) lgkmcnt(8)
    v_mfma_f32_16x16x32_bf16 v[48:51], v[8:11], v[120:123], v[48:51]
    ds_read_b64_tr_b16 v[28:29], v4 offset:4864
    s_waitcnt vmcnt(28)
    v_mfma_f32_16x16x32_bf16 v[68:71], v[8:11], v[124:127], v[68:71]
    ds_read_b64_tr_b16 v[30:31], v4 offset:6144
    buffer_load_dwordx4 v[228:231], v7, s[12:15], s32 offen offset:2048 sc1
    s_waitcnt lgkmcnt(8)
    v_mfma_f32_16x16x32_bf16 v[52:55], v[12:15], v[120:123], v[52:55]
    ds_read_b64_tr_b16 v[32:33], v4 offset:4896
    v_mfma_f32_16x16x32_bf16 v[72:75], v[12:15], v[124:127], v[72:75]
    ds_read_b64_tr_b16 v[34:35], v4 offset:6176
    s_waitcnt lgkmcnt(8)
    v_mfma_f32_16x16x32_bf16 v[56:59], v[16:19], v[120:123], v[56:59]
    ds_read_b64_tr_b16 v[36:37], v4 offset:4928
    v_mfma_f32_16x16x32_bf16 v[76:79], v[16:19], v[124:127], v[76:79]
    ds_read_b64_tr_b16 v[38:39], v4 offset:6208
    s_waitcnt lgkmcnt(8)
    v_mfma_f32_16x16x32_bf16 v[60:63], v[20:23], v[120:123], v[60:63]
    ds_read_b64_tr_b16 v[40:41], v4 offset:4960
    v_mfma_f32_16x16x32_bf16 v[80:83], v[20:23], v[124:127], v[80:83]
    ds_read_b64_tr_b16 v[42:43], v4 offset:6240
    s_waitcnt lgkmcnt(8)
    v_mfma_f32_16x16x32_bf16 v[64:67], v[24:27], v[120:123], v[64:67]
    ds_read_b64_tr_b16 v[44:45], v4 offset:4992
    v_mfma_f32_16x16x32_bf16 v[84:87], v[24:27], v[124:127], v[84:87]
    ds_read_b64_tr_b16 v[46:47], v4 offset:6272
    s_waitcnt vmcnt(28) lgkmcnt(8)
    v_mfma_f32_16x16x32_bf16 v[48:51], v[28:31], v[128:131], v[48:51]
    ds_read_b64_tr_b16 v[8:9], v4 offset:15104
    s_waitcnt vmcnt(27)
    v_mfma_f32_16x16x32_bf16 v[68:71], v[28:31], v[132:135], v[68:71]
    ds_read_b64_tr_b16 v[10:11], v4 offset:16384
    s_waitcnt lgkmcnt(8)
    v_mfma_f32_16x16x32_bf16 v[52:55], v[32:35], v[128:131], v[52:55]
    ds_read_b64_tr_b16 v[12:13], v4 offset:15136
    v_mfma_f32_16x16x32_bf16 v[72:75], v[32:35], v[132:135], v[72:75]
    ds_read_b64_tr_b16 v[14:15], v4 offset:16416
    s_waitcnt lgkmcnt(8)
    v_mfma_f32_16x16x32_bf16 v[56:59], v[36:39], v[128:131], v[56:59]
    ds_read_b64_tr_b16 v[16:17], v4 offset:15168
    v_mfma_f32_16x16x32_bf16 v[76:79], v[36:39], v[132:135], v[76:79]
    ds_read_b64_tr_b16 v[18:19], v4 offset:16448
    s_waitcnt lgkmcnt(8)
    v_mfma_f32_16x16x32_bf16 v[60:63], v[40:43], v[128:131], v[60:63]
    ds_read_b64_tr_b16 v[20:21], v4 offset:15200
    v_mfma_f32_16x16x32_bf16 v[80:83], v[40:43], v[132:135], v[80:83]
    ds_read_b64_tr_b16 v[22:23], v4 offset:16480
    s_waitcnt lgkmcnt(8)
    v_mfma_f32_16x16x32_bf16 v[64:67], v[44:47], v[128:131], v[64:67]
    ds_read_b64_tr_b16 v[24:25], v4 offset:15232
    v_mfma_f32_16x16x32_bf16 v[84:87], v[44:47], v[132:135], v[84:87]
    ds_read_b64_tr_b16 v[26:27], v4 offset:16512
    s_waitcnt vmcnt(7)
    s_barrier
    s_waitcnt vmcnt(26) lgkmcnt(8)
    v_mfma_f32_16x16x32_bf16 v[48:51], v[8:11], v[136:139], v[48:51]
    ds_read_b64_tr_b16 v[28:29], v4 offset:25344
    s_waitcnt vmcnt(25)
    v_mfma_f32_16x16x32_bf16 v[68:71], v[8:11], v[140:143], v[68:71]
    ds_read_b64_tr_b16 v[30:31], v4 offset:26624
    s_waitcnt lgkmcnt(8)
    v_mfma_f32_16x16x32_bf16 v[52:55], v[12:15], v[136:139], v[52:55]
    ds_read_b64_tr_b16 v[32:33], v4 offset:25376
    v_mfma_f32_16x16x32_bf16 v[72:75], v[12:15], v[140:143], v[72:75]
    ds_read_b64_tr_b16 v[34:35], v4 offset:26656
    s_waitcnt lgkmcnt(8)
    v_mfma_f32_16x16x32_bf16 v[56:59], v[16:19], v[136:139], v[56:59]
    ds_read_b64_tr_b16 v[36:37], v4 offset:25408
    v_mfma_f32_16x16x32_bf16 v[76:79], v[16:19], v[140:143], v[76:79]
    ds_read_b64_tr_b16 v[38:39], v4 offset:26688
    s_waitcnt lgkmcnt(8)
    v_mfma_f32_16x16x32_bf16 v[60:63], v[20:23], v[136:139], v[60:63]
    ds_read_b64_tr_b16 v[40:41], v4 offset:25440
    v_mfma_f32_16x16x32_bf16 v[80:83], v[20:23], v[140:143], v[80:83]
    ds_read_b64_tr_b16 v[42:43], v4 offset:26720
    s_waitcnt lgkmcnt(8)
    v_mfma_f32_16x16x32_bf16 v[64:67], v[24:27], v[136:139], v[64:67]
    ds_read_b64_tr_b16 v[44:45], v4 offset:25472
    v_mfma_f32_16x16x32_bf16 v[84:87], v[24:27], v[140:143], v[84:87]
    ds_read_b64_tr_b16 v[46:47], v4 offset:26752
    s_waitcnt vmcnt(24) lgkmcnt(8)
    v_mfma_f32_16x16x32_bf16 v[48:51], v[28:31], v[144:147], v[48:51]
    ds_read_b64_tr_b16 v[8:9], v2 offset:2048
    s_waitcnt vmcnt(23)
    v_mfma_f32_16x16x32_bf16 v[68:71], v[28:31], v[148:151], v[68:71]
    ds_read_b64_tr_b16 v[10:11], v2 offset:3328
    s_waitcnt lgkmcnt(8)
    v_mfma_f32_16x16x32_bf16 v[52:55], v[32:35], v[144:147], v[52:55]
    ds_read_b64_tr_b16 v[12:13], v2 offset:2080
    v_mfma_f32_16x16x32_bf16 v[72:75], v[32:35], v[148:151], v[72:75]
    ds_read_b64_tr_b16 v[14:15], v2 offset:3360
    s_waitcnt lgkmcnt(8)
    v_mfma_f32_16x16x32_bf16 v[56:59], v[36:39], v[144:147], v[56:59]
    ds_read_b64_tr_b16 v[16:17], v2 offset:2112
    v_mfma_f32_16x16x32_bf16 v[76:79], v[36:39], v[148:151], v[76:79]
    ds_read_b64_tr_b16 v[18:19], v2 offset:3392
    s_waitcnt lgkmcnt(8)
    v_mfma_f32_16x16x32_bf16 v[60:63], v[40:43], v[144:147], v[60:63]
    ds_read_b64_tr_b16 v[20:21], v2 offset:2144
    v_mfma_f32_16x16x32_bf16 v[80:83], v[40:43], v[148:151], v[80:83]
    ds_read_b64_tr_b16 v[22:23], v2 offset:3424
    s_waitcnt lgkmcnt(8)
    v_mfma_f32_16x16x32_bf16 v[64:67], v[44:47], v[144:147], v[64:67]
    ds_read_b64_tr_b16 v[24:25], v2 offset:2176
    v_mfma_f32_16x16x32_bf16 v[84:87], v[44:47], v[148:151], v[84:87]
    ds_read_b64_tr_b16 v[26:27], v2 offset:3456
    s_barrier
    s_waitcnt vmcnt(22) lgkmcnt(8)
    v_mfma_f32_16x16x32_bf16 v[48:51], v[8:11], v[152:155], v[48:51]
    ds_read_b64_tr_b16 v[28:29], v2 offset:12288
    s_waitcnt vmcnt(20)
    v_mfma_f32_16x16x32_bf16 v[68:71], v[8:11], v[156:159], v[68:71]
    ds_read_b64_tr_b16 v[30:31], v2 offset:13568
    s_waitcnt lgkmcnt(8)
    v_mfma_f32_16x16x32_bf16 v[52:55], v[12:15], v[152:155], v[52:55]
    ds_read_b64_tr_b16 v[32:33], v2 offset:12320
    v_mfma_f32_16x16x32_bf16 v[72:75], v[12:15], v[156:159], v[72:75]
    ds_read_b64_tr_b16 v[34:35], v2 offset:13600
    s_waitcnt lgkmcnt(8)
    v_mfma_f32_16x16x32_bf16 v[56:59], v[16:19], v[152:155], v[56:59]
    ds_read_b64_tr_b16 v[36:37], v2 offset:12352
    v_mfma_f32_16x16x32_bf16 v[76:79], v[16:19], v[156:159], v[76:79]
    ds_read_b64_tr_b16 v[38:39], v2 offset:13632
    s_waitcnt lgkmcnt(8)
    v_mfma_f32_16x16x32_bf16 v[60:63], v[20:23], v[152:155], v[60:63]
    ds_read_b64_tr_b16 v[40:41], v2 offset:12384
    v_mfma_f32_16x16x32_bf16 v[80:83], v[20:23], v[156:159], v[80:83]
    ds_read_b64_tr_b16 v[42:43], v2 offset:13664
    s_waitcnt lgkmcnt(8)
    v_mfma_f32_16x16x32_bf16 v[64:67], v[24:27], v[152:155], v[64:67]
    ds_read_b64_tr_b16 v[44:45], v2 offset:12416
    v_mfma_f32_16x16x32_bf16 v[84:87], v[24:27], v[156:159], v[84:87]
    ds_read_b64_tr_b16 v[46:47], v2 offset:13696
    s_waitcnt vmcnt(19) lgkmcnt(8)
    v_mfma_f32_16x16x32_bf16 v[48:51], v[28:31], v[160:163], v[48:51]
    ds_read_b64_tr_b16 v[8:9], v2 offset:22528
    s_waitcnt vmcnt(18)
    v_mfma_f32_16x16x32_bf16 v[68:71], v[28:31], v[164:167], v[68:71]
    ds_read_b64_tr_b16 v[10:11], v2 offset:23808
    s_waitcnt lgkmcnt(8)
    v_mfma_f32_16x16x32_bf16 v[52:55], v[32:35], v[160:163], v[52:55]
    ds_read_b64_tr_b16 v[12:13], v2 offset:22560
    v_mfma_f32_16x16x32_bf16 v[72:75], v[32:35], v[164:167], v[72:75]
    ds_read_b64_tr_b16 v[14:15], v2 offset:23840
    s_waitcnt lgkmcnt(8)
    v_mfma_f32_16x16x32_bf16 v[56:59], v[36:39], v[160:163], v[56:59]
    ds_read_b64_tr_b16 v[16:17], v2 offset:22592
    v_mfma_f32_16x16x32_bf16 v[76:79], v[36:39], v[164:167], v[76:79]
    ds_read_b64_tr_b16 v[18:19], v2 offset:23872
    s_waitcnt lgkmcnt(8)
    v_mfma_f32_16x16x32_bf16 v[60:63], v[40:43], v[160:163], v[60:63]
    ds_read_b64_tr_b16 v[20:21], v2 offset:22624
    v_mfma_f32_16x16x32_bf16 v[80:83], v[40:43], v[164:167], v[80:83]
    ds_read_b64_tr_b16 v[22:23], v2 offset:23904
    s_waitcnt lgkmcnt(8)
    v_mfma_f32_16x16x32_bf16 v[64:67], v[44:47], v[160:163], v[64:67]
    ds_read_b64_tr_b16 v[24:25], v2 offset:22656
    v_mfma_f32_16x16x32_bf16 v[84:87], v[44:47], v[164:167], v[84:87]
    ds_read_b64_tr_b16 v[26:27], v2 offset:23936
    s_barrier
    s_waitcnt vmcnt(16) lgkmcnt(8)
    v_mfma_f32_16x16x32_bf16 v[48:51], v[8:11], v[168:171], v[48:51]
    ds_read_b64_tr_b16 v[28:29], v2 offset:32768
    s_waitcnt vmcnt(15)
    v_mfma_f32_16x16x32_bf16 v[68:71], v[8:11], v[172:175], v[68:71]
    ds_read_b64_tr_b16 v[30:31], v2 offset:34048
    s_waitcnt lgkmcnt(8)
    v_mfma_f32_16x16x32_bf16 v[52:55], v[12:15], v[168:171], v[52:55]
    ds_read_b64_tr_b16 v[32:33], v2 offset:32800
    v_mfma_f32_16x16x32_bf16 v[72:75], v[12:15], v[172:175], v[72:75]
    ds_read_b64_tr_b16 v[34:35], v2 offset:34080
    s_waitcnt lgkmcnt(8)
    v_mfma_f32_16x16x32_bf16 v[56:59], v[16:19], v[168:171], v[56:59]
    ds_read_b64_tr_b16 v[36:37], v2 offset:32832
    v_mfma_f32_16x16x32_bf16 v[76:79], v[16:19], v[172:175], v[76:79]
    ds_read_b64_tr_b16 v[38:39], v2 offset:34112
    s_waitcnt lgkmcnt(8)
    v_mfma_f32_16x16x32_bf16 v[60:63], v[20:23], v[168:171], v[60:63]
    ds_read_b64_tr_b16 v[40:41], v2 offset:32864
    v_mfma_f32_16x16x32_bf16 v[80:83], v[20:23], v[172:175], v[80:83]
    ds_read_b64_tr_b16 v[42:43], v2 offset:34144
    s_waitcnt lgkmcnt(8)
    v_mfma_f32_16x16x32_bf16 v[64:67], v[24:27], v[168:171], v[64:67]
    ds_read_b64_tr_b16 v[44:45], v2 offset:32896
    v_mfma_f32_16x16x32_bf16 v[84:87], v[24:27], v[172:175], v[84:87]
    ds_read_b64_tr_b16 v[46:47], v2 offset:34176
    s_waitcnt vmcnt(14) lgkmcnt(8)
    v_mfma_f32_16x16x32_bf16 v[48:51], v[28:31], v[176:179], v[48:51]
    ds_read_b64_tr_b16 v[8:9], v2 offset:43008
    s_waitcnt vmcnt(13)
    v_mfma_f32_16x16x32_bf16 v[68:71], v[28:31], v[180:183], v[68:71]
    ds_read_b64_tr_b16 v[10:11], v2 offset:44288
    s_waitcnt lgkmcnt(8)
    v_mfma_f32_16x16x32_bf16 v[52:55], v[32:35], v[176:179], v[52:55]
    ds_read_b64_tr_b16 v[12:13], v2 offset:43040
    v_mfma_f32_16x16x32_bf16 v[72:75], v[32:35], v[180:183], v[72:75]
    ds_read_b64_tr_b16 v[14:15], v2 offset:44320
    s_waitcnt lgkmcnt(8)
    v_mfma_f32_16x16x32_bf16 v[56:59], v[36:39], v[176:179], v[56:59]
    ds_read_b64_tr_b16 v[16:17], v2 offset:43072
    v_mfma_f32_16x16x32_bf16 v[76:79], v[36:39], v[180:183], v[76:79]
    ds_read_b64_tr_b16 v[18:19], v2 offset:44352
    s_waitcnt lgkmcnt(8)
    v_mfma_f32_16x16x32_bf16 v[60:63], v[40:43], v[176:179], v[60:63]
    ds_read_b64_tr_b16 v[20:21], v2 offset:43104
    v_mfma_f32_16x16x32_bf16 v[80:83], v[40:43], v[180:183], v[80:83]
    ds_read_b64_tr_b16 v[22:23], v2 offset:44384
    s_waitcnt lgkmcnt(8)
    v_mfma_f32_16x16x32_bf16 v[64:67], v[44:47], v[176:179], v[64:67]
    ds_read_b64_tr_b16 v[24:25], v2 offset:43136
    v_mfma_f32_16x16x32_bf16 v[84:87], v[44:47], v[180:183], v[84:87]
    ds_read_b64_tr_b16 v[26:27], v2 offset:44416
    s_barrier
    s_waitcnt vmcnt(12) lgkmcnt(8)
    v_mfma_f32_16x16x32_bf16 v[48:51], v[8:11], v[184:187], v[48:51]
    ds_read_b64_tr_b16 v[28:29], v2 offset:53248
    s_waitcnt vmcnt(11)
    v_mfma_f32_16x16x32_bf16 v[68:71], v[8:11], v[188:191], v[68:71]
    ds_read_b64_tr_b16 v[30:31], v2 offset:54528
    s_waitcnt lgkmcnt(8)
    v_mfma_f32_16x16x32_bf16 v[52:55], v[12:15], v[184:187], v[52:55]
    ds_read_b64_tr_b16 v[32:33], v2 offset:53280
    v_mfma_f32_16x16x32_bf16 v[72:75], v[12:15], v[188:191], v[72:75]
    ds_read_b64_tr_b16 v[34:35], v2 offset:54560
    s_waitcnt lgkmcnt(8)
    v_mfma_f32_16x16x32_bf16 v[56:59], v[16:19], v[184:187], v[56:59]
    ds_read_b64_tr_b16 v[36:37], v2 offset:53312
    v_mfma_f32_16x16x32_bf16 v[76:79], v[16:19], v[188:191], v[76:79]
    ds_read_b64_tr_b16 v[38:39], v2 offset:54592
    s_waitcnt lgkmcnt(8)
    v_mfma_f32_16x16x32_bf16 v[60:63], v[20:23], v[184:187], v[60:63]
    ds_read_b64_tr_b16 v[40:41], v2 offset:53344
    v_mfma_f32_16x16x32_bf16 v[80:83], v[20:23], v[188:191], v[80:83]
    ds_read_b64_tr_b16 v[42:43], v2 offset:54624
    s_waitcnt lgkmcnt(8)
    v_mfma_f32_16x16x32_bf16 v[64:67], v[24:27], v[184:187], v[64:67]
    ds_read_b64_tr_b16 v[44:45], v2 offset:53376
    v_mfma_f32_16x16x32_bf16 v[84:87], v[24:27], v[188:191], v[84:87]
    ds_read_b64_tr_b16 v[46:47], v2 offset:54656
    s_waitcnt vmcnt(10) lgkmcnt(8)
    v_mfma_f32_16x16x32_bf16 v[48:51], v[28:31], v[192:195], v[48:51]
    ds_read_b64_tr_b16 v[8:9], v3 offset:2048
    s_waitcnt vmcnt(9)
    v_mfma_f32_16x16x32_bf16 v[68:71], v[28:31], v[196:199], v[68:71]
    ds_read_b64_tr_b16 v[10:11], v3 offset:3328
    s_waitcnt lgkmcnt(8)
    v_mfma_f32_16x16x32_bf16 v[52:55], v[32:35], v[192:195], v[52:55]
    ds_read_b64_tr_b16 v[12:13], v3 offset:2080
    v_mfma_f32_16x16x32_bf16 v[72:75], v[32:35], v[196:199], v[72:75]
    ds_read_b64_tr_b16 v[14:15], v3 offset:3360
    s_waitcnt lgkmcnt(8)
    v_mfma_f32_16x16x32_bf16 v[56:59], v[36:39], v[192:195], v[56:59]
    ds_read_b64_tr_b16 v[16:17], v3 offset:2112
    v_mfma_f32_16x16x32_bf16 v[76:79], v[36:39], v[196:199], v[76:79]
    ds_read_b64_tr_b16 v[18:19], v3 offset:3392
    s_waitcnt lgkmcnt(8)
    v_mfma_f32_16x16x32_bf16 v[60:63], v[40:43], v[192:195], v[60:63]
    ds_read_b64_tr_b16 v[20:21], v3 offset:2144
    v_mfma_f32_16x16x32_bf16 v[80:83], v[40:43], v[196:199], v[80:83]
    ds_read_b64_tr_b16 v[22:23], v3 offset:3424
    s_waitcnt lgkmcnt(8)
    v_mfma_f32_16x16x32_bf16 v[64:67], v[44:47], v[192:195], v[64:67]
    ds_read_b64_tr_b16 v[24:25], v3 offset:2176
    v_mfma_f32_16x16x32_bf16 v[84:87], v[44:47], v[196:199], v[84:87]
    ds_read_b64_tr_b16 v[26:27], v3 offset:3456
    s_barrier
    s_waitcnt vmcnt(8) lgkmcnt(8)
    v_mfma_f32_16x16x32_bf16 v[48:51], v[8:11], v[200:203], v[48:51]
    ds_read_b64_tr_b16 v[28:29], v3 offset:12288
    s_waitcnt vmcnt(6)
    v_mfma_f32_16x16x32_bf16 v[68:71], v[8:11], v[204:207], v[68:71]
    ds_read_b64_tr_b16 v[30:31], v3 offset:13568
    s_add_u32 s32, s31, 32768
    buffer_load_dwordx4 v[232:235], v5, s[12:15], s32 offen offset:0 sc1
    s_waitcnt lgkmcnt(8)
    v_mfma_f32_16x16x32_bf16 v[52:55], v[12:15], v[200:203], v[52:55]
    ds_read_b64_tr_b16 v[32:33], v3 offset:12320
    v_mfma_f32_16x16x32_bf16 v[72:75], v[12:15], v[204:207], v[72:75]
    ds_read_b64_tr_b16 v[34:35], v3 offset:13600
    buffer_load_dwordx4 v[236:239], v7, s[12:15], s32 offen offset:0 sc1
    s_waitcnt lgkmcnt(8)
    v_mfma_f32_16x16x32_bf16 v[56:59], v[16:19], v[200:203], v[56:59]
    ds_read_b64_tr_b16 v[36:37], v3 offset:12352
    v_mfma_f32_16x16x32_bf16 v[76:79], v[16:19], v[204:207], v[76:79]
    ds_read_b64_tr_b16 v[38:39], v3 offset:13632
    buffer_load_dwordx4 v[240:243], v5, s[12:15], s32 offen offset:2048 sc1
    s_waitcnt lgkmcnt(8)
    v_mfma_f32_16x16x32_bf16 v[60:63], v[20:23], v[200:203], v[60:63]
    ds_read_b64_tr_b16 v[40:41], v3 offset:12384
    v_mfma_f32_16x16x32_bf16 v[80:83], v[20:23], v[204:207], v[80:83]
    ds_read_b64_tr_b16 v[42:43], v3 offset:13664
    s_waitcnt lgkmcnt(8)
    v_mfma_f32_16x16x32_bf16 v[64:67], v[24:27], v[200:203], v[64:67]
    ds_read_b64_tr_b16 v[44:45], v3 offset:12416
    v_mfma_f32_16x16x32_bf16 v[84:87], v[24:27], v[204:207], v[84:87]
    ds_read_b64_tr_b16 v[46:47], v3 offset:13696
    s_waitcnt vmcnt(8) lgkmcnt(8)
    v_mfma_f32_16x16x32_bf16 v[48:51], v[28:31], v[208:211], v[48:51]
    ds_read_b64_tr_b16 v[8:9], v3 offset:22528
    s_waitcnt vmcnt(7)
    v_mfma_f32_16x16x32_bf16 v[68:71], v[28:31], v[212:215], v[68:71]
    ds_read_b64_tr_b16 v[10:11], v3 offset:23808
    buffer_load_dwordx4 v[244:247], v7, s[12:15], s32 offen offset:2048 sc1
    s_waitcnt lgkmcnt(8)
    v_mfma_f32_16x16x32_bf16 v[52:55], v[32:35], v[208:211], v[52:55]
    ds_read_b64_tr_b16 v[12:13], v3 offset:22560
    v_mfma_f32_16x16x32_bf16 v[72:75], v[32:35], v[212:215], v[72:75]
    ds_read_b64_tr_b16 v[14:15], v3 offset:23840
    s_add_u32 s32, s31, 36864
    buffer_load_dwordx4 v[248:251], v5, s[12:15], s32 offen offset:0 sc1
    s_waitcnt lgkmcnt(8)
    v_mfma_f32_16x16x32_bf16 v[56:59], v[36:39], v[208:211], v[56:59]
    ds_read_b64_tr_b16 v[16:17], v3 offset:22592
    v_mfma_f32_16x16x32_bf16 v[76:79], v[36:39], v[212:215], v[76:79]
    ds_read_b64_tr_b16 v[18:19], v3 offset:23872
    buffer_load_dwordx4 v[252:255], v7, s[12:15], s32 offen offset:0 sc1
    s_waitcnt lgkmcnt(8)
    v_mfma_f32_16x16x32_bf16 v[60:63], v[40:43], v[208:211], v[60:63]
    ds_read_b64_tr_b16 v[20:21], v3 offset:22624
    v_mfma_f32_16x16x32_bf16 v[80:83], v[40:43], v[212:215], v[80:83]
    ds_read_b64_tr_b16 v[22:23], v3 offset:23904
    s_waitcnt lgkmcnt(8)
    v_mfma_f32_16x16x32_bf16 v[64:67], v[44:47], v[208:211], v[64:67]
    ds_read_b64_tr_b16 v[24:25], v3 offset:22656
    v_mfma_f32_16x16x32_bf16 v[84:87], v[44:47], v[212:215], v[84:87]
    ds_read_b64_tr_b16 v[26:27], v3 offset:23936
    s_barrier
    s_waitcnt vmcnt(9) lgkmcnt(8)
    v_mfma_f32_16x16x32_bf16 v[48:51], v[8:11], v[216:219], v[48:51]
    ds_read_b64_tr_b16 v[28:29], v3 offset:32768
    s_waitcnt vmcnt(8)
    v_mfma_f32_16x16x32_bf16 v[68:71], v[8:11], v[220:223], v[68:71]
    ds_read_b64_tr_b16 v[30:31], v3 offset:34048
    buffer_load_dwordx4 v[104:107], v5, s[12:15], s32 offen offset:2048 sc1
    s_waitcnt lgkmcnt(8)
    v_mfma_f32_16x16x32_bf16 v[52:55], v[12:15], v[216:219], v[52:55]
    ds_read_b64_tr_b16 v[32:33], v3 offset:32800
    v_mfma_f32_16x16x32_bf16 v[72:75], v[12:15], v[220:223], v[72:75]
    ds_read_b64_tr_b16 v[34:35], v3 offset:34080
    buffer_load_dwordx4 v[108:111], v7, s[12:15], s32 offen offset:2048 sc1
    s_waitcnt lgkmcnt(8)
    v_mfma_f32_16x16x32_bf16 v[56:59], v[16:19], v[216:219], v[56:59]
    ds_read_b64_tr_b16 v[36:37], v3 offset:32832
    v_mfma_f32_16x16x32_bf16 v[76:79], v[16:19], v[220:223], v[76:79]
    ds_read_b64_tr_b16 v[38:39], v3 offset:34112
    s_add_u32 s32, s31, 40960
    buffer_load_dwordx4 v[112:115], v5, s[12:15], s32 offen offset:0 sc1
    s_waitcnt lgkmcnt(8)
    v_mfma_f32_16x16x32_bf16 v[60:63], v[20:23], v[216:219], v[60:63]
    ds_read_b64_tr_b16 v[40:41], v3 offset:32864
    v_mfma_f32_16x16x32_bf16 v[80:83], v[20:23], v[220:223], v[80:83]
    ds_read_b64_tr_b16 v[42:43], v3 offset:34144
    s_waitcnt lgkmcnt(8)
    v_mfma_f32_16x16x32_bf16 v[64:67], v[24:27], v[216:219], v[64:67]
    ds_read_b64_tr_b16 v[44:45], v3 offset:32896
    v_mfma_f32_16x16x32_bf16 v[84:87], v[24:27], v[220:223], v[84:87]
    ds_read_b64_tr_b16 v[46:47], v3 offset:34176
    s_waitcnt vmcnt(10) lgkmcnt(8)
    v_mfma_f32_16x16x32_bf16 v[48:51], v[28:31], v[224:227], v[48:51]
    ds_read_b64_tr_b16 v[8:9], v3 offset:43008
    s_waitcnt vmcnt(9)
    v_mfma_f32_16x16x32_bf16 v[68:71], v[28:31], v[228:231], v[68:71]
    ds_read_b64_tr_b16 v[10:11], v3 offset:44288
    buffer_load_dwordx4 v[116:119], v7, s[12:15], s32 offen offset:0 sc1
    s_waitcnt lgkmcnt(8)
    v_mfma_f32_16x16x32_bf16 v[52:55], v[32:35], v[224:227], v[52:55]
    ds_read_b64_tr_b16 v[12:13], v3 offset:43040
    v_mfma_f32_16x16x32_bf16 v[72:75], v[32:35], v[228:231], v[72:75]
    ds_read_b64_tr_b16 v[14:15], v3 offset:44320
    buffer_load_dwordx4 v[120:123], v5, s[12:15], s32 offen offset:2048 sc1
    s_waitcnt lgkmcnt(8)
    v_mfma_f32_16x16x32_bf16 v[56:59], v[36:39], v[224:227], v[56:59]
    ds_read_b64_tr_b16 v[16:17], v3 offset:43072
    v_mfma_f32_16x16x32_bf16 v[76:79], v[36:39], v[228:231], v[76:79]
    ds_read_b64_tr_b16 v[18:19], v3 offset:44352
    buffer_load_dwordx4 v[124:127], v7, s[12:15], s32 offen offset:2048 sc1
    s_waitcnt lgkmcnt(8)
    v_mfma_f32_16x16x32_bf16 v[60:63], v[40:43], v[224:227], v[60:63]
    ds_read_b64_tr_b16 v[20:21], v3 offset:43104
    v_mfma_f32_16x16x32_bf16 v[80:83], v[40:43], v[228:231], v[80:83]
    ds_read_b64_tr_b16 v[22:23], v3 offset:44384
    s_waitcnt lgkmcnt(8)
    v_mfma_f32_16x16x32_bf16 v[64:67], v[44:47], v[224:227], v[64:67]
    ds_read_b64_tr_b16 v[24:25], v3 offset:43136
    v_mfma_f32_16x16x32_bf16 v[84:87], v[44:47], v[228:231], v[84:87]
    ds_read_b64_tr_b16 v[26:27], v3 offset:44416
    s_barrier
    s_waitcnt vmcnt(11) lgkmcnt(8)
    v_mfma_f32_16x16x32_bf16 v[48:51], v[8:11], v[232:235], v[48:51]
    ds_read_b64_tr_b16 v[28:29], v3 offset:53248
    s_waitcnt vmcnt(10)
    v_mfma_f32_16x16x32_bf16 v[68:71], v[8:11], v[236:239], v[68:71]
    ds_read_b64_tr_b16 v[30:31], v3 offset:54528
    s_add_u32 s32, s31, 45056
    buffer_load_dwordx4 v[128:131], v5, s[12:15], s32 offen offset:0 sc1
    s_waitcnt lgkmcnt(8)
    v_mfma_f32_16x16x32_bf16 v[52:55], v[12:15], v[232:235], v[52:55]
    ds_read_b64_tr_b16 v[32:33], v3 offset:53280
    v_mfma_f32_16x16x32_bf16 v[72:75], v[12:15], v[236:239], v[72:75]
    ds_read_b64_tr_b16 v[34:35], v3 offset:54560
    buffer_load_dwordx4 v[132:135], v7, s[12:15], s32 offen offset:0 sc1
    s_waitcnt lgkmcnt(8)
    v_mfma_f32_16x16x32_bf16 v[56:59], v[16:19], v[232:235], v[56:59]
    ds_read_b64_tr_b16 v[36:37], v3 offset:53312
    v_mfma_f32_16x16x32_bf16 v[76:79], v[16:19], v[236:239], v[76:79]
    ds_read_b64_tr_b16 v[38:39], v3 offset:54592
    buffer_load_dwordx4 v[136:139], v5, s[12:15], s32 offen offset:2048 sc1
    s_waitcnt lgkmcnt(8)
    v_mfma_f32_16x16x32_bf16 v[60:63], v[20:23], v[232:235], v[60:63]
    ds_read_b64_tr_b16 v[40:41], v3 offset:53344
    v_mfma_f32_16x16x32_bf16 v[80:83], v[20:23], v[236:239], v[80:83]
    ds_read_b64_tr_b16 v[42:43], v3 offset:54624
    s_waitcnt lgkmcnt(8)
    v_mfma_f32_16x16x32_bf16 v[64:67], v[24:27], v[232:235], v[64:67]
    ds_read_b64_tr_b16 v[44:45], v3 offset:53376
    v_mfma_f32_16x16x32_bf16 v[84:87], v[24:27], v[236:239], v[84:87]
    ds_read_b64_tr_b16 v[46:47], v3 offset:54656
    s_waitcnt vmcnt(12) lgkmcnt(8)
    v_mfma_f32_16x16x32_bf16 v[48:51], v[28:31], v[240:243], v[48:51]
    ds_read_b64_tr_b16 v[8:9], v4 offset:2048
    s_waitcnt vmcnt(11)
    v_mfma_f32_16x16x32_bf16 v[68:71], v[28:31], v[244:247], v[68:71]
    ds_read_b64_tr_b16 v[10:11], v4 offset:3328
    buffer_load_dwordx4 v[140:143], v7, s[12:15], s32 offen offset:2048 sc1
    s_waitcnt lgkmcnt(8)
    v_mfma_f32_16x16x32_bf16 v[52:55], v[32:35], v[240:243], v[52:55]
    ds_read_b64_tr_b16 v[12:13], v4 offset:2080
    v_mfma_f32_16x16x32_bf16 v[72:75], v[32:35], v[244:247], v[72:75]
    ds_read_b64_tr_b16 v[14:15], v4 offset:3360
    s_waitcnt lgkmcnt(8)
    v_mfma_f32_16x16x32_bf16 v[56:59], v[36:39], v[240:243], v[56:59]
    ds_read_b64_tr_b16 v[16:17], v4 offset:2112
    v_mfma_f32_16x16x32_bf16 v[76:79], v[36:39], v[244:247], v[76:79]
    ds_read_b64_tr_b16 v[18:19], v4 offset:3392
    s_waitcnt lgkmcnt(8)
    v_mfma_f32_16x16x32_bf16 v[60:63], v[40:43], v[240:243], v[60:63]
    ds_read_b64_tr_b16 v[20:21], v4 offset:2144
    v_mfma_f32_16x16x32_bf16 v[80:83], v[40:43], v[244:247], v[80:83]
    ds_read_b64_tr_b16 v[22:23], v4 offset:3424
    s_waitcnt lgkmcnt(8)
    v_mfma_f32_16x16x32_bf16 v[64:67], v[44:47], v[240:243], v[64:67]
    ds_read_b64_tr_b16 v[24:25], v4 offset:2176
    v_mfma_f32_16x16x32_bf16 v[84:87], v[44:47], v[244:247], v[84:87]
    ds_read_b64_tr_b16 v[26:27], v4 offset:3456
    s_barrier
    s_waitcnt vmcnt(11) lgkmcnt(8)
    v_mfma_f32_16x16x32_bf16 v[48:51], v[8:11], v[248:251], v[48:51]
    ds_read_b64_tr_b16 v[28:29], v4 offset:12288
    s_waitcnt vmcnt(10)
    v_mfma_f32_16x16x32_bf16 v[68:71], v[8:11], v[252:255], v[68:71]
    ds_read_b64_tr_b16 v[30:31], v4 offset:13568
    s_waitcnt lgkmcnt(8)
    v_mfma_f32_16x16x32_bf16 v[52:55], v[12:15], v[248:251], v[52:55]
    ds_read_b64_tr_b16 v[32:33], v4 offset:12320
    v_mfma_f32_16x16x32_bf16 v[72:75], v[12:15], v[252:255], v[72:75]
    ds_read_b64_tr_b16 v[34:35], v4 offset:13600
    s_waitcnt lgkmcnt(8)
    v_mfma_f32_16x16x32_bf16 v[56:59], v[16:19], v[248:251], v[56:59]
    ds_read_b64_tr_b16 v[36:37], v4 offset:12352
    v_mfma_f32_16x16x32_bf16 v[76:79], v[16:19], v[252:255], v[76:79]
    ds_read_b64_tr_b16 v[38:39], v4 offset:13632
    s_waitcnt lgkmcnt(8)
    v_mfma_f32_16x16x32_bf16 v[60:63], v[20:23], v[248:251], v[60:63]
    ds_read_b64_tr_b16 v[40:41], v4 offset:12384
    v_mfma_f32_16x16x32_bf16 v[80:83], v[20:23], v[252:255], v[80:83]
    ds_read_b64_tr_b16 v[42:43], v4 offset:13664
    s_waitcnt lgkmcnt(8)
    v_mfma_f32_16x16x32_bf16 v[64:67], v[24:27], v[248:251], v[64:67]
    ds_read_b64_tr_b16 v[44:45], v4 offset:12416
    v_mfma_f32_16x16x32_bf16 v[84:87], v[24:27], v[252:255], v[84:87]
    ds_read_b64_tr_b16 v[46:47], v4 offset:13696
    s_waitcnt vmcnt(9) lgkmcnt(8)
    v_mfma_f32_16x16x32_bf16 v[48:51], v[28:31], v[104:107], v[48:51]
    ds_read_b64_tr_b16 v[8:9], v2 offset:2048
    s_waitcnt vmcnt(8)
    v_mfma_f32_16x16x32_bf16 v[68:71], v[28:31], v[108:111], v[68:71]
    ds_read_b64_tr_b16 v[10:11], v2 offset:3328
    s_waitcnt lgkmcnt(8)
    v_mfma_f32_16x16x32_bf16 v[52:55], v[32:35], v[104:107], v[52:55]
    ds_read_b64_tr_b16 v[12:13], v2 offset:2080
    v_mfma_f32_16x16x32_bf16 v[72:75], v[32:35], v[108:111], v[72:75]
    ds_read_b64_tr_b16 v[14:15], v2 offset:3360
    s_waitcnt lgkmcnt(8)
    v_mfma_f32_16x16x32_bf16 v[56:59], v[36:39], v[104:107], v[56:59]
    ds_read_b64_tr_b16 v[16:17], v2 offset:2112
    v_mfma_f32_16x16x32_bf16 v[76:79], v[36:39], v[108:111], v[76:79]
    ds_read_b64_tr_b16 v[18:19], v2 offset:3392
    s_waitcnt lgkmcnt(8)
    v_mfma_f32_16x16x32_bf16 v[60:63], v[40:43], v[104:107], v[60:63]
    ds_read_b64_tr_b16 v[20:21], v2 offset:2144
    v_mfma_f32_16x16x32_bf16 v[80:83], v[40:43], v[108:111], v[80:83]
    ds_read_b64_tr_b16 v[22:23], v2 offset:3424
    s_waitcnt lgkmcnt(8)
    v_mfma_f32_16x16x32_bf16 v[64:67], v[44:47], v[104:107], v[64:67]
    ds_read_b64_tr_b16 v[24:25], v2 offset:2176
    v_mfma_f32_16x16x32_bf16 v[84:87], v[44:47], v[108:111], v[84:87]
    ds_read_b64_tr_b16 v[26:27], v2 offset:3456
    s_barrier
    s_waitcnt vmcnt(7) lgkmcnt(8)
    v_mfma_f32_16x16x32_bf16 v[48:51], v[8:11], v[112:115], v[48:51]
    ds_read_b64_tr_b16 v[28:29], v2 offset:12288
    s_waitcnt vmcnt(6)
    v_mfma_f32_16x16x32_bf16 v[68:71], v[8:11], v[116:119], v[68:71]
    ds_read_b64_tr_b16 v[30:31], v2 offset:13568
    s_add_u32 s32, s31, 49152
    buffer_load_dwordx4 v[144:147], v5, s[12:15], s32 offen offset:0 sc1
    s_waitcnt lgkmcnt(8)
    v_mfma_f32_16x16x32_bf16 v[52:55], v[12:15], v[112:115], v[52:55]
    ds_read_b64_tr_b16 v[32:33], v2 offset:12320
    v_mfma_f32_16x16x32_bf16 v[72:75], v[12:15], v[116:119], v[72:75]
    ds_read_b64_tr_b16 v[34:35], v2 offset:13600
    buffer_load_dwordx4 v[148:151], v7, s[12:15], s32 offen offset:0 sc1
    s_waitcnt lgkmcnt(8)
    v_mfma_f32_16x16x32_bf16 v[56:59], v[16:19], v[112:115], v[56:59]
    ds_read_b64_tr_b16 v[36:37], v2 offset:12352
    v_mfma_f32_16x16x32_bf16 v[76:79], v[16:19], v[116:119], v[76:79]
    ds_read_b64_tr_b16 v[38:39], v2 offset:13632
    buffer_load_dwordx4 v[152:155], v5, s[12:15], s32 offen offset:2048 sc1
    s_waitcnt lgkmcnt(8)
    v_mfma_f32_16x16x32_bf16 v[60:63], v[20:23], v[112:115], v[60:63]
    ds_read_b64_tr_b16 v[40:41], v2 offset:12384
    v_mfma_f32_16x16x32_bf16 v[80:83], v[20:23], v[116:119], v[80:83]
    ds_read_b64_tr_b16 v[42:43], v2 offset:13664
    s_waitcnt lgkmcnt(8)
    v_mfma_f32_16x16x32_bf16 v[64:67], v[24:27], v[112:115], v[64:67]
    ds_read_b64_tr_b16 v[44:45], v2 offset:12416
    v_mfma_f32_16x16x32_bf16 v[84:87], v[24:27], v[116:119], v[84:87]
    ds_read_b64_tr_b16 v[46:47], v2 offset:13696
    s_waitcnt vmcnt(8) lgkmcnt(8)
    v_mfma_f32_16x16x32_bf16 v[48:51], v[28:31], v[120:123], v[48:51]
    ds_read_b64_tr_b16 v[8:9], v2 offset:22528
    s_waitcnt vmcnt(7)
    v_mfma_f32_16x16x32_bf16 v[68:71], v[28:31], v[124:127], v[68:71]
    ds_read_b64_tr_b16 v[10:11], v2 offset:23808
    buffer_load_dwordx4 v[156:159], v7, s[12:15], s32 offen offset:2048 sc1
    s_waitcnt lgkmcnt(8)
    v_mfma_f32_16x16x32_bf16 v[52:55], v[32:35], v[120:123], v[52:55]
    ds_read_b64_tr_b16 v[12:13], v2 offset:22560
    v_mfma_f32_16x16x32_bf16 v[72:75], v[32:35], v[124:127], v[72:75]
    ds_read_b64_tr_b16 v[14:15], v2 offset:23840
    s_add_u32 s32, s31, 53248
    buffer_load_dwordx4 v[160:163], v5, s[12:15], s32 offen offset:0 sc1
    s_waitcnt lgkmcnt(8)
    v_mfma_f32_16x16x32_bf16 v[56:59], v[36:39], v[120:123], v[56:59]
    ds_read_b64_tr_b16 v[16:17], v2 offset:22592
    v_mfma_f32_16x16x32_bf16 v[76:79], v[36:39], v[124:127], v[76:79]
    ds_read_b64_tr_b16 v[18:19], v2 offset:23872
    buffer_load_dwordx4 v[164:167], v7, s[12:15], s32 offen offset:0 sc1
    s_waitcnt lgkmcnt(8)
    v_mfma_f32_16x16x32_bf16 v[60:63], v[40:43], v[120:123], v[60:63]
    ds_read_b64_tr_b16 v[20:21], v2 offset:22624
    v_mfma_f32_16x16x32_bf16 v[80:83], v[40:43], v[124:127], v[80:83]
    ds_read_b64_tr_b16 v[22:23], v2 offset:23904
    s_waitcnt lgkmcnt(8)
    v_mfma_f32_16x16x32_bf16 v[64:67], v[44:47], v[120:123], v[64:67]
    ds_read_b64_tr_b16 v[24:25], v2 offset:22656
    v_mfma_f32_16x16x32_bf16 v[84:87], v[44:47], v[124:127], v[84:87]
    ds_read_b64_tr_b16 v[26:27], v2 offset:23936
    s_barrier
    s_waitcnt vmcnt(9) lgkmcnt(8)
    v_mfma_f32_16x16x32_bf16 v[48:51], v[8:11], v[128:131], v[48:51]
    ds_read_b64_tr_b16 v[28:29], v2 offset:32768
    s_waitcnt vmcnt(8)
    v_mfma_f32_16x16x32_bf16 v[68:71], v[8:11], v[132:135], v[68:71]
    ds_read_b64_tr_b16 v[30:31], v2 offset:34048
    buffer_load_dwordx2 v[88:89], v99, s[20:23], s34 offen offset:0 sc1
    s_waitcnt lgkmcnt(8)
    v_mfma_f32_16x16x32_bf16 v[52:55], v[12:15], v[128:131], v[52:55]
    ds_read_b64_tr_b16 v[32:33], v2 offset:32800
    v_mfma_f32_16x16x32_bf16 v[72:75], v[12:15], v[132:135], v[72:75]
    ds_read_b64_tr_b16 v[34:35], v2 offset:34080
    buffer_load_dwordx2 v[90:91], v99, s[20:23], s34 offen offset:1024 sc1
    s_waitcnt lgkmcnt(8)
    v_mfma_f32_16x16x32_bf16 v[56:59], v[16:19], v[128:131], v[56:59]
    ds_read_b64_tr_b16 v[36:37], v2 offset:32832
    v_mfma_f32_16x16x32_bf16 v[76:79], v[16:19], v[132:135], v[76:79]
    ds_read_b64_tr_b16 v[38:39], v2 offset:34112
    buffer_load_dwordx2 v[92:93], v99, s[20:23], s34 offen offset:2048 sc1
    s_waitcnt lgkmcnt(8)
    v_mfma_f32_16x16x32_bf16 v[60:63], v[20:23], v[128:131], v[60:63]
    ds_read_b64_tr_b16 v[40:41], v2 offset:32864
    v_mfma_f32_16x16x32_bf16 v[80:83], v[20:23], v[132:135], v[80:83]
    ds_read_b64_tr_b16 v[42:43], v2 offset:34144
    s_waitcnt lgkmcnt(8)
    v_mfma_f32_16x16x32_bf16 v[64:67], v[24:27], v[128:131], v[64:67]
    ds_read_b64_tr_b16 v[44:45], v2 offset:32896
    v_mfma_f32_16x16x32_bf16 v[84:87], v[24:27], v[132:135], v[84:87]
    ds_read_b64_tr_b16 v[46:47], v2 offset:34176
    s_waitcnt vmcnt(10) lgkmcnt(8)
    v_mfma_f32_16x16x32_bf16 v[48:51], v[28:31], v[136:139], v[48:51]
    ds_read_b64_tr_b16 v[8:9], v2 offset:43008
    s_waitcnt vmcnt(9)
    v_mfma_f32_16x16x32_bf16 v[68:71], v[28:31], v[140:143], v[68:71]
    ds_read_b64_tr_b16 v[10:11], v2 offset:44288
    buffer_load_dwordx2 v[94:95], v99, s[20:23], s34 offen offset:3072 sc1
    s_waitcnt lgkmcnt(8)
    v_mfma_f32_16x16x32_bf16 v[52:55], v[32:35], v[136:139], v[52:55]
    ds_read_b64_tr_b16 v[12:13], v2 offset:43040
    v_mfma_f32_16x16x32_bf16 v[72:75], v[32:35], v[140:143], v[72:75]
    ds_read_b64_tr_b16 v[14:15], v2 offset:44320
    buffer_load_dwordx2 v[96:97], v99, s[20:23], s35 offen offset:0 sc1
    s_waitcnt lgkmcnt(8)
    v_mfma_f32_16x16x32_bf16 v[56:59], v[36:39], v[136:139], v[56:59]
    ds_read_b64_tr_b16 v[16:17], v2 offset:43072
    v_mfma_f32_16x16x32_bf16 v[76:79], v[36:39], v[140:143], v[76:79]
    ds_read_b64_tr_b16 v[18:19], v2 offset:44352
    s_waitcnt lgkmcnt(8)
    v_mfma_f32_16x16x32_bf16 v[60:63], v[40:43], v[136:139], v[60:63]
    ds_read_b64_tr_b16 v[20:21], v2 offset:43104
    v_mfma_f32_16x16x32_bf16 v[80:83], v[40:43], v[140:143], v[80:83]
    ds_read_b64_tr_b16 v[22:23], v2 offset:44384
    s_waitcnt lgkmcnt(8)
    v_mfma_f32_16x16x32_bf16 v[64:67], v[44:47], v[136:139], v[64:67]
    ds_read_b64_tr_b16 v[24:25], v2 offset:43136
    v_mfma_f32_16x16x32_bf16 v[84:87], v[44:47], v[140:143], v[84:87]
    ds_read_b64_tr_b16 v[26:27], v2 offset:44416
    s_barrier
    s_waitcnt vmcnt(10) lgkmcnt(8)
    v_mfma_f32_16x16x32_bf16 v[48:51], v[8:11], v[144:147], v[48:51]
    ds_read_b64_tr_b16 v[28:29], v2 offset:53248
    s_waitcnt vmcnt(9)
    v_mfma_f32_16x16x32_bf16 v[68:71], v[8:11], v[148:151], v[68:71]
    ds_read_b64_tr_b16 v[30:31], v2 offset:54528
    s_waitcnt lgkmcnt(8)
    v_mfma_f32_16x16x32_bf16 v[52:55], v[12:15], v[144:147], v[52:55]
    ds_read_b64_tr_b16 v[32:33], v2 offset:53280
    v_mfma_f32_16x16x32_bf16 v[72:75], v[12:15], v[148:151], v[72:75]
    ds_read_b64_tr_b16 v[34:35], v2 offset:54560
    s_waitcnt lgkmcnt(8)
    v_mfma_f32_16x16x32_bf16 v[56:59], v[16:19], v[144:147], v[56:59]
    ds_read_b64_tr_b16 v[36:37], v2 offset:53312
    v_mfma_f32_16x16x32_bf16 v[76:79], v[16:19], v[148:151], v[76:79]
    ds_read_b64_tr_b16 v[38:39], v2 offset:54592
    s_waitcnt lgkmcnt(8)
    v_mfma_f32_16x16x32_bf16 v[60:63], v[20:23], v[144:147], v[60:63]
    ds_read_b64_tr_b16 v[40:41], v2 offset:53344
    v_mfma_f32_16x16x32_bf16 v[80:83], v[20:23], v[148:151], v[80:83]
    ds_read_b64_tr_b16 v[42:43], v2 offset:54624
    s_waitcnt lgkmcnt(8)
    v_mfma_f32_16x16x32_bf16 v[64:67], v[24:27], v[144:147], v[64:67]
    ds_read_b64_tr_b16 v[44:45], v2 offset:53376
    v_mfma_f32_16x16x32_bf16 v[84:87], v[24:27], v[148:151], v[84:87]
    ds_read_b64_tr_b16 v[46:47], v2 offset:54656
    s_waitcnt vmcnt(8) lgkmcnt(8)
    v_mfma_f32_16x16x32_bf16 v[48:51], v[28:31], v[152:155], v[48:51]
    ds_read_b64_tr_b16 v[8:9], v3 offset:2048
    s_waitcnt vmcnt(7)
    v_mfma_f32_16x16x32_bf16 v[68:71], v[28:31], v[156:159], v[68:71]
    ds_read_b64_tr_b16 v[10:11], v3 offset:3328
    s_waitcnt lgkmcnt(8)
    v_mfma_f32_16x16x32_bf16 v[52:55], v[32:35], v[152:155], v[52:55]
    ds_read_b64_tr_b16 v[12:13], v3 offset:2080
    v_mfma_f32_16x16x32_bf16 v[72:75], v[32:35], v[156:159], v[72:75]
    ds_read_b64_tr_b16 v[14:15], v3 offset:3360
    s_waitcnt lgkmcnt(8)
    v_mfma_f32_16x16x32_bf16 v[56:59], v[36:39], v[152:155], v[56:59]
    ds_read_b64_tr_b16 v[16:17], v3 offset:2112
    v_mfma_f32_16x16x32_bf16 v[76:79], v[36:39], v[156:159], v[76:79]
    ds_read_b64_tr_b16 v[18:19], v3 offset:3392
    s_waitcnt lgkmcnt(8)
    v_mfma_f32_16x16x32_bf16 v[60:63], v[40:43], v[152:155], v[60:63]
    ds_read_b64_tr_b16 v[20:21], v3 offset:2144
    v_mfma_f32_16x16x32_bf16 v[80:83], v[40:43], v[156:159], v[80:83]
    ds_read_b64_tr_b16 v[22:23], v3 offset:3424
    s_waitcnt lgkmcnt(8)
    v_mfma_f32_16x16x32_bf16 v[64:67], v[44:47], v[152:155], v[64:67]
    ds_read_b64_tr_b16 v[24:25], v3 offset:2176
    v_mfma_f32_16x16x32_bf16 v[84:87], v[44:47], v[156:159], v[84:87]
    ds_read_b64_tr_b16 v[26:27], v3 offset:3456
    s_waitcnt vmcnt(6) lgkmcnt(8)
    v_mfma_f32_16x16x32_bf16 v[48:51], v[8:11], v[160:163], v[48:51]
    s_waitcnt vmcnt(5)
    v_mfma_f32_16x16x32_bf16 v[68:71], v[8:11], v[164:167], v[68:71]
    s_waitcnt lgkmcnt(6)
    v_mfma_f32_16x16x32_bf16 v[52:55], v[12:15], v[160:163], v[52:55]
    v_mfma_f32_16x16x32_bf16 v[72:75], v[12:15], v[164:167], v[72:75]
    s_waitcnt lgkmcnt(4)
    v_mfma_f32_16x16x32_bf16 v[56:59], v[16:19], v[160:163], v[56:59]
    v_mfma_f32_16x16x32_bf16 v[76:79], v[16:19], v[164:167], v[76:79]
    s_waitcnt lgkmcnt(2)
    v_mfma_f32_16x16x32_bf16 v[60:63], v[20:23], v[160:163], v[60:63]
    v_mfma_f32_16x16x32_bf16 v[80:83], v[20:23], v[164:167], v[80:83]
    s_waitcnt lgkmcnt(0)
    v_mfma_f32_16x16x32_bf16 v[64:67], v[24:27], v[160:163], v[64:67]
    v_mfma_f32_16x16x32_bf16 v[84:87], v[24:27], v[164:167], v[84:87]
    ds_write_b128 v100, v[68:71] offset:0
    ds_write_b128 v100, v[72:75] offset:1024
    ds_write_b128 v100, v[76:79] offset:2048
    s_nop 1
    ds_write_b128 v100, v[80:83] offset:3072
    s_nop 1
    ds_write_b128 v100, v[84:87] offset:4096
    s_waitcnt lgkmcnt(0)
    s_barrier
    ds_read_b128 v[68:71], v101 offset:0
    ds_read_b128 v[72:75], v101 offset:1024
    ds_read_b128 v[76:79], v101 offset:2048
    ds_read_b128 v[80:83], v101 offset:3072
    ds_read_b128 v[84:87], v101 offset:4096
    s_waitcnt vmcnt(0)
    v_lshlrev_b32 v12, 16, v88
    v_and_b32 v13, s39, v88
    v_lshlrev_b32 v14, 16, v89
    v_and_b32 v15, s39, v89
    s_waitcnt lgkmcnt(4)
    v_pk_add_f32 v[48:49], v[48:49], v[68:69]
    v_pk_add_f32 v[50:51], v[50:51], v[70:71]
    v_pk_add_f32 v[48:49], v[48:49], v[12:13]
    v_pk_add_f32 v[50:51], v[50:51], v[14:15]
    v_cvt_pk_bf16_f32 v88, v48, v49
    v_cvt_pk_bf16_f32 v89, v50, v51
    buffer_store_dwordx2 v[88:89], v98, s[16:19], s33 offen offset:0
    v_lshlrev_b32 v16, 16, v90
    v_and_b32 v17, s39, v90
    v_lshlrev_b32 v18, 16, v91
    v_and_b32 v19, s39, v91
    s_waitcnt lgkmcnt(3)
    v_pk_add_f32 v[52:53], v[52:53], v[72:73]
    v_pk_add_f32 v[54:55], v[54:55], v[74:75]
    v_pk_add_f32 v[52:53], v[52:53], v[16:17]
    v_pk_add_f32 v[54:55], v[54:55], v[18:19]
    v_cvt_pk_bf16_f32 v90, v52, v53
    v_cvt_pk_bf16_f32 v91, v54, v55
    buffer_store_dwordx2 v[90:91], v98, s[16:19], s33 offen offset:32
    v_lshlrev_b32 v12, 16, v92
    v_and_b32 v13, s39, v92
    v_lshlrev_b32 v14, 16, v93
    v_and_b32 v15, s39, v93
    s_waitcnt lgkmcnt(2)
    v_pk_add_f32 v[56:57], v[56:57], v[76:77]
    v_pk_add_f32 v[58:59], v[58:59], v[78:79]
    v_pk_add_f32 v[56:57], v[56:57], v[12:13]
    v_pk_add_f32 v[58:59], v[58:59], v[14:15]
    v_cvt_pk_bf16_f32 v92, v56, v57
    v_cvt_pk_bf16_f32 v93, v58, v59
    buffer_store_dwordx2 v[92:93], v98, s[16:19], s33 offen offset:64
    v_lshlrev_b32 v16, 16, v94
    v_and_b32 v17, s39, v94
    v_lshlrev_b32 v18, 16, v95
    v_and_b32 v19, s39, v95
    s_waitcnt lgkmcnt(1)
    v_pk_add_f32 v[60:61], v[60:61], v[80:81]
    v_pk_add_f32 v[62:63], v[62:63], v[82:83]
    v_pk_add_f32 v[60:61], v[60:61], v[16:17]
    v_pk_add_f32 v[62:63], v[62:63], v[18:19]
    v_cvt_pk_bf16_f32 v94, v60, v61
    v_cvt_pk_bf16_f32 v95, v62, v63
    buffer_store_dwordx2 v[94:95], v98, s[16:19], s33 offen offset:96
    v_lshlrev_b32 v12, 16, v96
    v_and_b32 v13, s39, v96
    v_lshlrev_b32 v14, 16, v97
    v_and_b32 v15, s39, v97
    s_waitcnt lgkmcnt(0)
    v_pk_add_f32 v[64:65], v[64:65], v[84:85]
    v_pk_add_f32 v[66:67], v[66:67], v[86:87]
    v_pk_add_f32 v[64:65], v[64:65], v[12:13]
    v_pk_add_f32 v[66:67], v[66:67], v[14:15]
    v_cvt_pk_bf16_f32 v96, v64, v65
    v_cvt_pk_bf16_f32 v97, v66, v67
    buffer_store_dwordx2 v[96:97], v98, s[16:19], s33 offen offset:128
    s_endpgm
k_ffn_kernel_helper:
    s_sub_u32 s3, s3, 4
    v_lshlrev_b32 v2, 4, v0
    s_mul_i32 s30, s29, 102400
    s_mul_i32 s31, s3, 5120
    s_add_u32 s30, s30, s31
    s_waitcnt lgkmcnt(0)
    s_add_u32 s12, s8, 0x181c000
    s_addc_u32 s13, s9, 0
    s_mov_b32 s14, 0xc8000
    s_mov_b32 s15, 0x00020000
    s_add_u32 s32, s30, 0
    s_add_u32 m0, s31, 2048
    s_nop 0
    buffer_load_dwordx4 v2, s[12:15], s32 offen offset:0 lds
    buffer_load_dwordx4 v2, s[12:15], s32 offen offset:1024 lds
    buffer_load_dwordx4 v2, s[12:15], s32 offen offset:2048 lds
    buffer_load_dwordx4 v2, s[12:15], s32 offen offset:3072 lds
    s_add_u32 s32, s32, 4096
    s_add_u32 m0, m0, 4096
    s_nop 0
    buffer_load_dwordx4 v2, s[12:15], s32 offen offset:0 lds
    s_add_u32 s32, s30, 20480
    s_add_u32 m0, s31, 22528
    s_nop 0
    buffer_load_dwordx4 v2, s[12:15], s32 offen offset:0 lds
    buffer_load_dwordx4 v2, s[12:15], s32 offen offset:1024 lds
    buffer_load_dwordx4 v2, s[12:15], s32 offen offset:2048 lds
    buffer_load_dwordx4 v2, s[12:15], s32 offen offset:3072 lds
    s_add_u32 s32, s32, 4096
    s_add_u32 m0, m0, 4096
    s_nop 0
    buffer_load_dwordx4 v2, s[12:15], s32 offen offset:0 lds
    s_lshr_b32 s35, s3, 1
    s_and_b32 s36, s3, 1
    s_lshr_b32 s37, s41, 3
    s_mul_i32 s37, s37, 28
    s_mul_i32 s33, s35, 56
    s_add_u32 s37, s37, s33
    s_and_b32 s33, s41, 7
    s_add_u32 s48, s37, s33
    s_mul_i32 s48, s48, 40960
    s_lshr_b32 s33, s33, 1
    s_add_u32 s53, s37, s33
    s_add_u32 s53, s53, 24
    s_mul_i32 s53, s53, 40960
    s_lshl_b32 s33, s36, 12
    s_add_u32 s48, s48, s33
    s_add_u32 s55, s53, s33
    s_add_u32 s53, s55, s33
    s_mul_i32 s54, s35, 8320
    s_add_u32 s49, s54, s33
    s_lshr_b32 s33, s33, 1
    s_add_u32 s54, s54, s33
    v_and_b32 v10, 31, v0
    v_lshlrev_b32 v10, 4, v10
    v_lshrrev_b32 v1, 5, v0
    v_lshl_add_u32 v10, v1, 10, v10
    s_and_b32 s33, s41, 1
    s_lshl_b32 s33, s33, 9
    v_add_u32 v10, s33, v10
    s_add_u32 s16, s8, 0x18e4000
    s_addc_u32 s17, s9, 0
    s_mov_b32 s18, 0x460000
    s_mov_b32 s19, 0x00020000
    s_mul_i32 s50, s29, 276480
    s_add_u32 s50, s50, s31
    s_add_u32 s20, s8, 0x1600000
    s_addc_u32 s21, s9, 0
    s_mov_b32 s22, 0x21c000
    s_mov_b32 s23, 0x00020000
    s_add_u32 s24, s8, 0x1540000
    s_addc_u32 s25, s9, 0
    s_mov_b32 s26, 0x38000
    s_mov_b32 s27, 0x00020000
    s_mul_i32 s34, s35, 7168
    s_mul_i32 s36, s36, 56
    v_add_u32 v1, s36, v0
    v_lshrrev_b32 v3, 5, v1
    v_lshlrev_b32 v3, 9, v3
    v_and_b32 v4, 31, v1
    v_add_u32 v4, v4, v3
    s_lshl_b32 s33, s41, 5
    v_add_u32 v4, s33, v4
    s_lshl_b32 s33, s41, 4
    s_add_u32 s33, s33, 1440
    v_add_u32 v3, s33, v1
    v_cmp_gt_u32 vcc, 96, v1
    s_nop 1
    v_cndmask_b32 v4, v3, v4, vcc
    v_lshlrev_b32 v4, 2, v4
    v_lshrrev_b32 v3, 4, v1
    v_and_b32 v1, 15, v1
    v_lshlrev_b32 v3, 8, v3
    v_lshl_add_u32 v3, v1, 3, v3
    s_lshl_b32 s33, s35, 7
    v_add_u32 v3, s33, v3
    s_add_u32 s44, s8, 0x1580000
    s_addc_u32 s45, s9, 0
    s_mov_b32 s46, 0x18000
    s_mov_b32 s47, 0x00020000
    v_and_b32 v8, 15, v0
    v_lshlrev_b32 v8, 2, v8
    v_lshlrev_b32 v5, 7, v0
    v_lshlrev_b32 v6, 8, v0
    v_mov_b32 v7, 1
    s_lshl_b32 s33, s3, 2
    s_lshl_b64 s[56:57], 15, s33
    s_lshl_b32 s51, s40, 4
    s_add_u32 s51, s51, s41
    s_lshl_b32 s51, s51, 7
    s_lshl_b32 s52, s28, 3
    s_add_u32 s52, s52, s29
    s_lshl_b32 s52, s52, 8
    s_add_u32 s52, s52, 32768
    s_lshr_b32 s58, s28, 1
    s_lshl_b32 s58, s58, 11
    s_and_b32 s33, s28, 1
    s_lshl_b32 s33, s33, 3
    s_add_u32 s33, s33, s29
    s_lshl_b32 s33, s33, 2
    s_add_u32 s58, s58, s33
    s_lshl_b32 s59, s40, 10
    s_add_u32 s59, s59, s41
    s_lshl_b32 s59, s59, 2
    s_add_u32 s59, s59, 32768
    s_waitcnt vmcnt(5)
    s_barrier
    s_add_u32 s32, s30, 40960
    s_add_u32 m0, s31, 43008
    s_nop 0
    buffer_load_dwordx4 v2, s[12:15], s32 offen offset:0 lds
    buffer_load_dwordx4 v2, s[12:15], s32 offen offset:1024 lds
    buffer_load_dwordx4 v2, s[12:15], s32 offen offset:2048 lds
    buffer_load_dwordx4 v2, s[12:15], s32 offen offset:3072 lds
    s_add_u32 s32, s32, 4096
    s_add_u32 m0, m0, 4096
    s_nop 0
    buffer_load_dwordx4 v2, s[12:15], s32 offen offset:0 lds
    s_waitcnt vmcnt(5)
    s_barrier
    s_add_u32 s32, s30, 61440
    s_add_u32 m0, s31, 63488
    s_nop 0
    buffer_load_dwordx4 v2, s[12:15], s32 offen offset:0 lds
    buffer_load_dwordx4 v2, s[12:15], s32 offen offset:1024 lds
    buffer_load_dwordx4 v2, s[12:15], s32 offen offset:2048 lds
    buffer_load_dwordx4 v2, s[12:15], s32 offen offset:3072 lds
    s_add_u32 s32, s32, 4096
    s_add_u32 m0, m0, 4096
    s_nop 0
    buffer_load_dwordx4 v2, s[12:15], s32 offen offset:0 lds
    s_waitcnt vmcnt(5)
    s_barrier
    s_add_u32 s32, s30, 81920
    s_add_u32 m0, s31, 83968
    s_nop 0
    buffer_load_dwordx4 v2, s[12:15], s32 offen offset:0 lds
    buffer_load_dwordx4 v2, s[12:15], s32 offen offset:1024 lds
    buffer_load_dwordx4 v2, s[12:15], s32 offen offset:2048 lds
    buffer_load_dwordx4 v2, s[12:15], s32 offen offset:3072 lds
    s_add_u32 s32, s32, 4096
    s_add_u32 m0, m0, 4096
    s_nop 0
    buffer_load_dwordx4 v2, s[12:15], s32 offen offset:0 lds
    s_waitcnt vmcnt(5)
    s_barrier
    buffer_load_dword v16, v4, s[24:27], s34 offen
    s_add_u32 s34, s34, 14336
    buffer_load_dword v17, v4, s[24:27], s34 offen
    s_add_u32 s34, s34, 14336
    buffer_load_dword v18, v4, s[24:27], s34 offen
    s_add_u32 s34, s34, 14336
    buffer_load_dword v19, v4, s[24:27], s34 offen
    s_add_u32 s34, s34, 14336
    buffer_load_dword v20, v4, s[24:27], s34 offen
    s_add_u32 s34, s34, 14336
    buffer_load_dword v21, v4, s[24:27], s34 offen
    s_add_u32 s34, s34, 14336
    buffer_load_dword v22, v4, s[24:27], s34 offen
    s_add_u32 s34, s34, 14336
    buffer_load_dword v23, v4, s[24:27], s34 offen
    s_add_u32 s34, s34, 14336
    buffer_load_dword v24, v4, s[24:27], s34 offen
    s_add_u32 s34, s34, 14336
    buffer_load_dword v25, v4, s[24:27], s34 offen
    s_add_u32 s34, s34, 14336
    buffer_load_dword v26, v4, s[24:27], s34 offen
    s_add_u32 s34, s34, 14336
    buffer_load_dword v27, v4, s[24:27], s34 offen
    s_add_u32 s34, s34, 14336
    buffer_load_dword v28, v4, s[24:27], s34 offen
    s_add_u32 s34, s34, 14336
    buffer_load_dword v29, v4, s[24:27], s34 offen
    s_add_u32 s34, s34, 14336
    buffer_load_dword v30, v4, s[24:27], s34 offen
    s_add_u32 s34, s34, 14336
    buffer_load_dword v31, v4, s[24:27], s34 offen
    s_waitcnt vmcnt(16)
    s_barrier
    s_add_u32 s32, s48, 0
    s_add_u32 m0, s49, 104448
    s_nop 0
    buffer_load_dwordx4 v2, s[16:19], s32 offen offset:0 lds
    buffer_load_dwordx4 v2, s[16:19], s32 offen offset:1024 lds
    buffer_load_dwordx4 v2, s[16:19], s32 offen offset:2048 lds
    buffer_load_dwordx4 v2, s[16:19], s32 offen offset:3072 lds
    s_barrier
    s_add_u32 s32, s48, 8192
    s_add_u32 m0, s49, 120960
    s_nop 0
    buffer_load_dwordx4 v2, s[16:19], s32 offen offset:0 lds
    buffer_load_dwordx4 v2, s[16:19], s32 offen offset:1024 lds
    buffer_load_dwordx4 v2, s[16:19], s32 offen offset:2048 lds
    buffer_load_dwordx4 v2, s[16:19], s32 offen offset:3072 lds
    s_add_u32 s32, s48, 16384
    s_add_u32 m0, s49, 137472
    s_nop 0
    buffer_load_dwordx4 v2, s[16:19], s32 offen offset:0 lds
    buffer_load_dwordx4 v2, s[16:19], s32 offen offset:1024 lds
    buffer_load_dwordx4 v2, s[16:19], s32 offen offset:2048 lds
    buffer_load_dwordx4 v2, s[16:19], s32 offen offset:3072 lds
    s_add_u32 s32, s48, 24576
    s_add_u32 m0, s49, 2048
    s_nop 0
    buffer_load_dwordx4 v2, s[16:19], s32 offen offset:0 lds
    buffer_load_dwordx4 v2, s[16:19], s32 offen offset:1024 lds
    buffer_load_dwordx4 v2, s[16:19], s32 offen offset:2048 lds
    buffer_load_dwordx4 v2, s[16:19], s32 offen offset:3072 lds
    s_waitcnt vmcnt(16)
    v_add_f32 v16, v16, v24
    v_add_f32 v17, v17, v25
    v_add_f32 v18, v18, v26
    v_add_f32 v19, v19, v27
    v_add_f32 v20, v20, v28
    v_add_f32 v21, v21, v29
    v_add_f32 v22, v22, v30
    v_add_f32 v23, v23, v31
    v_add_f32 v16, v16, v20
    v_add_f32 v17, v17, v21
    v_add_f32 v18, v18, v22
    v_add_f32 v19, v19, v23
    v_add_f32 v16, v16, v18
    v_add_f32 v17, v17, v19
    v_add_f32 v16, v16, v17
    v_cvt_pk_bf16_f32 v17, v16, v16
    v_lshlrev_b32 v17, 16, v17
    v_sub_f32 v17, v16, v17
    v_cvt_pk_bf16_f32 v18, v16, v17
    v_and_b32 v19, 0xffff0000, v18
    v_sub_f32 v17, v17, v19
    v_mov_b32 v19, 0
    v_cvt_pk_bf16_f32 v19, v17, v19
    s_mov_b32 exec_hi, 0xffffff
    ds_write_b64 v3, v[18:19]
    s_mov_b32 exec_hi, -1
    s_waitcnt lgkmcnt(0)
    s_barrier
    s_barrier
    s_mov_b64 exec, s[56:57]
    buffer_store_dword v7, v5, s[44:47], s58 offen offset:0 sc1
    s_mov_b64 exec, -1
    s_add_u32 s32, s48, 32768
    s_add_u32 m0, s49, 18560
    s_nop 0
    buffer_load_dwordx4 v2, s[16:19], s32 offen offset:0 lds
    buffer_load_dwordx4 v2, s[16:19], s32 offen offset:1024 lds
    buffer_load_dwordx4 v2, s[16:19], s32 offen offset:2048 lds
    buffer_load_dwordx4 v2, s[16:19], s32 offen offset:3072 lds
    s_add_u32 s32, s48, 327680
    s_add_u32 m0, s49, 35072
    s_nop 0
    buffer_load_dwordx4 v2, s[16:19], s32 offen offset:0 lds
    buffer_load_dwordx4 v2, s[16:19], s32 offen offset:1024 lds
    buffer_load_dwordx4 v2, s[16:19], s32 offen offset:2048 lds
    buffer_load_dwordx4 v2, s[16:19], s32 offen offset:3072 lds
    s_add_u32 s32, s48, 335872
    s_add_u32 m0, s49, 51584
    s_nop 0
    buffer_load_dwordx4 v2, s[16:19], s32 offen offset:0 lds
    buffer_load_dwordx4 v2, s[16:19], s32 offen offset:1024 lds
    buffer_load_dwordx4 v2, s[16:19], s32 offen offset:2048 lds
    buffer_load_dwordx4 v2, s[16:19], s32 offen offset:3072 lds
    s_waitcnt vmcnt(21)
    s_cmp_lg_u32 s3, 0
    s_cbranch_scc1 k_ffn_kernel_pd_2
    s_mov_b32 s43, 0x100000
k_ffn_kernel_pl_1:
    buffer_load_dword v9, v8, s[44:47], s51 offen offset:0 sc1
    s_waitcnt vmcnt(0)
    v_cmp_eq_u32 vcc, 1, v9
    s_cmp_eq_u64 vcc, -1
    s_cbranch_scc1 k_ffn_kernel_pd_2
    s_sleep 1
    s_sub_u32 s43, s43, 1
    s_cmp_lg_u32 s43, 0
    s_cbranch_scc1 k_ffn_kernel_pl_1
k_ffn_kernel_pd_2:
    s_barrier
    s_waitcnt vmcnt(17)
    s_barrier
    s_waitcnt vmcnt(13)
    s_barrier
    s_waitcnt vmcnt(8)
    s_barrier
    s_add_u32 s32, s48, 344064
    s_add_u32 m0, s49, 68096
    s_nop 0
    buffer_load_dwordx4 v2, s[16:19], s32 offen offset:0 lds
    buffer_load_dwordx4 v2, s[16:19], s32 offen offset:1024 lds
    buffer_load_dwordx4 v2, s[16:19], s32 offen offset:2048 lds
    buffer_load_dwordx4 v2, s[16:19], s32 offen offset:3072 lds
    s_waitcnt vmcnt(8)
    s_barrier
    s_add_u32 s32, s48, 352256
    s_add_u32 m0, s49, 84608
    s_nop 0
    buffer_load_dwordx4 v2, s[16:19], s32 offen offset:0 lds
    buffer_load_dwordx4 v2, s[16:19], s32 offen offset:1024 lds
    buffer_load_dwordx4 v2, s[16:19], s32 offen offset:2048 lds
    buffer_load_dwordx4 v2, s[16:19], s32 offen offset:3072 lds
    s_waitcnt vmcnt(8)
    s_barrier
    s_add_u32 s32, s48, 360448
    s_add_u32 m0, s49, 101120
    s_nop 0
    buffer_load_dwordx4 v2, s[16:19], s32 offen offset:0 lds
    buffer_load_dwordx4 v2, s[16:19], s32 offen offset:1024 lds
    buffer_load_dwordx4 v2, s[16:19], s32 offen offset:2048 lds
    buffer_load_dwordx4 v2, s[16:19], s32 offen offset:3072 lds
    s_add_u32 s32, s48, 655360
    s_add_u32 m0, s49, 117632
    s_nop 0
    buffer_load_dwordx4 v2, s[16:19], s32 offen offset:0 lds
    buffer_load_dwordx4 v2, s[16:19], s32 offen offset:1024 lds
    buffer_load_dwordx4 v2, s[16:19], s32 offen offset:2048 lds
    buffer_load_dwordx4 v2, s[16:19], s32 offen offset:3072 lds
    s_waitcnt vmcnt(12)
    s_barrier
    s_add_u32 s32, s48, 663552
    s_add_u32 m0, s49, 134144
    s_nop 0
    buffer_load_dwordx4 v2, s[16:19], s32 offen offset:0 lds
    buffer_load_dwordx4 v2, s[16:19], s32 offen offset:1024 lds
    buffer_load_dwordx4 v2, s[16:19], s32 offen offset:2048 lds
    buffer_load_dwordx4 v2, s[16:19], s32 offen offset:3072 lds
    s_add_u32 s32, s48, 671744
    s_add_u32 m0, s49, 2048
    s_nop 0
    buffer_load_dwordx4 v2, s[16:19], s32 offen offset:0 lds
    buffer_load_dwordx4 v2, s[16:19], s32 offen offset:1024 lds
    buffer_load_dwordx4 v2, s[16:19], s32 offen offset:2048 lds
    buffer_load_dwordx4 v2, s[16:19], s32 offen offset:3072 lds
    s_waitcnt vmcnt(16)
    s_barrier
    s_add_u32 s32, s48, 679936
    s_add_u32 m0, s49, 18560
    s_nop 0
    buffer_load_dwordx4 v2, s[16:19], s32 offen offset:0 lds
    buffer_load_dwordx4 v2, s[16:19], s32 offen offset:1024 lds
    buffer_load_dwordx4 v2, s[16:19], s32 offen offset:2048 lds
    buffer_load_dwordx4 v2, s[16:19], s32 offen offset:3072 lds
    s_add_u32 s32, s48, 688128
    s_add_u32 m0, s49, 35072
    s_nop 0
    buffer_load_dwordx4 v2, s[16:19], s32 offen offset:0 lds
    buffer_load_dwordx4 v2, s[16:19], s32 offen offset:1024 lds
    buffer_load_dwordx4 v2, s[16:19], s32 offen offset:2048 lds
    buffer_load_dwordx4 v2, s[16:19], s32 offen offset:3072 lds
    s_waitcnt vmcnt(20)
    s_barrier
    s_mov_b64 exec, s[56:57]
    buffer_store_dword v7, v6, s[44:47], s59 offen offset:0 sc1
    s_mov_b64 exec, -1
    s_add_u32 s32, s53, 0
    s_add_u32 m0, s49, 51584
    s_nop 0
    buffer_load_dwordx4 v10, s[16:19], s32 offen offset:0 lds
    s_add_u32 s32, s32, 1024
    buffer_load_dwordx4 v10, s[16:19], s32 offen offset:1024 lds
    s_add_u32 s32, s32, 1024
    buffer_load_dwordx4 v10, s[16:19], s32 offen offset:2048 lds
    s_add_u32 s32, s32, 1024
    buffer_load_dwordx4 v10, s[16:19], s32 offen offset:3072 lds
    s_add_u32 s32, s53, 16384
    s_add_u32 m0, s49, 68096
    s_nop 0
    buffer_load_dwordx4 v10, s[16:19], s32 offen offset:0 lds
    s_add_u32 s32, s32, 1024
    buffer_load_dwordx4 v10, s[16:19], s32 offen offset:1024 lds
    s_add_u32 s32, s32, 1024
    buffer_load_dwordx4 v10, s[16:19], s32 offen offset:2048 lds
    s_add_u32 s32, s32, 1024
    buffer_load_dwordx4 v10, s[16:19], s32 offen offset:3072 lds
    s_waitcnt vmcnt(25)
    s_barrier
    s_add_u32 s32, s55, 32768
    s_add_u32 m0, s54, 84608
    s_nop 0
    buffer_load_dwordx4 v10, s[16:19], s32 offen offset:0 lds
    s_add_u32 s32, s32, 1024
    buffer_load_dwordx4 v10, s[16:19], s32 offen offset:1024 lds
    s_waitcnt vmcnt(23)
    s_barrier
    s_add_u32 s32, s50, 0
    s_add_u32 m0, s31, 97024
    s_nop 0
    buffer_load_dwordx4 v2, s[20:23], s32 offen offset:0 lds
    buffer_load_dwordx4 v2, s[20:23], s32 offen offset:1024 lds
    buffer_load_dwordx4 v2, s[20:23], s32 offen offset:2048 lds
    buffer_load_dwordx4 v2, s[20:23], s32 offen offset:3072 lds
    s_add_u32 s32, s32, 4096
    s_add_u32 m0, m0, 4096
    s_nop 0
    buffer_load_dwordx4 v2, s[20:23], s32 offen offset:0 lds
    s_waitcnt vmcnt(24)
    s_barrier
    s_waitcnt vmcnt(20)
    s_barrier
    s_mov_b64 exec, s[56:57]
    buffer_store_dword v7, v6, s[44:47], s59 offen offset:64 sc1
    s_mov_b64 exec, -1
    s_add_u32 s32, s50, 20480
    s_add_u32 m0, s31, 117504
    s_nop 0
    buffer_load_dwordx4 v2, s[20:23], s32 offen offset:0 lds
    buffer_load_dwordx4 v2, s[20:23], s32 offen offset:1024 lds
    buffer_load_dwordx4 v2, s[20:23], s32 offen offset:2048 lds
    buffer_load_dwordx4 v2, s[20:23], s32 offen offset:3072 lds
    s_add_u32 s32, s32, 4096
    s_add_u32 m0, m0, 4096
    s_nop 0
    buffer_load_dwordx4 v2, s[20:23], s32 offen offset:0 lds
    s_add_u32 s32, s50, 40960
    s_add_u32 m0, s31, 137984
    s_nop 0
    buffer_load_dwordx4 v2, s[20:23], s32 offen offset:0 lds
    buffer_load_dwordx4 v2, s[20:23], s32 offen offset:1024 lds
    buffer_load_dwordx4 v2, s[20:23], s32 offen offset:2048 lds
    buffer_load_dwordx4 v2, s[20:23], s32 offen offset:3072 lds
    s_add_u32 s32, s32, 4096
    s_add_u32 m0, m0, 4096
    s_nop 0
    buffer_load_dwordx4 v2, s[20:23], s32 offen offset:0 lds
    s_waitcnt vmcnt(27)
    s_barrier
    s_waitcnt vmcnt(22)
    s_barrier
    buffer_load_dword v9, v8, s[44:47], s52 offen offset:0 sc1
    s_add_u32 s32, s50, 61440
    s_add_u32 m0, s31, 2048
    s_nop 0
    buffer_load_dwordx4 v2, s[20:23], s32 offen offset:0 lds
    buffer_load_dwordx4 v2, s[20:23], s32 offen offset:1024 lds
    buffer_load_dwordx4 v2, s[20:23], s32 offen offset:2048 lds
    buffer_load_dwordx4 v2, s[20:23], s32 offen offset:3072 lds
    s_add_u32 s32, s32, 4096
    s_add_u32 m0, m0, 4096
    s_nop 0
    buffer_load_dwordx4 v2, s[20:23], s32 offen offset:0 lds
    s_waitcnt vmcnt(24)
    s_cmp_lg_u32 s3, 0
    s_cbranch_scc1 k_ffn_kernel_pd_4
    s_waitcnt vmcnt(5)
    v_cmp_eq_u32 vcc, 1, v9
    s_cmp_eq_u64 vcc, -1
    s_cbranch_scc1 k_ffn_kernel_pd_4
    s_mov_b32 s43, 0x100000
k_ffn_kernel_pl_3:
    buffer_load_dword v9, v8, s[44:47], s52 offen offset:0 sc1
    s_waitcnt vmcnt(0)
    v_cmp_eq_u32 vcc, 1, v9
    s_cmp_eq_u64 vcc, -1
    s_cbranch_scc1 k_ffn_kernel_pd_4
    s_sleep 1
    s_sub_u32 s43, s43, 1
    s_cmp_lg_u32 s43, 0
    s_cbranch_scc1 k_ffn_kernel_pl_3
k_ffn_kernel_pd_4:
    s_barrier
    s_add_u32 s32, s50, 81920
    s_add_u32 m0, s31, 22528
    s_nop 0
    buffer_load_dwordx4 v2, s[20:23], s32 offen offset:0 lds
    buffer_load_dwordx4 v2, s[20:23], s32 offen offset:1024 lds
    buffer_load_dwordx4 v2, s[20:23], s32 offen offset:2048 lds
    buffer_load_dwordx4 v2, s[20:23], s32 offen offset:3072 lds
    s_add_u32 s32, s32, 4096
    s_add_u32 m0, m0, 4096
    s_nop 0
    buffer_load_dwordx4 v2, s[20:23], s32 offen offset:0 lds
    s_waitcnt vmcnt(27)
    s_barrier
    buffer_load_dword v9, v8, s[44:47], s52 offen offset:64 sc1
    s_add_u32 s32, s50, 102400
    s_add_u32 m0, s31, 43008
    s_nop 0
    buffer_load_dwordx4 v2, s[20:23], s32 offen offset:0 lds
    buffer_load_dwordx4 v2, s[20:23], s32 offen offset:1024 lds
    buffer_load_dwordx4 v2, s[20:23], s32 offen offset:2048 lds
    buffer_load_dwordx4 v2, s[20:23], s32 offen offset:3072 lds
    s_add_u32 s32, s32, 4096
    s_add_u32 m0, m0, 4096
    s_nop 0
    buffer_load_dwordx4 v2, s[20:23], s32 offen offset:0 lds
    s_waitcnt vmcnt(28)
    s_cmp_lg_u32 s3, 0
    s_cbranch_scc1 k_ffn_kernel_pd_6
    s_waitcnt vmcnt(5)
    v_cmp_eq_u32 vcc, 1, v9
    s_cmp_eq_u64 vcc, -1
    s_cbranch_scc1 k_ffn_kernel_pd_6
    s_mov_b32 s43, 0x100000
k_ffn_kernel_pl_5:
    buffer_load_dword v9, v8, s[44:47], s52 offen offset:64 sc1
    s_waitcnt vmcnt(0)
    v_cmp_eq_u32 vcc, 1, v9
    s_cmp_eq_u64 vcc, -1
    s_cbranch_scc1 k_ffn_kernel_pd_6
    s_sleep 1
    s_sub_u32 s43, s43, 1
    s_cmp_lg_u32 s43, 0
    s_cbranch_scc1 k_ffn_kernel_pl_5
k_ffn_kernel_pd_6:
    s_barrier
    s_add_u32 s32, s50, 122880
    s_add_u32 m0, s31, 63488
    s_nop 0
    buffer_load_dwordx4 v2, s[20:23], s32 offen offset:0 lds
    buffer_load_dwordx4 v2, s[20:23], s32 offen offset:1024 lds
    buffer_load_dwordx4 v2, s[20:23], s32 offen offset:2048 lds
    buffer_load_dwordx4 v2, s[20:23], s32 offen offset:3072 lds
    s_add_u32 s32, s32, 4096
    s_add_u32 m0, m0, 4096
    s_nop 0
    buffer_load_dwordx4 v2, s[20:23], s32 offen offset:0 lds
    s_waitcnt vmcnt(27)
    s_barrier
    s_mov_b64 exec, s[56:57]
    buffer_store_dword v7, v6, s[44:47], s59 offen offset:128 sc1
    s_mov_b64 exec, -1
    s_waitcnt vmcnt(23)
    s_barrier
    s_add_u32 s32, s50, 143360
    s_add_u32 m0, s31, 83968
    s_nop 0
    buffer_load_dwordx4 v2, s[20:23], s32 offen offset:0 lds
    buffer_load_dwordx4 v2, s[20:23], s32 offen offset:1024 lds
    buffer_load_dwordx4 v2, s[20:23], s32 offen offset:2048 lds
    buffer_load_dwordx4 v2, s[20:23], s32 offen offset:3072 lds
    s_add_u32 s32, s32, 4096
    s_add_u32 m0, m0, 4096
    s_nop 0
    buffer_load_dwordx4 v2, s[20:23], s32 offen offset:0 lds
    s_waitcnt vmcnt(22)
    s_barrier
    s_mov_b64 exec, s[56:57]
    buffer_store_dword v7, v6, s[44:47], s59 offen offset:192 sc1
    s_mov_b64 exec, -1
    s_add_u32 s32, s50, 163840
    s_add_u32 m0, s31, 104448
    s_nop 0
    buffer_load_dwordx4 v2, s[20:23], s32 offen offset:0 lds
    buffer_load_dwordx4 v2, s[20:23], s32 offen offset:1024 lds
    buffer_load_dwordx4 v2, s[20:23], s32 offen offset:2048 lds
    buffer_load_dwordx4 v2, s[20:23], s32 offen offset:3072 lds
    s_add_u32 s32, s32, 4096
    s_add_u32 m0, m0, 4096
    s_nop 0
    buffer_load_dwordx4 v2, s[20:23], s32 offen offset:0 lds
    s_waitcnt vmcnt(23)
    s_barrier
    s_add_u32 s32, s50, 184320
    s_add_u32 m0, s31, 124928
    s_nop 0
    buffer_load_dwordx4 v2, s[20:23], s32 offen offset:0 lds
    buffer_load_dwordx4 v2, s[20:23], s32 offen offset:1024 lds
    buffer_load_dwordx4 v2, s[20:23], s32 offen offset:2048 lds
    buffer_load_dwordx4 v2, s[20:23], s32 offen offset:3072 lds
    s_add_u32 s32, s32, 4096
    s_add_u32 m0, m0, 4096
    s_nop 0
    buffer_load_dwordx4 v2, s[20:23], s32 offen offset:0 lds
    s_waitcnt vmcnt(22)
    s_barrier
    s_add_u32 s32, s50, 204800
    s_add_u32 m0, s31, 2048
    s_nop 0
    buffer_load_dwordx4 v2, s[20:23], s32 offen offset:0 lds
    buffer_load_dwordx4 v2, s[20:23], s32 offen offset:1024 lds
    buffer_load_dwordx4 v2, s[20:23], s32 offen offset:2048 lds
    buffer_load_dwordx4 v2, s[20:23], s32 offen offset:3072 lds
    s_add_u32 s32, s32, 4096
    s_add_u32 m0, m0, 4096
    s_nop 0
    buffer_load_dwordx4 v2, s[20:23], s32 offen offset:0 lds
    s_waitcnt vmcnt(22)
    s_barrier
    buffer_load_dword v9, v8, s[44:47], s52 offen offset:128 sc1
    s_add_u32 s32, s50, 225280
    s_add_u32 m0, s31, 22528
    s_nop 0
    buffer_load_dwordx4 v2, s[20:23], s32 offen offset:0 lds
    buffer_load_dwordx4 v2, s[20:23], s32 offen offset:1024 lds
    buffer_load_dwordx4 v2, s[20:23], s32 offen offset:2048 lds
    buffer_load_dwordx4 v2, s[20:23], s32 offen offset:3072 lds
    s_add_u32 s32, s32, 4096
    s_add_u32 m0, m0, 4096
    s_nop 0
    buffer_load_dwordx4 v2, s[20:23], s32 offen offset:0 lds
    s_waitcnt vmcnt(22)
    s_cmp_lg_u32 s3, 0
    s_cbranch_scc1 k_ffn_kernel_pd_8
    s_waitcnt vmcnt(5)
    v_cmp_eq_u32 vcc, 1, v9
    s_cmp_eq_u64 vcc, -1
    s_cbranch_scc1 k_ffn_kernel_pd_8
    s_mov_b32 s43, 0x100000
k_ffn_kernel_pl_7:
    buffer_load_dword v9, v8, s[44:47], s52 offen offset:128 sc1
    s_waitcnt vmcnt(0)
    v_cmp_eq_u32 vcc, 1, v9
    s_cmp_eq_u64 vcc, -1
    s_cbranch_scc1 k_ffn_kernel_pd_8
    s_sleep 1
    s_sub_u32 s43, s43, 1
    s_cmp_lg_u32 s43, 0
    s_cbranch_scc1 k_ffn_kernel_pl_7
k_ffn_kernel_pd_8:
    s_barrier
    s_add_u32 s32, s50, 245760
    s_add_u32 m0, s31, 43008
    s_nop 0
    buffer_load_dwordx4 v2, s[20:23], s32 offen offset:0 lds
    buffer_load_dwordx4 v2, s[20:23], s32 offen offset:1024 lds
    buffer_load_dwordx4 v2, s[20:23], s32 offen offset:2048 lds
    buffer_load_dwordx4 v2, s[20:23], s32 offen offset:3072 lds
    s_add_u32 s32, s32, 4096
    s_add_u32 m0, m0, 4096
    s_nop 0
    buffer_load_dwordx4 v2, s[20:23], s32 offen offset:0 lds
    s_waitcnt vmcnt(21)
    s_barrier
    s_add_u32 s32, s50, 266240
    s_add_u32 m0, s31, 63488
    s_cmp_ge_u32 s3, 2
    s_cselect_b32 s33, 10240, 0
    s_sub_u32 s32, s32, s33
    s_sub_u32 m0, m0, s33
    s_nop 0
    buffer_load_dwordx4 v2, s[20:23], s32 offen offset:0 lds
    buffer_load_dwordx4 v2, s[20:23], s32 offen offset:1024 lds
    buffer_load_dwordx4 v2, s[20:23], s32 offen offset:2048 lds
    buffer_load_dwordx4 v2, s[20:23], s32 offen offset:3072 lds
    s_add_u32 s32, s32, 4096
    s_add_u32 m0, m0, 4096
    s_nop 0
    buffer_load_dwordx4 v2, s[20:23], s32 offen offset:0 lds
    s_waitcnt vmcnt(21)
    s_barrier
    s_waitcnt vmcnt(16)
    s_barrier
    buffer_load_dword v9, v8, s[44:47], s52 offen offset:192 sc1
    s_waitcnt vmcnt(11)
    s_cmp_lg_u32 s3, 0
    s_cbranch_scc1 k_ffn_kernel_pd_10
    s_waitcnt vmcnt(0)
    v_cmp_eq_u32 vcc, 1, v9
    s_cmp_eq_u64 vcc, -1
    s_cbranch_scc1 k_ffn_kernel_pd_10
    s_mov_b32 s43, 0x100000
k_ffn_kernel_pl_9:
    buffer_load_dword v9, v8, s[44:47], s52 offen offset:192 sc1
    s_waitcnt vmcnt(0)
    v_cmp_eq_u32 vcc, 1, v9
    s_cmp_eq_u64 vcc, -1
    s_cbranch_scc1 k_ffn_kernel_pd_10
    s_sleep 1
    s_sub_u32 s43, s43, 1
    s_cmp_lg_u32 s43, 0
    s_cbranch_scc1 k_ffn_kernel_pl_9
k_ffn_kernel_pd_10:
    s_barrier
    s_waitcnt vmcnt(6)
    s_barrier
    s_waitcnt vmcnt(1)
    s_barrier
    s_waitcnt vmcnt(0)
k_ffn_kernel_end:
    s_endpgm
code_end:
.section .rodata,"a"
.p2align 6
.amdhsa_kernel k_qkv_kernel
  .amdhsa_next_free_vgpr 192
  .amdhsa_next_free_sgpr 102
  .amdhsa_accum_offset 192
  .amdhsa_group_segment_fixed_size 0
  .amdhsa_kernarg_size 80
  .amdhsa_user_sgpr_count 2
  .amdhsa_user_sgpr_kernarg_segment_ptr 1
  .amdhsa_system_sgpr_workgroup_id_x 1
.end_amdhsa_kernel
.p2align 6
.amdhsa_kernel k_attn_kernel
  .amdhsa_next_free_vgpr 144
  .amdhsa_next_free_sgpr 102
  .amdhsa_accum_offset 144
  .amdhsa_group_segment_fixed_size 0
  .amdhsa_kernarg_size 80
  .amdhsa_user_sgpr_count 2
  .amdhsa_user_sgpr_kernarg_segment_ptr 1
  .amdhsa_system_sgpr_workgroup_id_x 1
.end_amdhsa_kernel
.p2align 6
.amdhsa_kernel k_ffn_kernel
  .amdhsa_next_free_vgpr 256
  .amdhsa_next_free_sgpr 102
  .amdhsa_accum_offset 256
  .amdhsa_group_segment_fixed_size 0
  .amdhsa_kernarg_size 80
  .amdhsa_user_sgpr_count 2
  .amdhsa_user_sgpr_kernarg_segment_ptr 1
  .amdhsa_system_sgpr_workgroup_id_x 1
.end_amdhsa_kernel
```
